```python
import torch

def _softmax(x, axis=-1):
    return torch.softmax(x, dim=axis)
def _gelu(x):
    return torch.nn.functional.gelu(x, approximate="tanh")
def _silu(x):
    return torch.nn.functional.silu(x)
def _sigmoid(x):
    return torch.sigmoid(x)
def _layernorm(x, axis=-1, eps=1e-5):
    m = x.mean(dim=axis, keepdim=True)
    v = x.var(dim=axis, keepdim=True, unbiased=False)
    return (x - m) / torch.sqrt(v + eps)
def _scatter_add(tgt, idx, src, axis=0):
    return tgt.clone().index_add_(axis, idx, src)
def _segment_sum(src, seg, n):
    out = torch.zeros((n,) + src.shape[1:], dtype=src.dtype)
    return out.index_add_(0, seg, src)
def _pad(x, pw):
    flat = tuple(v for pair in reversed(pw) for v in pair)
    return torch.nn.functional.pad(x, flat)

kernel_name = 'standalone__gqa_block_cached__near_ridge'

def setup_inputs():

    _w = (lambda a: (lambda t: t.to(torch.bfloat16) if t.is_floating_point() else t)(torch.as_tensor(a)))
    B, Sq, D = 8, 160, 448
    Hq, Hkv, Sk, Dh = 16, 8, 1024, 256
    assert Hq % Hkv == 0, (Hq, Hkv)
    return {
        "x": _w((lambda *s: torch.randn(*s, dtype=torch.bfloat16) * 0.8)(B, Sq, D)),
        "k_cache": _w((lambda *s: torch.randn(*s, dtype=torch.bfloat16) * 0.8)(B, Hkv, Sk, Dh)),
        "v_cache": _w((lambda *s: torch.randn(*s, dtype=torch.bfloat16) * 0.05)(B, Hkv, Sk, Dh)),
        "wq": _w((lambda *s: torch.randn(*s, dtype=torch.bfloat16) * 0.8)(D, Hq * Dh) * (D ** -0.5)),
        "wo": _w((lambda *s: torch.randn(*s, dtype=torch.bfloat16) * 0.05)(Hq * Dh, D) * ((Hq * Dh) ** -0.5)),
    }

def reference(x, k_cache, v_cache, wq, wo):
    B, Sq, D = x.shape
    Hq, Dh = 16, 256
    Hkv = k_cache.shape[1]
    rep = Hq // Hkv
    q = (lambda x, *d: x.permute(*d))((x @ wq).reshape(B, Sq, Hq, Dh), 0, 2, 1, 3)
    k = (lambda x, n, axis: torch.repeat_interleave(x, n, dim=axis))(k_cache, rep, axis=1)
    v = (lambda x, n, axis: torch.repeat_interleave(x, n, dim=axis))(v_cache, rep, axis=1)
    scores = torch.einsum("bhqd,bhkd->bhqk", q, k) * (Dh ** -0.5)
    p = _softmax(scores, axis=-1)
    o = torch.einsum("bhqk,bhkd->bhqd", p, v)
    return (lambda x, *d: x.permute(*d))(o, 0, 2, 1, 3).reshape(B, Sq, Hq * Dh) @ wo
```

```asm
; @launch kernel=attn_kernel grid=(256,1,1) block=(256,1,1) lds=163840
; @launch kernel=red_kernel grid=(2304,1,1) block=(64,1,1) lds=0
.amdgcn_target "amdgcn-amd-amdhsa--gfx950"
.text
.globl attn_kernel
.p2align 8
.type attn_kernel,@function
attn_kernel:
    s_cmp_ge_u32 s2, 256
    s_cbranch_scc1 L_attn_kernel_done
    s_load_dwordx16 s[4:19], s[0:1], 0
    s_getpc_b64 s[94:95]
L_pc0:
    v_lshrrev_b32 v1, 6, v0
    s_nop 0
    v_readfirstlane_b32 s45, v1
    v_and_b32 v0, 63, v0
    s_lshr_b32 s88, s2, 3
    s_lshl_b32 s88, s88, 2
    s_add_u32 s88, s88, s45
    s_mul_i32 s88, s88, 384
    s_min_u32 s88, s88, L_text_end-L_pc0-384
    s_add_u32 s94, s94, s88
    s_addc_u32 s95, s95, 0
    s_load_dword s99, s[94:95], 0
    s_load_dword s99, s[94:95], 64
    s_load_dword s99, s[94:95], 128
    s_load_dword s99, s[94:95], 192
    s_load_dword s99, s[94:95], 256
    s_load_dword s99, s[94:95], 320
    s_and_b32 s3, s2, 7
    s_lshr_b32 s46, s2, 5
    s_bfe_u32 s51, s2, 0x20003
    s_lshr_b32 s100, s51, 1
    s_lshl_b32 s101, s3, 1
    s_add_u32 s101, s101, s100
    s_lshr_b32 s63, s45, 1
    s_mov_b32 s92, 0x3db8aa3b
    s_mov_b32 s93, s92
    s_mov_b32 s48, 0x3f803f80
    s_mov_b32 s54, 0
    s_and_b32 s88, s51, 1
    s_lshl_b32 s62, s46, 1
    s_add_u32 s62, s62, s88
    s_mul_i32 s88, s62, 37
    s_lshr_b32 s88, s88, 8
    s_mul_i32 s88, s88, 7
    s_sub_u32 s55, s62, s88
L_restart:
    v_lshrrev_b32 v6, 3, v0
    v_and_b32 v7, 7, v0
    v_xor_b32 v7, v7, v6
    v_lshlrev_b32 v7, 4, v7
    s_mul_i32 s60, s100, 3
    s_add_u32 s60, s60, s55
    s_sub_u32 s88, s60, 7
    s_cmp_ge_u32 s60, 7
    s_cselect_b32 s60, s88, s60
    s_mov_b32 s44, s60
    s_lshl_b32 s52, s45, 12
    s_lshl_b32 s53, s45, 10
    v_and_b32 v156, 3, v6
    v_lshrrev_b32 v157, 2, v6
    v_lshl_add_u32 v156, v157, 3, v156
    s_and_b32 s56, s45, 1
    s_lshl_b32 s56, s56, 4
    s_lshl_b32 s57, s63, 2
    s_add_u32 s56, s56, s57
    v_add_u32 v156, s56, v156
    v_lshl_add_u32 v39, v156, 13, v7
    s_lshl_b32 s56, s45, 3
    v_add_u32 v156, s56, v6
    v_mul_u32_u24 v156, 896, v156
    v_add_u32 v40, v156, v7
    v_mov_b32 v43, v40
    s_lshl_b32 s88, s101, 9
    s_sub_u32 s89, 3670016, s88
    s_waitcnt lgkmcnt(0)
    s_add_u32 s32, s10, s88
    s_addc_u32 s33, s11, 0
    s_and_b32 s33, s33, 0xffff
    s_mov_b32 s34, s89
    s_mov_b32 s35, 0x00020000
    s_mul_i32 s88, s62, 71680
    s_add_u32 s20, s4, s88
    s_addc_u32 s21, s5, 0
    s_and_b32 s21, s21, 0xffff
    s_mov_b32 s22, 71680
    s_mov_b32 s23, 0x00020000
    s_add_u32 m0, s53, 139264
    s_lshl_b32 s56, s44, 7
    s_add_u32 s57, s56, 28672
    s_add_u32 s58, s56, 57344
    s_add_u32 s44, s44, 1
    s_cmp_eq_u32 s44, 7
    s_cselect_b32 s44, 0, s44
    s_cmp_lg_u32 s63, 0
    s_cbranch_scc1 L_x3_0
    buffer_load_dwordx4 v40, s[20:23], s58 offen lds
L_x3_0:
    s_add_u32 m0, s53, 131072
    s_nop 0
    buffer_load_dwordx4 v40, s[20:23], s56 offen lds
    s_add_u32 m0, s53, 135168
    s_nop 0
    buffer_load_dwordx4 v40, s[20:23], s57 offen lds
    s_add_u32 m0, s52, 0
    s_lshl_b32 s56, s60, 19
    s_add_u32 s57, s56, 262144
    s_add_u32 s60, s60, 1
    s_cmp_eq_u32 s60, 7
    s_cselect_b32 s60, 0, s60
    buffer_load_dwordx4 v39, s[32:35], s56 offen lds
    s_add_u32 m0, s52, 896
    s_nop 0
    buffer_load_dwordx4 v39, s[32:35], s56 offen offset:128 lds
    s_add_u32 m0, s52, 1792
    s_nop 0
    buffer_load_dwordx4 v39, s[32:35], s56 offen offset:256 lds
    s_add_u32 m0, s52, 2688
    s_nop 0
    buffer_load_dwordx4 v39, s[32:35], s56 offen offset:384 lds
    s_add_u32 m0, s52, 16384
    s_nop 0
    buffer_load_dwordx4 v39, s[32:35], s57 offen lds
    s_add_u32 m0, s52, 17280
    s_nop 0
    buffer_load_dwordx4 v39, s[32:35], s57 offen offset:128 lds
    s_add_u32 m0, s52, 18176
    s_nop 0
    buffer_load_dwordx4 v39, s[32:35], s57 offen offset:256 lds
    s_add_u32 m0, s52, 19072
    s_nop 0
    buffer_load_dwordx4 v39, s[32:35], s57 offen offset:384 lds
    v_lshl_add_u32 v156, v6, 9, v7
    v_add_u32 v41, s52, v156
    s_and_b32 s56, s45, 1
    s_lshl_b32 s56, s56, 12
    v_add_u32 v42, s56, v156
    s_lshl_b32 s88, s46, 3
    s_add_u32 s88, s88, s3
    s_lshl_b32 s88, s88, 19
    s_add_u32 s24, s6, s88
    s_addc_u32 s25, s7, 0
    s_and_b32 s25, s25, 0xffff
    s_mov_b32 s26, 524288
    s_mov_b32 s27, 0x00020000
    s_add_u32 s28, s8, s88
    s_addc_u32 s29, s9, 0
    s_and_b32 s29, s29, 0xffff
    s_mov_b32 s30, 524288
    s_mov_b32 s31, 0x00020000
    s_mul_i32 s88, s101, 229376
    s_add_u32 s36, s12, s88
    s_addc_u32 s37, s13, 0
    s_and_b32 s37, s37, 0xffff
    s_mov_b32 s38, 229376
    s_mov_b32 s39, 0x00020000
    s_lshl_b32 s50, s100, 14
    s_add_u32 s88, s51, 0
    s_and_b32 s88, s88, 3
    s_lshl_b32 s56, s88, 15
    s_add_u32 s88, s51, 1
    s_and_b32 s88, s88, 3
    s_lshl_b32 s57, s88, 15
    s_add_u32 s88, s51, 2
    s_and_b32 s88, s88, 3
    s_lshl_b32 s58, s88, 15
    s_add_u32 s88, s51, 3
    s_and_b32 s88, s88, 3
    s_lshl_b32 s59, s88, 15
    s_and_b32 s89, s46, 1
    s_add_u32 s64, s56, 0
    s_add_u32 s65, s58, 0
    s_add_u32 s66, s57, 0
    s_add_u32 s88, s56, 131072
    s_cmp_eq_u32 s89, 0
    s_cselect_b32 s66, s66, s88
    s_add_u32 s67, s59, 0
    s_add_u32 s88, s58, 131072
    s_cmp_eq_u32 s89, 0
    s_cselect_b32 s67, s67, s88
    s_add_u32 s68, s56, 131072
    s_add_u32 s88, s57, 0
    s_cmp_eq_u32 s89, 0
    s_cselect_b32 s68, s68, s88
    s_add_u32 s69, s58, 131072
    s_add_u32 s88, s59, 0
    s_cmp_eq_u32 s89, 0
    s_cselect_b32 s69, s69, s88
    s_add_u32 s70, s57, 131072
    s_add_u32 s88, s56, 262144
    s_cmp_eq_u32 s89, 0
    s_cselect_b32 s70, s70, s88
    s_add_u32 s71, s59, 131072
    s_add_u32 s88, s58, 262144
    s_cmp_eq_u32 s89, 0
    s_cselect_b32 s71, s71, s88
    s_add_u32 s72, s56, 262144
    s_add_u32 s88, s57, 131072
    s_cmp_eq_u32 s89, 0
    s_cselect_b32 s72, s72, s88
    s_add_u32 s73, s58, 262144
    s_add_u32 s88, s59, 131072
    s_cmp_eq_u32 s89, 0
    s_cselect_b32 s73, s73, s88
    s_add_u32 s74, s57, 262144
    s_add_u32 s88, s56, 393216
    s_cmp_eq_u32 s89, 0
    s_cselect_b32 s74, s74, s88
    s_add_u32 s75, s59, 262144
    s_add_u32 s88, s58, 393216
    s_cmp_eq_u32 s89, 0
    s_cselect_b32 s75, s75, s88
    s_add_u32 s76, s56, 393216
    s_add_u32 s88, s57, 262144
    s_cmp_eq_u32 s89, 0
    s_cselect_b32 s76, s76, s88
    s_add_u32 s77, s58, 393216
    s_add_u32 s88, s59, 262144
    s_cmp_eq_u32 s89, 0
    s_cselect_b32 s77, s77, s88
    s_add_u32 s78, s57, 393216
    s_add_u32 s79, s59, 393216
    s_lshl_b32 s88, s101, 4
    s_add_u32 s88, s88, s62
    s_mul_i32 s88, s88, 73728
    s_add_u32 s40, s18, s88
    s_addc_u32 s41, s19, 0
    s_and_b32 s41, s41, 0xffff
    s_mov_b32 s42, 73728
    s_mov_b32 s43, 0x00020000
    s_xor_b32 s49, s63, s100
    v_bfe_u32 v6, v0, 2, 3
    v_bfe_u32 v7, v0, 1, 1
    v_lshrrev_b32 v156, 5, v0
    v_lshlrev_b32 v156, 12, v156
    v_lshl_add_u32 v156, v6, 7, v156
    v_and_b32 v157, 1, v0
    v_lshl_add_u32 v156, v157, 3, v156
    v_add_u32 v156, s53, v156
    v_or_b32 v157, 0, v7
    v_xor_b32 v157, v157, v6
    v_lshl_add_u32 v28, v157, 4, v156
    v_or_b32 v157, 2, v7
    v_xor_b32 v157, v157, v6
    v_lshl_add_u32 v29, v157, 4, v156
    v_or_b32 v157, 4, v7
    v_xor_b32 v157, v157, v6
    v_lshl_add_u32 v30, v157, 4, v156
    v_or_b32 v157, 6, v7
    v_xor_b32 v157, v157, v6
    v_lshl_add_u32 v31, v157, 4, v156
    v_and_b32 v6, 7, v0
    v_lshrrev_b32 v7, 4, v0
    v_bfe_u32 v156, v0, 3, 1
    s_lshl_b32 s56, s45, 13
    v_or_b32 v157, 0, v7
    v_xor_b32 v157, v157, v6
    v_lshlrev_b32 v157, 4, v157
    v_lshl_add_u32 v157, v6, 7, v157
    v_lshl_add_u32 v44, v156, 10, v157
    v_add_u32 v44, 131072, v44
    v_lshl_add_u32 v32, v156, 12, v157
    v_add_u32 v32, s56, v32
    v_or_b32 v157, 4, v7
    v_xor_b32 v157, v157, v6
    v_lshlrev_b32 v157, 4, v157
    v_lshl_add_u32 v157, v6, 7, v157
    v_lshl_add_u32 v45, v156, 10, v157
    v_add_u32 v45, 131072, v45
    v_lshl_add_u32 v33, v156, 12, v157
    v_add_u32 v33, s56, v33
    v_lshlrev_b32 v34, 4, v0
    v_add_u32 v35, 98304, v34
    v_mov_b32 v6, 0
    v_mov_b32 v7, 163072
    ds_write_b32 v7, v6 offset:0
    v_mov_b32 v1, 0xff800000
    v_mov_b32 v2, 0xff800000
    v_mov_b32 v3, 0xff800000
    v_mov_b32 v4, 0xff800000
    v_mov_b32 v5, 0xff800000
    v_mov_b32 v236, s48
    v_mov_b32 v237, s48
    v_mov_b32 v238, s48
    v_mov_b32 v239, s48
    s_and_b32 s59, s45, 1
    s_mul_i32 s59, s59, 5120
    s_mov_b32 s58, 141312
    s_cmp_eq_u32 s49, 0
    s_cselect_b32 s58, 131072, s58
    s_add_u32 s58, s58, s59
    v_add_u32 v36, s58, v34
    s_mov_b32 s58, 151552
    s_cmp_eq_u32 s49, 0
    s_cselect_b32 s58, 141312, s58
    s_add_u32 s58, s58, s59
    v_add_u32 v37, s58, v34
    s_mov_b32 s58, 131072
    s_cmp_eq_u32 s49, 0
    s_cselect_b32 s58, 151552, s58
    s_add_u32 s58, s58, s59
    v_add_u32 v38, s58, v34
    s_add_u32 m0, s53, 149504
    s_lshl_b32 s56, s44, 7
    s_add_u32 s57, s56, 28672
    s_add_u32 s58, s56, 57344
    s_add_u32 s44, s44, 1
    s_cmp_eq_u32 s44, 7
    s_cselect_b32 s44, 0, s44
    s_cmp_lg_u32 s63, 0
    s_cbranch_scc1 L_x3_1
    buffer_load_dwordx4 v40, s[20:23], s58 offen lds
L_x3_1:
    s_add_u32 m0, s53, 141312
    s_nop 0
    buffer_load_dwordx4 v40, s[20:23], s56 offen lds
    s_add_u32 m0, s53, 145408
    s_nop 0
    buffer_load_dwordx4 v40, s[20:23], s57 offen lds
    s_add_u32 m0, s52, 32768
    s_lshl_b32 s56, s60, 19
    s_add_u32 s57, s56, 262144
    s_add_u32 s60, s60, 1
    s_cmp_eq_u32 s60, 7
    s_cselect_b32 s60, 0, s60
    buffer_load_dwordx4 v39, s[32:35], s56 offen lds
    s_add_u32 m0, s52, 33664
    s_nop 0
    buffer_load_dwordx4 v39, s[32:35], s56 offen offset:128 lds
    s_add_u32 m0, s52, 34560
    s_nop 0
    buffer_load_dwordx4 v39, s[32:35], s56 offen offset:256 lds
    s_add_u32 m0, s52, 35456
    s_nop 0
    buffer_load_dwordx4 v39, s[32:35], s56 offen offset:384 lds
    s_add_u32 m0, s52, 49152
    s_nop 0
    buffer_load_dwordx4 v39, s[32:35], s57 offen lds
    s_add_u32 m0, s52, 50048
    s_nop 0
    buffer_load_dwordx4 v39, s[32:35], s57 offen offset:128 lds
    s_add_u32 m0, s52, 50944
    s_nop 0
    buffer_load_dwordx4 v39, s[32:35], s57 offen offset:256 lds
    s_add_u32 m0, s52, 51840
    s_nop 0
    buffer_load_dwordx4 v39, s[32:35], s57 offen offset:384 lds
    s_add_u32 m0, s53, 159744
    s_lshl_b32 s56, s44, 7
    s_add_u32 s57, s56, 28672
    s_add_u32 s58, s56, 57344
    s_add_u32 s44, s44, 1
    s_cmp_eq_u32 s44, 7
    s_cselect_b32 s44, 0, s44
    s_cmp_lg_u32 s63, 0
    s_cbranch_scc1 L_x3_2
    buffer_load_dwordx4 v40, s[20:23], s58 offen lds
L_x3_2:
    s_add_u32 m0, s53, 151552
    s_nop 0
    buffer_load_dwordx4 v40, s[20:23], s56 offen lds
    s_add_u32 m0, s53, 155648
    s_nop 0
    buffer_load_dwordx4 v40, s[20:23], s57 offen lds
    s_add_u32 m0, s52, 65536
    s_lshl_b32 s56, s60, 19
    s_add_u32 s57, s56, 262144
    s_add_u32 s60, s60, 1
    s_cmp_eq_u32 s60, 7
    s_cselect_b32 s60, 0, s60
    buffer_load_dwordx4 v39, s[32:35], s56 offen lds
    s_add_u32 m0, s52, 66432
    s_nop 0
    buffer_load_dwordx4 v39, s[32:35], s56 offen offset:128 lds
    s_add_u32 m0, s52, 67328
    s_nop 0
    buffer_load_dwordx4 v39, s[32:35], s56 offen offset:256 lds
    s_add_u32 m0, s52, 68224
    s_nop 0
    buffer_load_dwordx4 v39, s[32:35], s56 offen offset:384 lds
    s_add_u32 m0, s52, 81920
    s_nop 0
    buffer_load_dwordx4 v39, s[32:35], s57 offen lds
    s_add_u32 m0, s52, 82816
    s_nop 0
    buffer_load_dwordx4 v39, s[32:35], s57 offen offset:128 lds
    s_add_u32 m0, s52, 83712
    s_nop 0
    buffer_load_dwordx4 v39, s[32:35], s57 offen offset:256 lds
    s_add_u32 m0, s52, 84608
    s_nop 0
    buffer_load_dwordx4 v39, s[32:35], s57 offen offset:384 lds
    s_waitcnt lgkmcnt(0)
    s_waitcnt vmcnt(24)
    s_barrier
    ds_read_b128 a[0:3], v44 offset:0
    ds_read_b128 a[4:7], v44 offset:2048
    ds_read_b128 a[8:11], v44 offset:4096
    ds_read_b128 a[12:15], v44 offset:6144
    ds_read_b128 a[16:19], v44 offset:8192
    ds_read_b128 a[20:23], v45 offset:0
    ds_read_b128 a[24:27], v45 offset:2048
    ds_read_b128 a[28:31], v45 offset:4096
    ds_read_b128 a[32:35], v45 offset:6144
    ds_read_b128 a[36:39], v45 offset:8192
    ds_read_b64_tr_b16 a[160:161], v28 offset:0
    ds_read_b64_tr_b16 a[162:163], v28 offset:8192
    ds_read_b64_tr_b16 a[164:165], v29 offset:0
    ds_read_b64_tr_b16 a[166:167], v29 offset:8192
    ds_read_b64_tr_b16 a[168:169], v30 offset:0
    ds_read_b64_tr_b16 a[170:171], v30 offset:8192
    ds_read_b64_tr_b16 a[172:173], v31 offset:0
    ds_read_b64_tr_b16 a[174:175], v31 offset:8192
    s_waitcnt lgkmcnt(8)
    s_waitcnt vmcnt(14)
    s_barrier
    s_waitcnt lgkmcnt(4)
    v_mfma_f32_16x16x32_bf16 v[56:59], a[160:163], a[0:3], 0
    v_mfma_f32_16x16x32_bf16 v[60:63], a[160:163], a[4:7], 0
    ds_read_b64_tr_b16 a[176:177], v28 offset:16384
    v_mfma_f32_16x16x32_bf16 v[64:67], a[160:163], a[8:11], 0
    ds_read_b64_tr_b16 a[178:179], v28 offset:24576
    v_mfma_f32_16x16x32_bf16 v[68:71], a[160:163], a[12:15], 0
    s_add_u32 m0, s52, 98304
    s_lshl_b32 s56, s60, 19
    s_add_u32 s57, s56, 262144
    s_add_u32 s60, s60, 1
    s_cmp_eq_u32 s60, 7
    s_cselect_b32 s60, 0, s60
    buffer_load_dwordx4 v39, s[32:35], s56 offen lds
    s_add_u32 m0, s52, 99200
    v_mfma_f32_16x16x32_bf16 v[72:75], a[160:163], a[16:19], 0
    ds_read_b128 a[40:43], v44 offset:10240
    v_mfma_f32_16x16x32_bf16 v[76:79], a[164:167], a[0:3], 0
    ds_read_b64_tr_b16 a[180:181], v29 offset:16384
    v_mfma_f32_16x16x32_bf16 v[80:83], a[164:167], a[4:7], 0
    ds_read_b64_tr_b16 a[182:183], v29 offset:24576
    v_mfma_f32_16x16x32_bf16 v[84:87], a[164:167], a[8:11], 0
    buffer_load_dwordx4 v39, s[32:35], s56 offen offset:128 lds
    s_add_u32 m0, s52, 100096
    v_mfma_f32_16x16x32_bf16 v[88:91], a[164:167], a[12:15], 0
    ds_read_b128 a[44:47], v44 offset:12288
    v_mfma_f32_16x16x32_bf16 v[92:95], a[164:167], a[16:19], 0
    ds_read_b64_tr_b16 a[184:185], v30 offset:16384
    s_waitcnt lgkmcnt(7)
    v_mfma_f32_16x16x32_bf16 v[96:99], a[168:171], a[0:3], 0
    buffer_load_dwordx4 v39, s[32:35], s56 offen offset:256 lds
    s_add_u32 m0, s52, 100992
    v_mfma_f32_16x16x32_bf16 v[100:103], a[168:171], a[4:7], 0
    ds_read_b64_tr_b16 a[186:187], v30 offset:24576
    v_mfma_f32_16x16x32_bf16 v[104:107], a[168:171], a[8:11], 0
    ds_read_b128 a[48:51], v44 offset:14336
    v_mfma_f32_16x16x32_bf16 v[108:111], a[168:171], a[12:15], 0
    buffer_load_dwordx4 v39, s[32:35], s56 offen offset:384 lds
    s_add_u32 m0, s52, 114688
    v_mfma_f32_16x16x32_bf16 v[112:115], a[168:171], a[16:19], 0
    ds_read_b128 a[52:55], v44 offset:16384
    v_mfma_f32_16x16x32_bf16 v[116:119], a[172:175], a[0:3], 0
    ds_read_b64_tr_b16 a[188:189], v31 offset:16384
    v_mfma_f32_16x16x32_bf16 v[120:123], a[172:175], a[4:7], 0
    ds_read_b64_tr_b16 a[190:191], v31 offset:24576
    v_mfma_f32_16x16x32_bf16 v[124:127], a[172:175], a[8:11], 0
    buffer_load_dwordx4 v39, s[32:35], s57 offen lds
    s_add_u32 m0, s52, 115584
    v_mfma_f32_16x16x32_bf16 v[128:131], a[172:175], a[12:15], 0
    ds_read_b128 a[56:59], v44 offset:18432
    v_mfma_f32_16x16x32_bf16 v[132:135], a[172:175], a[16:19], 0
    ds_read_b64_tr_b16 a[192:193], v28 offset:32768
    s_waitcnt lgkmcnt(9)
    v_mfma_f32_16x16x32_bf16 v[56:59], a[176:179], a[20:23], v[56:59]
    ds_read_b64_tr_b16 a[194:195], v28 offset:40960
    v_mfma_f32_16x16x32_bf16 v[60:63], a[176:179], a[24:27], v[60:63]
    buffer_load_dwordx4 v39, s[32:35], s57 offen offset:128 lds
    s_add_u32 m0, s52, 116480
    v_mfma_f32_16x16x32_bf16 v[64:67], a[176:179], a[28:31], v[64:67]
    ds_read_b128 a[60:63], v45 offset:10240
    v_mfma_f32_16x16x32_bf16 v[68:71], a[176:179], a[32:35], v[68:71]
    ds_read_b64_tr_b16 a[196:197], v29 offset:32768
    v_mfma_f32_16x16x32_bf16 v[72:75], a[176:179], a[36:39], v[72:75]
    ds_read_b128 a[64:67], v45 offset:12288
    v_mfma_f32_16x16x32_bf16 v[76:79], a[180:183], a[20:23], v[76:79]
    buffer_load_dwordx4 v39, s[32:35], s57 offen offset:256 lds
    s_add_u32 m0, s52, 117376
    v_mfma_f32_16x16x32_bf16 v[80:83], a[180:183], a[24:27], v[80:83]
    ds_read_b64_tr_b16 a[198:199], v29 offset:40960
    v_mfma_f32_16x16x32_bf16 v[84:87], a[180:183], a[28:31], v[84:87]
    ds_read_b128 a[68:71], v45 offset:14336
    v_mfma_f32_16x16x32_bf16 v[88:91], a[180:183], a[32:35], v[88:91]
    buffer_load_dwordx4 v39, s[32:35], s57 offen offset:384 lds
    v_mfma_f32_16x16x32_bf16 v[92:95], a[180:183], a[36:39], v[92:95]
    ds_read_b64_tr_b16 a[160:161], v30 offset:32768
    s_waitcnt lgkmcnt(9)
    v_mfma_f32_16x16x32_bf16 v[96:99], a[184:187], a[20:23], v[96:99]
    ds_read_b64_tr_b16 a[162:163], v30 offset:40960
    v_mfma_f32_16x16x32_bf16 v[100:103], a[184:187], a[24:27], v[100:103]
    ds_read_b128 a[72:75], v45 offset:16384
    v_mfma_f32_16x16x32_bf16 v[104:107], a[184:187], a[28:31], v[104:107]
    s_add_u32 m0, s53, 139264
    s_lshl_b32 s56, s44, 7
    s_add_u32 s57, s56, 28672
    s_add_u32 s58, s56, 57344
    s_add_u32 s44, s44, 1
    s_cmp_eq_u32 s44, 7
    s_cselect_b32 s44, 0, s44
    s_cmp_lg_u32 s63, 0
    s_cbranch_scc1 L_x3_3
    buffer_load_dwordx4 v40, s[20:23], s58 offen lds
L_x3_3:
    s_add_u32 m0, s53, 131072
    v_mfma_f32_16x16x32_bf16 v[108:111], a[184:187], a[32:35], v[108:111]
    ds_read_b64_tr_b16 a[164:165], v31 offset:32768
    v_mfma_f32_16x16x32_bf16 v[112:115], a[184:187], a[36:39], v[112:115]
    ds_read_b128 a[76:79], v45 offset:18432
    v_mfma_f32_16x16x32_bf16 v[116:119], a[188:191], a[20:23], v[116:119]
    ds_read_b64_tr_b16 a[166:167], v31 offset:40960
    v_mfma_f32_16x16x32_bf16 v[120:123], a[188:191], a[24:27], v[120:123]
    buffer_load_dwordx4 v40, s[20:23], s56 offen lds
    s_add_u32 m0, s53, 135168
    v_mfma_f32_16x16x32_bf16 v[124:127], a[188:191], a[28:31], v[124:127]
    buffer_load_dwordx4 v40, s[20:23], s57 offen lds
    v_mfma_f32_16x16x32_bf16 v[128:131], a[188:191], a[32:35], v[128:131]
    v_mfma_f32_16x16x32_bf16 v[132:135], a[188:191], a[36:39], v[132:135]
    s_waitcnt lgkmcnt(1)
    s_waitcnt vmcnt(14)
    s_barrier
    v_mfma_f32_16x16x32_bf16 v[56:59], a[192:195], a[40:43], v[56:59]
    v_mfma_f32_16x16x32_bf16 v[60:63], a[192:195], a[44:47], v[60:63]
    ds_read_b64_tr_b16 a[168:169], v28 offset:49152
    v_mfma_f32_16x16x32_bf16 v[64:67], a[192:195], a[48:51], v[64:67]
    ds_read_b64_tr_b16 a[170:171], v28 offset:57344
    v_mfma_f32_16x16x32_bf16 v[68:71], a[192:195], a[52:55], v[68:71]
    s_add_u32 m0, s52, 0
    s_lshl_b32 s56, s60, 19
    s_add_u32 s57, s56, 262144
    s_add_u32 s60, s60, 1
    s_cmp_eq_u32 s60, 7
    s_cselect_b32 s60, 0, s60
    buffer_load_dwordx4 v39, s[32:35], s56 offen lds
    s_add_u32 m0, s52, 896
    v_mfma_f32_16x16x32_bf16 v[72:75], a[192:195], a[56:59], v[72:75]
    ds_read_b128 a[0:3], v44 offset:20480
    v_mfma_f32_16x16x32_bf16 v[76:79], a[196:199], a[40:43], v[76:79]
    ds_read_b64_tr_b16 a[172:173], v29 offset:49152
    v_mfma_f32_16x16x32_bf16 v[80:83], a[196:199], a[44:47], v[80:83]
    ds_read_b64_tr_b16 a[174:175], v29 offset:57344
    v_mfma_f32_16x16x32_bf16 v[84:87], a[196:199], a[48:51], v[84:87]
    buffer_load_dwordx4 v39, s[32:35], s56 offen offset:128 lds
    s_add_u32 m0, s52, 1792
    v_mfma_f32_16x16x32_bf16 v[88:91], a[196:199], a[52:55], v[88:91]
    ds_read_b128 a[4:7], v44 offset:22528
    v_mfma_f32_16x16x32_bf16 v[92:95], a[196:199], a[56:59], v[92:95]
    ds_read_b64_tr_b16 a[176:177], v30 offset:49152
    s_waitcnt lgkmcnt(7)
    v_mfma_f32_16x16x32_bf16 v[96:99], a[160:163], a[40:43], v[96:99]
    buffer_load_dwordx4 v39, s[32:35], s56 offen offset:256 lds
    s_add_u32 m0, s52, 2688
    v_mfma_f32_16x16x32_bf16 v[100:103], a[160:163], a[44:47], v[100:103]
    ds_read_b64_tr_b16 a[178:179], v30 offset:57344
    v_mfma_f32_16x16x32_bf16 v[104:107], a[160:163], a[48:51], v[104:107]
    ds_read_b128 a[8:11], v44 offset:24576
    v_mfma_f32_16x16x32_bf16 v[108:111], a[160:163], a[52:55], v[108:111]
    buffer_load_dwordx4 v39, s[32:35], s56 offen offset:384 lds
    s_add_u32 m0, s52, 16384
    v_mfma_f32_16x16x32_bf16 v[112:115], a[160:163], a[56:59], v[112:115]
    ds_read_b128 a[12:15], v44 offset:26624
    v_mfma_f32_16x16x32_bf16 v[116:119], a[164:167], a[40:43], v[116:119]
    ds_read_b64_tr_b16 a[180:181], v31 offset:49152
    v_mfma_f32_16x16x32_bf16 v[120:123], a[164:167], a[44:47], v[120:123]
    ds_read_b64_tr_b16 a[182:183], v31 offset:57344
    v_mfma_f32_16x16x32_bf16 v[124:127], a[164:167], a[48:51], v[124:127]
    buffer_load_dwordx4 v39, s[32:35], s57 offen lds
    s_add_u32 m0, s52, 17280
    v_mfma_f32_16x16x32_bf16 v[128:131], a[164:167], a[52:55], v[128:131]
    ds_read_b128 a[16:19], v44 offset:28672
    v_mfma_f32_16x16x32_bf16 v[132:135], a[164:167], a[56:59], v[132:135]
    v_xor_b32 v28, 0x10000, v28
    v_xor_b32 v29, 0x10000, v29
    v_xor_b32 v30, 0x10000, v30
    v_xor_b32 v31, 0x10000, v31
    ds_read_b64_tr_b16 a[184:185], v28 offset:0
    s_waitcnt lgkmcnt(9)
    v_mfma_f32_16x16x32_bf16 v[56:59], a[168:171], a[60:63], v[56:59]
    ds_read_b64_tr_b16 a[186:187], v28 offset:8192
    v_mfma_f32_16x16x32_bf16 v[60:63], a[168:171], a[64:67], v[60:63]
    buffer_load_dwordx4 v39, s[32:35], s57 offen offset:128 lds
    s_add_u32 m0, s52, 18176
    v_mfma_f32_16x16x32_bf16 v[64:67], a[168:171], a[68:71], v[64:67]
    ds_read_b128 a[20:23], v45 offset:20480
    v_mfma_f32_16x16x32_bf16 v[68:71], a[168:171], a[72:75], v[68:71]
    ds_read_b64_tr_b16 a[188:189], v29 offset:0
    v_mfma_f32_16x16x32_bf16 v[72:75], a[168:171], a[76:79], v[72:75]
    ds_read_b128 a[24:27], v45 offset:22528
    v_mfma_f32_16x16x32_bf16 v[76:79], a[172:175], a[60:63], v[76:79]
    buffer_load_dwordx4 v39, s[32:35], s57 offen offset:256 lds
    s_add_u32 m0, s52, 19072
    v_mfma_f32_16x16x32_bf16 v[80:83], a[172:175], a[64:67], v[80:83]
    ds_read_b64_tr_b16 a[190:191], v29 offset:8192
    v_mfma_f32_16x16x32_bf16 v[84:87], a[172:175], a[68:71], v[84:87]
    ds_read_b128 a[28:31], v45 offset:24576
    v_mfma_f32_16x16x32_bf16 v[88:91], a[172:175], a[72:75], v[88:91]
    buffer_load_dwordx4 v39, s[32:35], s57 offen offset:384 lds
    v_mfma_f32_16x16x32_bf16 v[92:95], a[172:175], a[76:79], v[92:95]
    ds_read_b64_tr_b16 a[192:193], v30 offset:0
    s_waitcnt lgkmcnt(9)
    v_mfma_f32_16x16x32_bf16 v[96:99], a[176:179], a[60:63], v[96:99]
    ds_read_b64_tr_b16 a[194:195], v30 offset:8192
    v_mfma_f32_16x16x32_bf16 v[100:103], a[176:179], a[64:67], v[100:103]
    ds_read_b128 a[32:35], v45 offset:26624
    v_mfma_f32_16x16x32_bf16 v[104:107], a[176:179], a[68:71], v[104:107]
    s_add_u32 m0, s53, 149504
    s_lshl_b32 s56, s44, 7
    s_add_u32 s57, s56, 28672
    s_add_u32 s58, s56, 57344
    s_add_u32 s44, s44, 1
    s_cmp_eq_u32 s44, 7
    s_cselect_b32 s44, 0, s44
    s_cmp_lg_u32 s63, 0
    s_cbranch_scc1 L_x3_4
    buffer_load_dwordx4 v40, s[20:23], s58 offen lds
L_x3_4:
    s_add_u32 m0, s53, 141312
    v_mfma_f32_16x16x32_bf16 v[108:111], a[176:179], a[72:75], v[108:111]
    ds_read_b64_tr_b16 a[196:197], v31 offset:0
    v_mfma_f32_16x16x32_bf16 v[112:115], a[176:179], a[76:79], v[112:115]
    ds_read_b128 a[36:39], v45 offset:28672
    v_mfma_f32_16x16x32_bf16 v[116:119], a[180:183], a[60:63], v[116:119]
    ds_read_b64_tr_b16 a[198:199], v31 offset:8192
    v_mfma_f32_16x16x32_bf16 v[120:123], a[180:183], a[64:67], v[120:123]
    buffer_load_dwordx4 v40, s[20:23], s56 offen lds
    s_add_u32 m0, s53, 145408
    v_mfma_f32_16x16x32_bf16 v[124:127], a[180:183], a[68:71], v[124:127]
    buffer_load_dwordx4 v40, s[20:23], s57 offen lds
    v_mfma_f32_16x16x32_bf16 v[128:131], a[180:183], a[72:75], v[128:131]
    v_mfma_f32_16x16x32_bf16 v[132:135], a[180:183], a[76:79], v[132:135]
    s_waitcnt lgkmcnt(1)
    s_waitcnt vmcnt(10)
    s_barrier
    v_mfma_f32_16x16x32_bf16 v[56:59], a[184:187], a[0:3], v[56:59]
    v_mfma_f32_16x16x32_bf16 v[60:63], a[184:187], a[4:7], v[60:63]
    ds_read_b64_tr_b16 a[160:161], v28 offset:16384
    v_mfma_f32_16x16x32_bf16 v[64:67], a[184:187], a[8:11], v[64:67]
    ds_read_b64_tr_b16 a[162:163], v28 offset:24576
    v_mfma_f32_16x16x32_bf16 v[68:71], a[184:187], a[12:15], v[68:71]
    s_add_u32 m0, s52, 32768
    s_lshl_b32 s56, s60, 19
    s_add_u32 s57, s56, 262144
    s_add_u32 s60, s60, 1
    s_cmp_eq_u32 s60, 7
    s_cselect_b32 s60, 0, s60
    buffer_load_dwordx4 v39, s[32:35], s56 offen lds
    s_add_u32 m0, s52, 33664
    v_mfma_f32_16x16x32_bf16 v[72:75], a[184:187], a[16:19], v[72:75]
    ds_read_b128 a[40:43], v44 offset:0
    v_mfma_f32_16x16x32_bf16 v[76:79], a[188:191], a[0:3], v[76:79]
    ds_read_b64_tr_b16 a[164:165], v29 offset:16384
    v_mfma_f32_16x16x32_bf16 v[80:83], a[188:191], a[4:7], v[80:83]
    ds_read_b64_tr_b16 a[166:167], v29 offset:24576
    v_mfma_f32_16x16x32_bf16 v[84:87], a[188:191], a[8:11], v[84:87]
    buffer_load_dwordx4 v39, s[32:35], s56 offen offset:128 lds
    s_add_u32 m0, s52, 34560
    v_mfma_f32_16x16x32_bf16 v[88:91], a[188:191], a[12:15], v[88:91]
    ds_read_b128 a[44:47], v44 offset:2048
    v_mfma_f32_16x16x32_bf16 v[92:95], a[188:191], a[16:19], v[92:95]
    ds_read_b64_tr_b16 a[168:169], v30 offset:16384
    s_waitcnt lgkmcnt(7)
    v_mfma_f32_16x16x32_bf16 v[96:99], a[192:195], a[0:3], v[96:99]
    buffer_load_dwordx4 v39, s[32:35], s56 offen offset:256 lds
    s_add_u32 m0, s52, 35456
    v_mfma_f32_16x16x32_bf16 v[100:103], a[192:195], a[4:7], v[100:103]
    ds_read_b64_tr_b16 a[170:171], v30 offset:24576
    v_mfma_f32_16x16x32_bf16 v[104:107], a[192:195], a[8:11], v[104:107]
    ds_read_b128 a[48:51], v44 offset:4096
    v_mfma_f32_16x16x32_bf16 v[108:111], a[192:195], a[12:15], v[108:111]
    buffer_load_dwordx4 v39, s[32:35], s56 offen offset:384 lds
    s_add_u32 m0, s52, 49152
    v_mfma_f32_16x16x32_bf16 v[112:115], a[192:195], a[16:19], v[112:115]
    ds_read_b128 a[52:55], v44 offset:6144
    v_mfma_f32_16x16x32_bf16 v[116:119], a[196:199], a[0:3], v[116:119]
    ds_read_b64_tr_b16 a[172:173], v31 offset:16384
    v_mfma_f32_16x16x32_bf16 v[120:123], a[196:199], a[4:7], v[120:123]
    ds_read_b64_tr_b16 a[174:175], v31 offset:24576
    v_mfma_f32_16x16x32_bf16 v[124:127], a[196:199], a[8:11], v[124:127]
    buffer_load_dwordx4 v39, s[32:35], s57 offen lds
    s_add_u32 m0, s52, 50048
    v_mfma_f32_16x16x32_bf16 v[128:131], a[196:199], a[12:15], v[128:131]
    ds_read_b128 a[56:59], v44 offset:8192
    v_mfma_f32_16x16x32_bf16 v[132:135], a[196:199], a[16:19], v[132:135]
    ds_read_b64_tr_b16 a[176:177], v28 offset:32768
    s_waitcnt lgkmcnt(9)
    v_mfma_f32_16x16x32_bf16 v[56:59], a[160:163], a[20:23], v[56:59]
    ds_read_b64_tr_b16 a[178:179], v28 offset:40960
    v_mfma_f32_16x16x32_bf16 v[60:63], a[160:163], a[24:27], v[60:63]
    buffer_load_dwordx4 v39, s[32:35], s57 offen offset:128 lds
    s_add_u32 m0, s52, 50944
    v_mfma_f32_16x16x32_bf16 v[64:67], a[160:163], a[28:31], v[64:67]
    ds_read_b128 a[60:63], v45 offset:0
    v_mfma_f32_16x16x32_bf16 v[68:71], a[160:163], a[32:35], v[68:71]
    ds_read_b64_tr_b16 a[180:181], v29 offset:32768
    v_mfma_f32_16x16x32_bf16 v[72:75], a[160:163], a[36:39], v[72:75]
    ds_read_b128 a[64:67], v45 offset:2048
    v_mfma_f32_16x16x32_bf16 v[76:79], a[164:167], a[20:23], v[76:79]
    buffer_load_dwordx4 v39, s[32:35], s57 offen offset:256 lds
    s_add_u32 m0, s52, 51840
    v_mfma_f32_16x16x32_bf16 v[80:83], a[164:167], a[24:27], v[80:83]
    ds_read_b64_tr_b16 a[182:183], v29 offset:40960
    v_mfma_f32_16x16x32_bf16 v[84:87], a[164:167], a[28:31], v[84:87]
    ds_read_b128 a[68:71], v45 offset:4096
    v_mfma_f32_16x16x32_bf16 v[88:91], a[164:167], a[32:35], v[88:91]
    buffer_load_dwordx4 v39, s[32:35], s57 offen offset:384 lds
    v_mfma_f32_16x16x32_bf16 v[92:95], a[164:167], a[36:39], v[92:95]
    ds_read_b64_tr_b16 a[184:185], v30 offset:32768
    s_waitcnt lgkmcnt(9)
    v_mfma_f32_16x16x32_bf16 v[96:99], a[168:171], a[20:23], v[96:99]
    ds_read_b64_tr_b16 a[186:187], v30 offset:40960
    v_mfma_f32_16x16x32_bf16 v[100:103], a[168:171], a[24:27], v[100:103]
    ds_read_b128 a[72:75], v45 offset:6144
    v_mfma_f32_16x16x32_bf16 v[104:107], a[168:171], a[28:31], v[104:107]
    s_add_u32 m0, s53, 159744
    s_lshl_b32 s56, s44, 7
    s_add_u32 s57, s56, 28672
    s_add_u32 s58, s56, 57344
    s_add_u32 s44, s44, 1
    s_cmp_eq_u32 s44, 7
    s_cselect_b32 s44, 0, s44
    s_cmp_lg_u32 s63, 0
    s_cbranch_scc1 L_x3_5
    buffer_load_dwordx4 v40, s[20:23], s58 offen lds
L_x3_5:
    s_add_u32 m0, s53, 151552
    v_mfma_f32_16x16x32_bf16 v[108:111], a[168:171], a[32:35], v[108:111]
    ds_read_b64_tr_b16 a[188:189], v31 offset:32768
    v_mfma_f32_16x16x32_bf16 v[112:115], a[168:171], a[36:39], v[112:115]
    ds_read_b128 a[76:79], v45 offset:8192
    v_mfma_f32_16x16x32_bf16 v[116:119], a[172:175], a[20:23], v[116:119]
    ds_read_b64_tr_b16 a[190:191], v31 offset:40960
    v_mfma_f32_16x16x32_bf16 v[120:123], a[172:175], a[24:27], v[120:123]
    buffer_load_dwordx4 v40, s[20:23], s56 offen lds
    s_add_u32 m0, s53, 155648
    v_mfma_f32_16x16x32_bf16 v[124:127], a[172:175], a[28:31], v[124:127]
    buffer_load_dwordx4 v40, s[20:23], s57 offen lds
    v_mfma_f32_16x16x32_bf16 v[128:131], a[172:175], a[32:35], v[128:131]
    v_mfma_f32_16x16x32_bf16 v[132:135], a[172:175], a[36:39], v[132:135]
    s_waitcnt lgkmcnt(1)
    s_waitcnt vmcnt(10)
    s_barrier
    v_mfma_f32_16x16x32_bf16 v[56:59], a[176:179], a[40:43], v[56:59]
    v_mfma_f32_16x16x32_bf16 v[60:63], a[176:179], a[44:47], v[60:63]
    ds_read_b64_tr_b16 a[192:193], v28 offset:49152
    v_mfma_f32_16x16x32_bf16 v[64:67], a[176:179], a[48:51], v[64:67]
    ds_read_b64_tr_b16 a[194:195], v28 offset:57344
    v_mfma_f32_16x16x32_bf16 v[68:71], a[176:179], a[52:55], v[68:71]
    s_add_u32 m0, s52, 65536
    s_lshl_b32 s56, s60, 19
    s_add_u32 s57, s56, 262144
    s_add_u32 s60, s60, 1
    s_cmp_eq_u32 s60, 7
    s_cselect_b32 s60, 0, s60
    buffer_load_dwordx4 v39, s[32:35], s56 offen lds
    s_add_u32 m0, s52, 66432
    v_mfma_f32_16x16x32_bf16 v[72:75], a[176:179], a[56:59], v[72:75]
    ds_read_b128 a[0:3], v44 offset:10240
    v_mfma_f32_16x16x32_bf16 v[76:79], a[180:183], a[40:43], v[76:79]
    ds_read_b64_tr_b16 a[196:197], v29 offset:49152
    v_mfma_f32_16x16x32_bf16 v[80:83], a[180:183], a[44:47], v[80:83]
    ds_read_b64_tr_b16 a[198:199], v29 offset:57344
    v_mfma_f32_16x16x32_bf16 v[84:87], a[180:183], a[48:51], v[84:87]
    buffer_load_dwordx4 v39, s[32:35], s56 offen offset:128 lds
    s_add_u32 m0, s52, 67328
    v_mfma_f32_16x16x32_bf16 v[88:91], a[180:183], a[52:55], v[88:91]
    ds_read_b128 a[4:7], v44 offset:12288
    v_mfma_f32_16x16x32_bf16 v[92:95], a[180:183], a[56:59], v[92:95]
    ds_read_b64_tr_b16 a[160:161], v30 offset:49152
    s_waitcnt lgkmcnt(7)
    v_mfma_f32_16x16x32_bf16 v[96:99], a[184:187], a[40:43], v[96:99]
    buffer_load_dwordx4 v39, s[32:35], s56 offen offset:256 lds
    s_add_u32 m0, s52, 68224
    v_mfma_f32_16x16x32_bf16 v[100:103], a[184:187], a[44:47], v[100:103]
    ds_read_b64_tr_b16 a[162:163], v30 offset:57344
    v_mfma_f32_16x16x32_bf16 v[104:107], a[184:187], a[48:51], v[104:107]
    ds_read_b128 a[8:11], v44 offset:14336
    v_mfma_f32_16x16x32_bf16 v[108:111], a[184:187], a[52:55], v[108:111]
    buffer_load_dwordx4 v39, s[32:35], s56 offen offset:384 lds
    s_add_u32 m0, s52, 81920
    v_mfma_f32_16x16x32_bf16 v[112:115], a[184:187], a[56:59], v[112:115]
    ds_read_b128 a[12:15], v44 offset:16384
    v_mfma_f32_16x16x32_bf16 v[116:119], a[188:191], a[40:43], v[116:119]
    ds_read_b64_tr_b16 a[164:165], v31 offset:49152
    v_mfma_f32_16x16x32_bf16 v[120:123], a[188:191], a[44:47], v[120:123]
    ds_read_b64_tr_b16 a[166:167], v31 offset:57344
    v_mfma_f32_16x16x32_bf16 v[124:127], a[188:191], a[48:51], v[124:127]
    buffer_load_dwordx4 v39, s[32:35], s57 offen lds
    s_add_u32 m0, s52, 82816
    v_mfma_f32_16x16x32_bf16 v[128:131], a[188:191], a[52:55], v[128:131]
    ds_read_b128 a[16:19], v44 offset:18432
    v_mfma_f32_16x16x32_bf16 v[132:135], a[188:191], a[56:59], v[132:135]
    v_xor_b32 v28, 0x10000, v28
    v_xor_b32 v29, 0x10000, v29
    v_xor_b32 v30, 0x10000, v30
    v_xor_b32 v31, 0x10000, v31
    ds_read_b64_tr_b16 a[168:169], v28 offset:0
    s_waitcnt lgkmcnt(9)
    v_mfma_f32_16x16x32_bf16 v[56:59], a[192:195], a[60:63], v[56:59]
    ds_read_b64_tr_b16 a[170:171], v28 offset:8192
    v_mfma_f32_16x16x32_bf16 v[60:63], a[192:195], a[64:67], v[60:63]
    buffer_load_dwordx4 v39, s[32:35], s57 offen offset:128 lds
    s_add_u32 m0, s52, 83712
    v_mfma_f32_16x16x32_bf16 v[64:67], a[192:195], a[68:71], v[64:67]
    ds_read_b128 a[20:23], v45 offset:10240
    v_mfma_f32_16x16x32_bf16 v[68:71], a[192:195], a[72:75], v[68:71]
    ds_read_b64_tr_b16 a[172:173], v29 offset:0
    v_mfma_f32_16x16x32_bf16 v[72:75], a[192:195], a[76:79], v[72:75]
    ds_read_b128 a[24:27], v45 offset:12288
    v_mfma_f32_16x16x32_bf16 v[76:79], a[196:199], a[60:63], v[76:79]
    buffer_load_dwordx4 v39, s[32:35], s57 offen offset:256 lds
    s_add_u32 m0, s52, 84608
    v_mfma_f32_16x16x32_bf16 v[80:83], a[196:199], a[64:67], v[80:83]
    ds_read_b64_tr_b16 a[174:175], v29 offset:8192
    v_mfma_f32_16x16x32_bf16 v[84:87], a[196:199], a[68:71], v[84:87]
    ds_read_b128 a[28:31], v45 offset:14336
    v_mfma_f32_16x16x32_bf16 v[88:91], a[196:199], a[72:75], v[88:91]
    buffer_load_dwordx4 v39, s[32:35], s57 offen offset:384 lds
    v_mfma_f32_16x16x32_bf16 v[92:95], a[196:199], a[76:79], v[92:95]
    ds_read_b64_tr_b16 a[176:177], v30 offset:0
    s_waitcnt lgkmcnt(9)
    v_mfma_f32_16x16x32_bf16 v[96:99], a[160:163], a[60:63], v[96:99]
    ds_read_b64_tr_b16 a[178:179], v30 offset:8192
    v_mfma_f32_16x16x32_bf16 v[100:103], a[160:163], a[64:67], v[100:103]
    ds_read_b128 a[32:35], v45 offset:16384
    v_mfma_f32_16x16x32_bf16 v[104:107], a[160:163], a[68:71], v[104:107]
    s_add_u32 m0, s53, 139264
    s_lshl_b32 s56, s44, 7
    s_add_u32 s57, s56, 28672
    s_add_u32 s58, s56, 57344
    s_add_u32 s44, s44, 1
    s_cmp_eq_u32 s44, 7
    s_cselect_b32 s44, 0, s44
    s_cmp_lg_u32 s63, 0
    s_cbranch_scc1 L_x3_6
    buffer_load_dwordx4 v40, s[20:23], s58 offen lds
L_x3_6:
    s_add_u32 m0, s53, 131072
    v_mfma_f32_16x16x32_bf16 v[108:111], a[160:163], a[72:75], v[108:111]
    ds_read_b64_tr_b16 a[180:181], v31 offset:0
    v_mfma_f32_16x16x32_bf16 v[112:115], a[160:163], a[76:79], v[112:115]
    ds_read_b128 a[36:39], v45 offset:18432
    v_mfma_f32_16x16x32_bf16 v[116:119], a[164:167], a[60:63], v[116:119]
    ds_read_b64_tr_b16 a[182:183], v31 offset:8192
    v_mfma_f32_16x16x32_bf16 v[120:123], a[164:167], a[64:67], v[120:123]
    buffer_load_dwordx4 v40, s[20:23], s56 offen lds
    s_add_u32 m0, s53, 135168
    v_mfma_f32_16x16x32_bf16 v[124:127], a[164:167], a[68:71], v[124:127]
    buffer_load_dwordx4 v40, s[20:23], s57 offen lds
    v_mfma_f32_16x16x32_bf16 v[128:131], a[164:167], a[72:75], v[128:131]
    v_mfma_f32_16x16x32_bf16 v[132:135], a[164:167], a[76:79], v[132:135]
    s_waitcnt lgkmcnt(1)
    s_waitcnt vmcnt(10)
    s_barrier
    v_mfma_f32_16x16x32_bf16 v[56:59], a[168:171], a[0:3], v[56:59]
    v_mfma_f32_16x16x32_bf16 v[60:63], a[168:171], a[4:7], v[60:63]
    ds_read_b64_tr_b16 a[184:185], v28 offset:16384
    v_mfma_f32_16x16x32_bf16 v[64:67], a[168:171], a[8:11], v[64:67]
    ds_read_b64_tr_b16 a[186:187], v28 offset:24576
    v_mfma_f32_16x16x32_bf16 v[68:71], a[168:171], a[12:15], v[68:71]
    s_add_u32 m0, s52, 98304
    s_nop 0
    buffer_load_dwordx4 v41, s[24:27], s64 offen lds
    s_add_u32 m0, s52, 99200
    v_mfma_f32_16x16x32_bf16 v[72:75], a[168:171], a[16:19], v[72:75]
    ds_read_b128 a[40:43], v44 offset:20480
    v_mfma_f32_16x16x32_bf16 v[76:79], a[172:175], a[0:3], v[76:79]
    ds_read_b64_tr_b16 a[188:189], v29 offset:16384
    v_mfma_f32_16x16x32_bf16 v[80:83], a[172:175], a[4:7], v[80:83]
    ds_read_b64_tr_b16 a[190:191], v29 offset:24576
    v_mfma_f32_16x16x32_bf16 v[84:87], a[172:175], a[8:11], v[84:87]
    ds_read_b128 a[44:47], v44 offset:22528
    v_mfma_f32_16x16x32_bf16 v[88:91], a[172:175], a[12:15], v[88:91]
    buffer_load_dwordx4 v41, s[24:27], s64 offen offset:128 lds
    s_add_u32 m0, s52, 114688
    v_mfma_f32_16x16x32_bf16 v[92:95], a[172:175], a[16:19], v[92:95]
    ds_read_b64_tr_b16 a[192:193], v30 offset:16384
    s_waitcnt lgkmcnt(7)
    v_mfma_f32_16x16x32_bf16 v[96:99], a[176:179], a[0:3], v[96:99]
    ds_read_b64_tr_b16 a[194:195], v30 offset:24576
    v_mfma_f32_16x16x32_bf16 v[100:103], a[176:179], a[4:7], v[100:103]
    ds_read_b128 a[48:51], v44 offset:24576
    v_mfma_f32_16x16x32_bf16 v[104:107], a[176:179], a[8:11], v[104:107]
    s_add_u32 s57, s64, 16384
    buffer_load_dwordx4 v41, s[24:27], s57 offen lds
    s_add_u32 m0, s52, 115584
    v_mfma_f32_16x16x32_bf16 v[108:111], a[176:179], a[12:15], v[108:111]
    ds_read_b128 a[52:55], v44 offset:26624
    v_mfma_f32_16x16x32_bf16 v[112:115], a[176:179], a[16:19], v[112:115]
    ds_read_b64_tr_b16 a[196:197], v31 offset:16384
    v_mfma_f32_16x16x32_bf16 v[116:119], a[180:183], a[0:3], v[116:119]
    ds_read_b64_tr_b16 a[198:199], v31 offset:24576
    v_mfma_f32_16x16x32_bf16 v[120:123], a[180:183], a[4:7], v[120:123]
    ds_read_b128 a[56:59], v44 offset:28672
    v_mfma_f32_16x16x32_bf16 v[124:127], a[180:183], a[8:11], v[124:127]
    buffer_load_dwordx4 v41, s[24:27], s57 offen offset:128 lds
    s_add_u32 m0, s52, 100096
    v_mfma_f32_16x16x32_bf16 v[128:131], a[180:183], a[12:15], v[128:131]
    ds_read_b64_tr_b16 a[160:161], v28 offset:32768
    v_mfma_f32_16x16x32_bf16 v[132:135], a[180:183], a[16:19], v[132:135]
    ds_read_b64_tr_b16 a[162:163], v28 offset:40960
    s_waitcnt lgkmcnt(10)
    v_mfma_f32_16x16x32_bf16 v[56:59], a[184:187], a[20:23], v[56:59]
    ds_read_b128 a[60:63], v45 offset:20480
    v_mfma_f32_16x16x32_bf16 v[60:63], a[184:187], a[24:27], v[60:63]
    buffer_load_dwordx4 v41, s[24:27], s64 offen offset:256 lds
    s_add_u32 m0, s52, 100992
    v_mfma_f32_16x16x32_bf16 v[64:67], a[184:187], a[28:31], v[64:67]
    ds_read_b64_tr_b16 a[164:165], v29 offset:32768
    v_mfma_f32_16x16x32_bf16 v[68:71], a[184:187], a[32:35], v[68:71]
    ds_read_b128 a[64:67], v45 offset:22528
    v_mfma_f32_16x16x32_bf16 v[72:75], a[184:187], a[36:39], v[72:75]
    ds_read_b64_tr_b16 a[166:167], v29 offset:40960
    v_mfma_f32_16x16x32_bf16 v[76:79], a[188:191], a[20:23], v[76:79]
    ds_read_b128 a[68:71], v45 offset:24576
    v_mfma_f32_16x16x32_bf16 v[80:83], a[188:191], a[24:27], v[80:83]
    buffer_load_dwordx4 v41, s[24:27], s64 offen offset:384 lds
    s_add_u32 m0, s52, 116480
    v_mfma_f32_16x16x32_bf16 v[84:87], a[188:191], a[28:31], v[84:87]
    ds_read_b64_tr_b16 a[168:169], v30 offset:32768
    v_mfma_f32_16x16x32_bf16 v[88:91], a[188:191], a[32:35], v[88:91]
    ds_read_b64_tr_b16 a[170:171], v30 offset:40960
    v_mfma_f32_16x16x32_bf16 v[92:95], a[188:191], a[36:39], v[92:95]
    ds_read_b128 a[72:75], v45 offset:26624
    s_waitcnt lgkmcnt(11)
    v_mfma_f32_16x16x32_bf16 v[96:99], a[192:195], a[20:23], v[96:99]
    buffer_load_dwordx4 v41, s[24:27], s57 offen offset:256 lds
    s_add_u32 m0, s52, 117376
    v_mfma_f32_16x16x32_bf16 v[100:103], a[192:195], a[24:27], v[100:103]
    ds_read_b64_tr_b16 a[172:173], v31 offset:32768
    v_mfma_f32_16x16x32_bf16 v[104:107], a[192:195], a[28:31], v[104:107]
    ds_read_b128 a[76:79], v45 offset:28672
    v_mfma_f32_16x16x32_bf16 v[108:111], a[192:195], a[32:35], v[108:111]
    ds_read_b64_tr_b16 a[174:175], v31 offset:40960
    v_mfma_f32_16x16x32_bf16 v[112:115], a[192:195], a[36:39], v[112:115]
    v_mfma_f32_16x16x32_bf16 v[116:119], a[196:199], a[20:23], v[116:119]
    buffer_load_dwordx4 v41, s[24:27], s57 offen offset:384 lds
    v_mfma_f32_16x16x32_bf16 v[120:123], a[196:199], a[24:27], v[120:123]
    v_mfma_f32_16x16x32_bf16 v[124:127], a[196:199], a[28:31], v[124:127]
    v_mfma_f32_16x16x32_bf16 v[128:131], a[196:199], a[32:35], v[128:131]
    v_mfma_f32_16x16x32_bf16 v[132:135], a[196:199], a[36:39], v[132:135]
    s_waitcnt lgkmcnt(1)
    s_waitcnt vmcnt(8)
    s_barrier
    v_mfma_f32_16x16x32_bf16 v[56:59], a[160:163], a[40:43], v[56:59]
    v_mfma_f32_16x16x32_bf16 v[60:63], a[160:163], a[44:47], v[60:63]
    ds_read_b64_tr_b16 a[176:177], v28 offset:49152
    v_mfma_f32_16x16x32_bf16 v[64:67], a[160:163], a[48:51], v[64:67]
    ds_read_b64_tr_b16 a[178:179], v28 offset:57344
    v_mfma_f32_16x16x32_bf16 v[68:71], a[160:163], a[52:55], v[68:71]
    s_add_u32 m0, s52, 0
    s_nop 0
    buffer_load_dwordx4 v41, s[24:27], s65 offen lds
    s_add_u32 m0, s52, 896
    v_mfma_f32_16x16x32_bf16 v[72:75], a[160:163], a[56:59], v[72:75]
    ds_read_b128 a[0:3], v44 offset:0
    v_mfma_f32_16x16x32_bf16 v[76:79], a[164:167], a[40:43], v[76:79]
    ds_read_b64_tr_b16 a[180:181], v29 offset:49152
    v_mfma_f32_16x16x32_bf16 v[80:83], a[164:167], a[44:47], v[80:83]
    ds_read_b64_tr_b16 a[182:183], v29 offset:57344
    v_mfma_f32_16x16x32_bf16 v[84:87], a[164:167], a[48:51], v[84:87]
    ds_read_b128 a[4:7], v44 offset:2048
    v_mfma_f32_16x16x32_bf16 v[88:91], a[164:167], a[52:55], v[88:91]
    buffer_load_dwordx4 v41, s[24:27], s65 offen offset:128 lds
    s_add_u32 m0, s52, 16384
    v_mfma_f32_16x16x32_bf16 v[92:95], a[164:167], a[56:59], v[92:95]
    ds_read_b64_tr_b16 a[184:185], v30 offset:49152
    s_waitcnt lgkmcnt(7)
    v_mfma_f32_16x16x32_bf16 v[96:99], a[168:171], a[40:43], v[96:99]
    ds_read_b64_tr_b16 a[186:187], v30 offset:57344
    v_mfma_f32_16x16x32_bf16 v[100:103], a[168:171], a[44:47], v[100:103]
    ds_read_b128 a[8:11], v44 offset:4096
    v_mfma_f32_16x16x32_bf16 v[104:107], a[168:171], a[48:51], v[104:107]
    s_add_u32 s57, s65, 16384
    buffer_load_dwordx4 v41, s[24:27], s57 offen lds
    s_add_u32 m0, s52, 17280
    v_mfma_f32_16x16x32_bf16 v[108:111], a[168:171], a[52:55], v[108:111]
    ds_read_b128 a[12:15], v44 offset:6144
    v_mfma_f32_16x16x32_bf16 v[112:115], a[168:171], a[56:59], v[112:115]
    ds_read_b64_tr_b16 a[188:189], v31 offset:49152
    v_mfma_f32_16x16x32_bf16 v[116:119], a[172:175], a[40:43], v[116:119]
    ds_read_b64_tr_b16 a[190:191], v31 offset:57344
    v_mfma_f32_16x16x32_bf16 v[120:123], a[172:175], a[44:47], v[120:123]
    ds_read_b128 a[16:19], v44 offset:8192
    v_mfma_f32_16x16x32_bf16 v[124:127], a[172:175], a[48:51], v[124:127]
    buffer_load_dwordx4 v41, s[24:27], s57 offen offset:128 lds
    s_add_u32 m0, s52, 1792
    v_mfma_f32_16x16x32_bf16 v[128:131], a[172:175], a[52:55], v[128:131]
    v_xor_b32 v28, 0x10000, v28
    v_xor_b32 v29, 0x10000, v29
    v_xor_b32 v30, 0x10000, v30
    v_xor_b32 v31, 0x10000, v31
    ds_read_b64_tr_b16 a[192:193], v28 offset:0
    v_mfma_f32_16x16x32_bf16 v[132:135], a[172:175], a[56:59], v[132:135]
    ds_read_b64_tr_b16 a[194:195], v28 offset:8192
    s_waitcnt lgkmcnt(10)
    v_mfma_f32_16x16x32_bf16 v[56:59], a[176:179], a[60:63], v[56:59]
    ds_read_b128 a[20:23], v45 offset:0
    v_mfma_f32_16x16x32_bf16 v[60:63], a[176:179], a[64:67], v[60:63]
    buffer_load_dwordx4 v41, s[24:27], s65 offen offset:256 lds
    s_add_u32 m0, s52, 2688
    v_mfma_f32_16x16x32_bf16 v[64:67], a[176:179], a[68:71], v[64:67]
    ds_read_b64_tr_b16 a[196:197], v28 offset:16384
    v_mfma_f32_16x16x32_bf16 v[68:71], a[176:179], a[72:75], v[68:71]
    ds_read_b128 a[24:27], v45 offset:2048
    v_mfma_f32_16x16x32_bf16 v[72:75], a[176:179], a[76:79], v[72:75]
    ds_read_b64_tr_b16 a[198:199], v28 offset:24576
    v_mfma_f32_16x16x32_bf16 v[76:79], a[180:183], a[60:63], v[76:79]
    ds_read_b128 a[28:31], v45 offset:4096
    v_mfma_f32_16x16x32_bf16 v[80:83], a[180:183], a[64:67], v[80:83]
    buffer_load_dwordx4 v41, s[24:27], s65 offen offset:384 lds
    s_add_u32 m0, s52, 18176
    v_mfma_f32_16x16x32_bf16 v[84:87], a[180:183], a[68:71], v[84:87]
    ds_read_b64_tr_b16 a[160:161], v29 offset:0
    v_mfma_f32_16x16x32_bf16 v[88:91], a[180:183], a[72:75], v[88:91]
    ds_read_b64_tr_b16 a[162:163], v29 offset:8192
    v_mfma_f32_16x16x32_bf16 v[92:95], a[180:183], a[76:79], v[92:95]
    ds_read_b128 a[32:35], v45 offset:6144
    s_waitcnt lgkmcnt(11)
    v_mfma_f32_16x16x32_bf16 v[96:99], a[184:187], a[60:63], v[96:99]
    buffer_load_dwordx4 v41, s[24:27], s57 offen offset:256 lds
    s_add_u32 m0, s52, 19072
    v_mfma_f32_16x16x32_bf16 v[100:103], a[184:187], a[64:67], v[100:103]
    ds_read_b64_tr_b16 a[164:165], v29 offset:16384
    v_mfma_f32_16x16x32_bf16 v[104:107], a[184:187], a[68:71], v[104:107]
    ds_read_b128 a[36:39], v45 offset:8192
    v_mfma_f32_16x16x32_bf16 v[108:111], a[184:187], a[72:75], v[108:111]
    ds_read_b64_tr_b16 a[166:167], v29 offset:24576
    v_mfma_f32_16x16x32_bf16 v[112:115], a[184:187], a[76:79], v[112:115]
    v_mfma_f32_16x16x32_bf16 v[116:119], a[188:191], a[60:63], v[116:119]
    buffer_load_dwordx4 v41, s[24:27], s57 offen offset:384 lds
    v_mfma_f32_16x16x32_bf16 v[120:123], a[188:191], a[64:67], v[120:123]
    v_mfma_f32_16x16x32_bf16 v[124:127], a[188:191], a[68:71], v[124:127]
    v_mfma_f32_16x16x32_bf16 v[128:131], a[188:191], a[72:75], v[128:131]
    v_mfma_f32_16x16x32_bf16 v[132:135], a[188:191], a[76:79], v[132:135]
    s_waitcnt lgkmcnt(1)
    s_waitcnt vmcnt(12)
    s_barrier
    v_mfma_f32_16x16x32_bf16 v[56:59], a[192:195], a[0:3], v[56:59]
    ds_read_b64_tr_b16 a[168:169], v30 offset:0
    v_lshrrev_b32 v6, 5, v0
    v_lshlrev_b32 v6, 8, v6
    v_and_b32 v7, 15, v0
    v_lshl_add_u32 v6, v7, 4, v6
    v_bfe_u32 v7, v0, 4, 1
    v_lshl_add_u32 v6, v7, 3, v6
    s_add_u32 s59, s53, 131072
    v_add_u32 v6, s59, v6
    v_subrev_u32 v7, 49152, v6
    v_mfma_f32_16x16x32_bf16 v[60:63], a[192:195], a[4:7], v[60:63]
    ds_read_b64_tr_b16 a[170:171], v30 offset:8192
    v_mfma_f32_16x16x32_bf16 v[64:67], a[192:195], a[8:11], v[64:67]
    v_mfma_f32_16x16x32_bf16 v[68:71], a[192:195], a[12:15], v[68:71]
    v_mfma_f32_16x16x32_bf16 v[72:75], a[192:195], a[16:19], v[72:75]
    ds_read_b64_tr_b16 a[172:173], v30 offset:16384
    v_mfma_f32_16x16x32_bf16 v[56:59], a[196:199], a[20:23], v[56:59]
    ds_read_b64_tr_b16 a[174:175], v30 offset:24576
    v_mfma_f32_16x16x32_bf16 v[60:63], a[196:199], a[24:27], v[60:63]
    v_mfma_f32_16x16x32_bf16 v[64:67], a[196:199], a[28:31], v[64:67]
    v_mfma_f32_16x16x32_bf16 v[68:71], a[196:199], a[32:35], v[68:71]
    ds_read_b64_tr_b16 a[176:177], v31 offset:0
    v_mfma_f32_16x16x32_bf16 v[72:75], a[196:199], a[36:39], v[72:75]
    ds_read_b64_tr_b16 a[178:179], v31 offset:8192
    s_waitcnt lgkmcnt(6)
    v_mfma_f32_16x16x32_bf16 v[76:79], a[160:163], a[0:3], v[76:79]
    v_mfma_f32_16x16x32_bf16 v[80:83], a[160:163], a[4:7], v[80:83]
    v_mfma_f32_16x16x32_bf16 v[84:87], a[160:163], a[8:11], v[84:87]
    v_pk_mul_f32 v[56:57], v[56:57], s[92:93]
    v_pk_mul_f32 v[58:59], v[58:59], s[92:93]
    v_cvt_pk_bf16_f32 v56, v56, v57
    v_cvt_pk_bf16_f32 v57, v58, v59
    ds_write_b64 v6, v[56:57] offset:0
    ds_read_b64_tr_b16 a[180:181], v31 offset:16384
    v_mfma_f32_16x16x32_bf16 v[88:91], a[160:163], a[12:15], v[88:91]
    v_pk_mul_f32 v[60:61], v[60:61], s[92:93]
    v_pk_mul_f32 v[62:63], v[62:63], s[92:93]
    v_cvt_pk_bf16_f32 v60, v60, v61
    v_cvt_pk_bf16_f32 v61, v62, v63
    ds_write_b64 v6, v[60:61] offset:4096
    ds_read_b64_tr_b16 a[182:183], v31 offset:24576
    v_mfma_f32_16x16x32_bf16 v[92:95], a[160:163], a[16:19], v[92:95]
    v_pk_mul_f32 v[64:65], v[64:65], s[92:93]
    v_pk_mul_f32 v[66:67], v[66:67], s[92:93]
    v_cvt_pk_bf16_f32 v64, v64, v65
    v_cvt_pk_bf16_f32 v65, v66, v67
    ds_write_b64 v6, v[64:65] offset:8192
    v_mfma_f32_16x16x32_bf16 v[76:79], a[164:167], a[20:23], v[76:79]
    v_pk_mul_f32 v[68:69], v[68:69], s[92:93]
    v_pk_mul_f32 v[70:71], v[70:71], s[92:93]
    v_cvt_pk_bf16_f32 v68, v68, v69
    v_cvt_pk_bf16_f32 v69, v70, v71
    ds_write_b64 v6, v[68:69] offset:12288
    v_mfma_f32_16x16x32_bf16 v[80:83], a[164:167], a[24:27], v[80:83]
    v_pk_mul_f32 v[72:73], v[72:73], s[92:93]
    v_pk_mul_f32 v[74:75], v[74:75], s[92:93]
    v_cvt_pk_bf16_f32 v72, v72, v73
    v_cvt_pk_bf16_f32 v73, v74, v75
    ds_write_b64 v6, v[72:73] offset:16384
    v_mfma_f32_16x16x32_bf16 v[84:87], a[164:167], a[28:31], v[84:87]
    v_xor_b32 v32, 0x10000, v32
    v_xor_b32 v33, 0x10000, v33
    ds_read_b128 a[184:187], v32 offset:32768
    v_mfma_f32_16x16x32_bf16 v[88:91], a[164:167], a[32:35], v[88:91]
    v_mfma_f32_16x16x32_bf16 v[92:95], a[164:167], a[36:39], v[92:95]
    s_waitcnt lgkmcnt(10)
    v_mfma_f32_16x16x32_bf16 v[96:99], a[168:171], a[0:3], v[96:99]
    v_mfma_f32_16x16x32_bf16 v[100:103], a[168:171], a[4:7], v[100:103]
    ds_read_b128 a[188:191], v32 offset:33792
    v_mfma_f32_16x16x32_bf16 v[104:107], a[168:171], a[8:11], v[104:107]
    v_pk_mul_f32 v[76:77], v[76:77], s[92:93]
    v_pk_mul_f32 v[78:79], v[78:79], s[92:93]
    v_cvt_pk_bf16_f32 v76, v76, v77
    v_cvt_pk_bf16_f32 v77, v78, v79
    ds_write_b64 v6, v[76:77] offset:512
    v_mfma_f32_16x16x32_bf16 v[108:111], a[168:171], a[12:15], v[108:111]
    v_pk_mul_f32 v[80:81], v[80:81], s[92:93]
    v_pk_mul_f32 v[82:83], v[82:83], s[92:93]
    v_cvt_pk_bf16_f32 v80, v80, v81
    v_cvt_pk_bf16_f32 v81, v82, v83
    ds_write_b64 v6, v[80:81] offset:4608
    v_mfma_f32_16x16x32_bf16 v[112:115], a[168:171], a[16:19], v[112:115]
    v_pk_mul_f32 v[84:85], v[84:85], s[92:93]
    v_pk_mul_f32 v[86:87], v[86:87], s[92:93]
    v_cvt_pk_bf16_f32 v84, v84, v85
    v_cvt_pk_bf16_f32 v85, v86, v87
    ds_write_b64 v6, v[84:85] offset:8704
    v_mfma_f32_16x16x32_bf16 v[96:99], a[172:175], a[20:23], v[96:99]
    v_pk_mul_f32 v[88:89], v[88:89], s[92:93]
    v_pk_mul_f32 v[90:91], v[90:91], s[92:93]
    v_cvt_pk_bf16_f32 v88, v88, v89
    v_cvt_pk_bf16_f32 v89, v90, v91
    ds_write_b64 v6, v[88:89] offset:12800
    ds_read_b128 a[192:195], v33 offset:32768
    v_mfma_f32_16x16x32_bf16 v[100:103], a[172:175], a[24:27], v[100:103]
    v_pk_mul_f32 v[92:93], v[92:93], s[92:93]
    v_pk_mul_f32 v[94:95], v[94:95], s[92:93]
    v_cvt_pk_bf16_f32 v92, v92, v93
    v_cvt_pk_bf16_f32 v93, v94, v95
    ds_write_b64 v6, v[92:93] offset:16896
    v_mfma_f32_16x16x32_bf16 v[104:107], a[172:175], a[28:31], v[104:107]
    v_mfma_f32_16x16x32_bf16 v[108:111], a[172:175], a[32:35], v[108:111]
    s_waitcnt lgkmcnt(0)
    s_barrier
    ds_read_b128 a[80:83], v35 offset:32768
    v_mfma_f32_16x16x32_bf16 v[112:115], a[172:175], a[36:39], v[112:115]
    ds_read_b128 a[84:87], v35 offset:36864
    ds_read_b128 a[196:199], v33 offset:33792
    v_mfma_f32_16x16x32_bf16 v[116:119], a[176:179], a[0:3], v[116:119]
    ds_read_b128 a[88:91], v35 offset:40960
    ds_read_b128 a[92:95], v35 offset:45056
    v_mfma_f32_16x16x32_bf16 v[120:123], a[176:179], a[4:7], v[120:123]
    ds_read_b128 a[96:99], v35 offset:49152
    v_mfma_f32_16x16x32_bf16 v[124:127], a[176:179], a[8:11], v[124:127]
    v_pk_mul_f32 v[96:97], v[96:97], s[92:93]
    v_pk_mul_f32 v[98:99], v[98:99], s[92:93]
    v_cvt_pk_bf16_f32 v96, v96, v97
    v_cvt_pk_bf16_f32 v97, v98, v99
    ds_read_b128 a[100:103], v35 offset:33792
    ds_write_b64 v7, v[96:97] offset:0
    ds_read_b128 a[104:107], v35 offset:37888
    v_mfma_f32_16x16x32_bf16 v[128:131], a[176:179], a[12:15], v[128:131]
    v_pk_mul_f32 v[100:101], v[100:101], s[92:93]
    v_pk_mul_f32 v[102:103], v[102:103], s[92:93]
    v_cvt_pk_bf16_f32 v100, v100, v101
    v_cvt_pk_bf16_f32 v101, v102, v103
    ds_write_b64 v7, v[100:101] offset:4096
    ds_read_b128 a[108:111], v35 offset:41984
    ds_read_b128 a[112:115], v35 offset:46080
    v_mfma_f32_16x16x32_bf16 v[132:135], a[176:179], a[16:19], v[132:135]
    v_pk_mul_f32 v[104:105], v[104:105], s[92:93]
    v_pk_mul_f32 v[106:107], v[106:107], s[92:93]
    v_cvt_pk_bf16_f32 v104, v104, v105
    v_cvt_pk_bf16_f32 v105, v106, v107
    ds_write_b64 v7, v[104:105] offset:8192
    ds_read_b128 a[116:119], v35 offset:50176
    v_mfma_f32_16x16x32_bf16 v[116:119], a[180:183], a[20:23], v[116:119]
    v_pk_mul_f32 v[108:109], v[108:109], s[92:93]
    v_pk_mul_f32 v[110:111], v[110:111], s[92:93]
    v_cvt_pk_bf16_f32 v108, v108, v109
    v_cvt_pk_bf16_f32 v109, v110, v111
    ds_write_b64 v6, v[108:109] offset:20480
    ds_read_b128 a[120:123], v35 offset:34816
    ds_read_b128 a[124:127], v35 offset:38912
    v_mfma_f32_16x16x32_bf16 v[120:123], a[180:183], a[24:27], v[120:123]
    v_pk_mul_f32 v[112:113], v[112:113], s[92:93]
    v_pk_mul_f32 v[114:115], v[114:115], s[92:93]
    v_cvt_pk_bf16_f32 v112, v112, v113
    v_cvt_pk_bf16_f32 v113, v114, v115
    ds_write_b64 v6, v[112:113] offset:24576
    ds_read_b128 a[128:131], v35 offset:43008
    ds_read_b128 a[132:135], v35 offset:47104
    v_mfma_f32_16x16x32_bf16 v[124:127], a[180:183], a[28:31], v[124:127]
    ds_read_b128 a[136:139], v35 offset:51200
    v_mfma_f32_16x16x32_bf16 v[128:131], a[180:183], a[32:35], v[128:131]
    ds_read_b128 a[140:143], v35 offset:35840
    ds_read_b128 a[144:147], v35 offset:39936
    v_mfma_f32_16x16x32_bf16 v[132:135], a[180:183], a[36:39], v[132:135]
    ds_read_b128 a[148:151], v35 offset:44032
    ds_read_b128 a[152:155], v35 offset:48128
    ds_read_b128 a[156:159], v35 offset:52224
    v_pk_mul_f32 v[116:117], v[116:117], s[92:93]
    v_pk_mul_f32 v[118:119], v[118:119], s[92:93]
    v_cvt_pk_bf16_f32 v116, v116, v117
    v_cvt_pk_bf16_f32 v117, v118, v119
    ds_write_b64 v7, v[116:117] offset:512
    v_pk_mul_f32 v[120:121], v[120:121], s[92:93]
    v_pk_mul_f32 v[122:123], v[122:123], s[92:93]
    v_cvt_pk_bf16_f32 v120, v120, v121
    v_cvt_pk_bf16_f32 v121, v122, v123
    ds_write_b64 v7, v[120:121] offset:4608
    v_pk_mul_f32 v[124:125], v[124:125], s[92:93]
    v_pk_mul_f32 v[126:127], v[126:127], s[92:93]
    v_cvt_pk_bf16_f32 v124, v124, v125
    v_cvt_pk_bf16_f32 v125, v126, v127
    ds_write_b64 v7, v[124:125] offset:8704
    v_pk_mul_f32 v[128:129], v[128:129], s[92:93]
    v_pk_mul_f32 v[130:131], v[130:131], s[92:93]
    v_cvt_pk_bf16_f32 v128, v128, v129
    v_cvt_pk_bf16_f32 v129, v130, v131
    ds_write_b64 v6, v[128:129] offset:20992
    v_pk_mul_f32 v[132:133], v[132:133], s[92:93]
    v_pk_mul_f32 v[134:135], v[134:135], s[92:93]
    v_cvt_pk_bf16_f32 v132, v132, v133
    v_cvt_pk_bf16_f32 v133, v134, v135
    ds_write_b64 v6, v[132:133] offset:25088
    s_add_u32 m0, s52, 32768
    s_nop 0
    buffer_load_dwordx4 v41, s[24:27], s66 offen lds
    s_add_u32 m0, s52, 33664
    s_nop 0
    buffer_load_dwordx4 v41, s[24:27], s66 offen offset:128 lds
    s_add_u32 m0, s52, 49152
    s_add_u32 s57, s66, 16384
    buffer_load_dwordx4 v41, s[24:27], s57 offen lds
    s_add_u32 m0, s52, 50048
    s_nop 0
    buffer_load_dwordx4 v41, s[24:27], s57 offen offset:128 lds
    s_add_u32 m0, s52, 34560
    s_nop 0
    buffer_load_dwordx4 v41, s[24:27], s66 offen offset:256 lds
    s_add_u32 m0, s52, 35456
    s_nop 0
    buffer_load_dwordx4 v41, s[24:27], s66 offen offset:384 lds
    s_add_u32 m0, s52, 50944
    s_nop 0
    buffer_load_dwordx4 v41, s[24:27], s57 offen offset:256 lds
    s_add_u32 m0, s52, 51840
    s_nop 0
    buffer_load_dwordx4 v41, s[24:27], s57 offen offset:384 lds
    s_waitcnt lgkmcnt(0)
    s_waitcnt vmcnt(12)
    s_barrier
    v_add_u32 v6, 81920, v34
    ds_read_b128 a[0:3], v6 offset:0
    v_mfma_f32_16x16x32_bf16 v[56:59], a[184:187], a[80:83], 0
    ds_read_b128 a[4:7], v6 offset:4096
    ds_read_b128 a[160:163], v32 offset:34816
    v_mfma_f32_16x16x32_bf16 v[60:63], a[184:187], a[84:87], 0
    ds_read_b128 a[8:11], v6 offset:8192
    ds_read_b128 a[12:15], v35 offset:53248
    v_mfma_f32_16x16x32_bf16 v[64:67], a[184:187], a[88:91], 0
    ds_read_b128 a[16:19], v35 offset:57344
    v_mfma_f32_16x16x32_bf16 v[68:71], a[184:187], a[92:95], 0
    ds_read_b128 a[20:23], v6 offset:1024
    v_mfma_f32_16x16x32_bf16 v[72:75], a[184:187], a[96:99], 0
    ds_read_b128 a[24:27], v6 offset:5120
    ds_read_b128 a[164:167], v32 offset:35840
    v_mfma_f32_16x16x32_bf16 v[56:59], a[188:191], a[100:103], v[56:59]
    ds_read_b128 a[28:31], v6 offset:9216
    s_add_u32 m0, s52, 65536
    s_nop 0
    buffer_load_dwordx4 v41, s[24:27], s67 offen lds
    s_add_u32 m0, s52, 66432
    ds_read_b128 a[32:35], v35 offset:54272
    v_mfma_f32_16x16x32_bf16 v[60:63], a[188:191], a[104:107], v[60:63]
    ds_read_b128 a[36:39], v35 offset:58368
    v_mfma_f32_16x16x32_bf16 v[64:67], a[188:191], a[108:111], v[64:67]
    ds_read_b128 a[40:43], v6 offset:2048
    v_mfma_f32_16x16x32_bf16 v[68:71], a[188:191], a[112:115], v[68:71]
    ds_read_b128 a[44:47], v6 offset:6144
    ds_read_b128 a[168:171], v33 offset:34816
    v_mfma_f32_16x16x32_bf16 v[72:75], a[188:191], a[116:119], v[72:75]
    ds_read_b128 a[48:51], v6 offset:10240
    ds_read_b128 a[52:55], v35 offset:55296
    s_waitcnt lgkmcnt(15)
    v_mfma_f32_16x16x32_bf16 v[56:59], a[192:195], a[0:3], v[56:59]
    ds_read_b128 a[56:59], v35 offset:59392
    v_mfma_f32_16x16x32_bf16 v[60:63], a[192:195], a[4:7], v[60:63]
    ds_read_b128 a[60:63], v6 offset:3072
    s_waitcnt lgkmcnt(15)
    v_mfma_f32_16x16x32_bf16 v[64:67], a[192:195], a[8:11], v[64:67]
    ds_read_b128 a[64:67], v6 offset:7168
    ds_read_b128 a[172:175], v33 offset:35840
    s_waitcnt lgkmcnt(15)
    v_mfma_f32_16x16x32_bf16 v[68:71], a[192:195], a[12:15], v[68:71]
    ds_read_b128 a[68:71], v6 offset:11264
    ds_read_b128 a[72:75], v35 offset:56320
    v_mfma_f32_16x16x32_bf16 v[72:75], a[192:195], a[16:19], v[72:75]
    buffer_load_dwordx4 v41, s[24:27], s67 offen offset:128 lds
    s_add_u32 m0, s52, 67328
    ds_read_b128 a[76:79], v35 offset:60416
    s_waitcnt lgkmcnt(15)
    v_mfma_f32_16x16x32_bf16 v[56:59], a[196:199], a[20:23], v[56:59]
    v_mfma_f32_16x16x32_bf16 v[60:63], a[196:199], a[24:27], v[60:63]
    s_waitcnt lgkmcnt(14)
    v_mfma_f32_16x16x32_bf16 v[64:67], a[196:199], a[28:31], v[64:67]
    v_xor_b32 v32, 0x10000, v32
    v_xor_b32 v33, 0x10000, v33
    ds_read_b128 a[176:179], v33 offset:0
    s_waitcnt lgkmcnt(14)
    v_mfma_f32_16x16x32_bf16 v[68:71], a[196:199], a[32:35], v[68:71]
    s_waitcnt lgkmcnt(13)
    v_mfma_f32_16x16x32_bf16 v[72:75], a[196:199], a[36:39], v[72:75]
    v_mfma_f32_16x16x32_bf16 v[56:59], a[160:163], a[120:123], v[56:59]
    v_mfma_f32_16x16x32_bf16 v[60:63], a[160:163], a[124:127], v[60:63]
    ds_read_b128 a[180:183], v33 offset:1024
    v_mfma_f32_16x16x32_bf16 v[64:67], a[160:163], a[128:131], v[64:67]
    buffer_load_dwordx4 v41, s[24:27], s67 offen offset:256 lds
    s_add_u32 m0, s52, 68224
    v_mfma_f32_16x16x32_bf16 v[68:71], a[160:163], a[132:135], v[68:71]
    v_mfma_f32_16x16x32_bf16 v[72:75], a[160:163], a[136:139], v[72:75]
    v_mfma_f32_16x16x32_bf16 v[56:59], a[164:167], a[140:143], v[56:59]
    ds_read_b128 a[184:187], v32 offset:0
    v_mfma_f32_16x16x32_bf16 v[60:63], a[164:167], a[144:147], v[60:63]
    v_mfma_f32_16x16x32_bf16 v[64:67], a[164:167], a[148:151], v[64:67]
    v_mfma_f32_16x16x32_bf16 v[68:71], a[164:167], a[152:155], v[68:71]
    v_mfma_f32_16x16x32_bf16 v[72:75], a[164:167], a[156:159], v[72:75]
    ds_read_b128 a[188:191], v32 offset:1024
    s_waitcnt lgkmcnt(7)
    v_mfma_f32_16x16x32_bf16 v[56:59], a[168:171], a[40:43], v[56:59]
    v_mfma_f32_16x16x32_bf16 v[60:63], a[168:171], a[44:47], v[60:63]
    buffer_load_dwordx4 v41, s[24:27], s67 offen offset:384 lds
    v_mfma_f32_16x16x32_bf16 v[64:67], a[168:171], a[48:51], v[64:67]
    v_mfma_f32_16x16x32_bf16 v[68:71], a[168:171], a[52:55], v[68:71]
    v_mfma_f32_16x16x32_bf16 v[72:75], a[168:171], a[56:59], v[72:75]
    v_mfma_f32_16x16x32_bf16 v[56:59], a[172:175], a[60:63], v[56:59]
    v_mfma_f32_16x16x32_bf16 v[60:63], a[172:175], a[64:67], v[60:63]
    s_waitcnt lgkmcnt(6)
    v_mfma_f32_16x16x32_bf16 v[64:67], a[172:175], a[68:71], v[64:67]
    s_waitcnt lgkmcnt(5)
    v_mfma_f32_16x16x32_bf16 v[68:71], a[172:175], a[72:75], v[68:71]
    s_waitcnt lgkmcnt(4)
    v_mfma_f32_16x16x32_bf16 v[72:75], a[172:175], a[76:79], v[72:75]
    v_and_b32 v7, 15, v0
    v_lshlrev_b32 v7, 4, v7
    s_lshl_b32 s59, s45, 2
    s_add_u32 s59, s59, 161792
    v_add_u32 v7, s59, v7
    v_max3_f32 v196, v56, v57, v58
    v_max_f32 v196, v196, v59
    v_max3_f32 v200, v60, v61, v62
    v_max_f32 v200, v200, v63
    v_max3_f32 v204, v64, v65, v66
    v_max_f32 v204, v204, v67
    v_max3_f32 v208, v68, v69, v70
    v_max_f32 v208, v208, v71
    v_max3_f32 v212, v72, v73, v74
    v_max_f32 v212, v212, v75
    v_mov_b32 v197, v196
    v_mov_b32 v201, v200
    v_mov_b32 v205, v204
    v_mov_b32 v209, v208
    v_mov_b32 v213, v212
    v_permlane32_swap_b32 v196, v197
    v_permlane32_swap_b32 v200, v201
    v_permlane32_swap_b32 v204, v205
    v_permlane32_swap_b32 v208, v209
    v_permlane32_swap_b32 v212, v213
    v_max_f32 v196, v196, v197
    v_max_f32 v200, v200, v201
    v_max_f32 v204, v204, v205
    v_max_f32 v208, v208, v209
    v_max_f32 v212, v212, v213
    v_mov_b32 v197, v196
    v_mov_b32 v201, v200
    v_mov_b32 v205, v204
    v_mov_b32 v209, v208
    v_mov_b32 v213, v212
    v_permlane16_swap_b32 v196, v197
    v_permlane16_swap_b32 v200, v201
    v_permlane16_swap_b32 v204, v205
    v_permlane16_swap_b32 v208, v209
    v_permlane16_swap_b32 v212, v213
    v_max_f32 v196, v196, v197
    v_max_f32 v200, v200, v201
    v_max_f32 v204, v204, v205
    v_max_f32 v208, v208, v209
    v_max_f32 v212, v212, v213
    ds_write_b32 v7, v196 offset:0
    ds_write_b32 v7, v200 offset:256
    ds_write_b32 v7, v204 offset:512
    ds_write_b32 v7, v208 offset:768
    ds_write_b32 v7, v212 offset:1024
    s_waitcnt lgkmcnt(0)
    s_waitcnt vmcnt(8)
    s_barrier
    v_and_b32 v7, 15, v0
    v_lshlrev_b32 v7, 4, v7
    v_add_u32 v7, 161792, v7
    ds_read_b128 v[196:199], v7 offset:0
    ds_read_b128 v[200:203], v7 offset:256
    ds_read_b128 v[204:207], v7 offset:512
    ds_read_b128 v[208:211], v7 offset:768
    ds_read_b128 v[212:215], v7 offset:1024
    v_mfma_f32_16x16x32_bf16 v[216:219], a[176:179], a[0:3], 0
    ds_read_b128 a[192:195], v33 offset:2048
    v_mfma_f32_16x16x32_bf16 v[220:223], a[176:179], a[4:7], 0
    v_mfma_f32_16x16x32_bf16 v[224:227], a[176:179], a[8:11], 0
    s_add_u32 m0, s52, 81920
    s_add_u32 s57, s67, 16384
    buffer_load_dwordx4 v41, s[24:27], s57 offen lds
    s_add_u32 m0, s52, 82816
    v_mfma_f32_16x16x32_bf16 v[228:231], a[176:179], a[12:15], 0
    v_mfma_f32_16x16x32_bf16 v[232:235], a[176:179], a[16:19], 0
    ds_read_b128 a[196:199], v33 offset:3072
    v_mfma_f32_16x16x32_bf16 v[216:219], a[180:183], a[20:23], v[216:219]
    buffer_load_dwordx4 v41, s[24:27], s57 offen offset:128 lds
    s_add_u32 m0, s52, 83712
    s_waitcnt lgkmcnt(2)
    s_cmp_lg_u32 s54, 0
    s_cbranch_scc1 L_havem
    v_max3_f32 v8, v196, v197, v198
    v_max_f32 v8, v8, v199
    v_sub_f32 v8, 0, v8
    v_max3_f32 v12, v200, v201, v202
    v_max_f32 v12, v12, v203
    v_sub_f32 v12, 0, v12
    v_max3_f32 v16, v204, v205, v206
    v_max_f32 v16, v16, v207
    v_sub_f32 v16, 0, v16
    v_max3_f32 v20, v208, v209, v210
    v_max_f32 v20, v20, v211
    v_sub_f32 v20, 0, v20
    v_max3_f32 v24, v212, v213, v214
    v_max_f32 v24, v24, v215
    v_sub_f32 v24, 0, v24
L_havem:
    v_mov_b32 v9, v8
    v_mov_b32 v10, v8
    v_mov_b32 v11, v8
    v_mov_b32 v13, v12
    v_mov_b32 v14, v12
    v_mov_b32 v15, v12
    v_mov_b32 v17, v16
    v_mov_b32 v18, v16
    v_mov_b32 v19, v16
    v_mov_b32 v21, v20
    v_mov_b32 v22, v20
    v_mov_b32 v23, v20
    v_mov_b32 v25, v24
    v_mov_b32 v26, v24
    v_mov_b32 v27, v24
    v_mfma_f32_16x16x32_bf16 v[220:223], a[180:183], a[24:27], v[220:223]
    v_add_f32 v56, v56, v8
    v_add_f32 v57, v57, v8
    v_mfma_f32_16x16x32_bf16 v[224:227], a[180:183], a[28:31], v[224:227]
    v_add_f32 v58, v58, v8
    v_add_f32 v59, v59, v8
    v_mfma_f32_16x16x32_bf16 v[228:231], a[180:183], a[32:35], v[228:231]
    buffer_load_dwordx4 v41, s[24:27], s57 offen offset:256 lds
    s_add_u32 m0, s52, 84608
    v_max3_f32 v1, v1, v56, v57
    ds_read_b128 a[160:163], v32 offset:2048
    v_mfma_f32_16x16x32_bf16 v[232:235], a[180:183], a[36:39], v[232:235]
    v_max3_f32 v1, v1, v58, v59
    v_exp_f32 v56, v56
    v_mfma_f32_16x16x32_bf16 v[216:219], a[184:187], a[80:83], v[216:219]
    v_exp_f32 v57, v57
    v_exp_f32 v58, v58
    v_mfma_f32_16x16x32_bf16 v[220:223], a[184:187], a[84:87], v[220:223]
    buffer_load_dwordx4 v41, s[24:27], s57 offen offset:384 lds
    v_exp_f32 v59, v59
    v_cvt_pk_bf16_f32 v56, v56, v57
    v_mfma_f32_16x16x32_bf16 v[224:227], a[184:187], a[88:91], v[224:227]
    v_cvt_pk_bf16_f32 v57, v58, v59
    ds_read_b128 a[164:167], v32 offset:3072
    v_mfma_f32_16x16x32_bf16 v[228:231], a[184:187], a[92:95], v[228:231]
    v_add_f32 v60, v60, v12
    v_add_f32 v61, v61, v12
    v_mfma_f32_16x16x32_bf16 v[232:235], a[184:187], a[96:99], v[232:235]
    s_add_u32 m0, s52, 98304
    s_nop 0
    buffer_load_dwordx4 v41, s[24:27], s68 offen lds
    s_add_u32 m0, s52, 99200
    v_add_f32 v62, v62, v12
    v_add_f32 v63, v63, v12
    v_mfma_f32_16x16x32_bf16 v[216:219], a[188:191], a[100:103], v[216:219]
    v_max3_f32 v2, v2, v60, v61
    v_max3_f32 v2, v2, v62, v63
    v_mfma_f32_16x16x32_bf16 v[220:223], a[188:191], a[104:107], v[220:223]
    v_exp_f32 v60, v60
    v_mfma_f32_16x16x32_bf16 v[224:227], a[188:191], a[108:111], v[224:227]
    buffer_load_dwordx4 v41, s[24:27], s68 offen offset:128 lds
    s_add_u32 m0, s52, 114688
    v_exp_f32 v61, v61
    ds_read_b128 a[168:171], v33 offset:32768
    v_exp_f32 v62, v62
    v_mfma_f32_16x16x32_bf16 v[228:231], a[188:191], a[112:115], v[228:231]
    v_exp_f32 v63, v63
    v_cvt_pk_bf16_f32 v60, v60, v61
    v_mfma_f32_16x16x32_bf16 v[232:235], a[188:191], a[116:119], v[232:235]
    v_cvt_pk_bf16_f32 v61, v62, v63
    v_add_f32 v64, v64, v16
    s_add_u32 s57, s68, 16384
    buffer_load_dwordx4 v41, s[24:27], s57 offen lds
    s_add_u32 m0, s52, 115584
    s_waitcnt lgkmcnt(3)
    v_mfma_f32_16x16x32_bf16 v[216:219], a[192:195], a[40:43], v[216:219]
    v_add_f32 v65, v65, v16
    v_mfma_f32_16x16x32_bf16 v[220:223], a[192:195], a[44:47], v[220:223]
    v_add_f32 v66, v66, v16
    ds_read_b128 a[172:175], v33 offset:33792
    v_add_f32 v67, v67, v16
    v_mfma_f32_16x16x32_bf16 v[224:227], a[192:195], a[48:51], v[224:227]
    v_max3_f32 v3, v3, v64, v65
    v_max3_f32 v3, v3, v66, v67
    buffer_load_dwordx4 v41, s[24:27], s57 offen offset:128 lds
    s_add_u32 m0, s52, 100096
    v_mfma_f32_16x16x32_bf16 v[228:231], a[192:195], a[52:55], v[228:231]
    v_exp_f32 v64, v64
    v_exp_f32 v65, v65
    v_mfma_f32_16x16x32_bf16 v[232:235], a[192:195], a[56:59], v[232:235]
    v_exp_f32 v66, v66
    v_exp_f32 v67, v67
    v_mfma_f32_16x16x32_bf16 v[216:219], a[196:199], a[60:63], v[216:219]
    ds_read_b128 a[176:179], v32 offset:32768
    v_cvt_pk_bf16_f32 v64, v64, v65
    buffer_load_dwordx4 v41, s[24:27], s68 offen offset:256 lds
    s_add_u32 m0, s52, 100992
    v_mfma_f32_16x16x32_bf16 v[220:223], a[196:199], a[64:67], v[220:223]
    v_cvt_pk_bf16_f32 v65, v66, v67
    v_add_f32 v68, v68, v20
    v_mfma_f32_16x16x32_bf16 v[224:227], a[196:199], a[68:71], v[224:227]
    v_add_f32 v69, v69, v20
    v_add_f32 v70, v70, v20
    v_mfma_f32_16x16x32_bf16 v[228:231], a[196:199], a[72:75], v[228:231]
    v_add_f32 v71, v71, v20
    buffer_load_dwordx4 v41, s[24:27], s68 offen offset:384 lds
    s_add_u32 m0, s52, 116480
    v_max3_f32 v4, v4, v68, v69
    v_mfma_f32_16x16x32_bf16 v[232:235], a[196:199], a[76:79], v[232:235]
    v_max3_f32 v4, v4, v70, v71
    ds_read_b128 a[180:183], v32 offset:33792
    s_waitcnt lgkmcnt(4)
    v_mfma_f32_16x16x32_bf16 v[216:219], a[160:163], a[120:123], v[216:219]
    v_exp_f32 v68, v68
    v_exp_f32 v69, v69
    v_mfma_f32_16x16x32_bf16 v[220:223], a[160:163], a[124:127], v[220:223]
    v_exp_f32 v70, v70
    buffer_load_dwordx4 v41, s[24:27], s57 offen offset:256 lds
    s_add_u32 m0, s52, 117376
    v_exp_f32 v71, v71
    v_mfma_f32_16x16x32_bf16 v[224:227], a[160:163], a[128:131], v[224:227]
    v_cvt_pk_bf16_f32 v68, v68, v69
    v_cvt_pk_bf16_f32 v69, v70, v71
    v_mfma_f32_16x16x32_bf16 v[228:231], a[160:163], a[132:135], v[228:231]
    v_add_f32 v72, v72, v24
    v_mfma_f32_16x16x32_bf16 v[232:235], a[160:163], a[136:139], v[232:235]
    v_add_f32 v73, v73, v24
    buffer_load_dwordx4 v41, s[24:27], s57 offen offset:384 lds
    v_add_f32 v74, v74, v24
    v_mfma_f32_16x16x32_bf16 v[216:219], a[164:167], a[140:143], v[216:219]
    v_add_f32 v75, v75, v24
    v_max3_f32 v5, v5, v72, v73
    v_mfma_f32_16x16x32_bf16 v[220:223], a[164:167], a[144:147], v[220:223]
    v_max3_f32 v5, v5, v74, v75
    v_exp_f32 v72, v72
    v_mfma_f32_16x16x32_bf16 v[224:227], a[164:167], a[148:151], v[224:227]
    v_exp_f32 v73, v73
    v_mfma_f32_16x16x32_bf16 v[228:231], a[164:167], a[152:155], v[228:231]
    v_exp_f32 v74, v74
    v_exp_f32 v75, v75
    v_mfma_f32_16x16x32_bf16 v[232:235], a[164:167], a[156:159], v[232:235]
    v_cvt_pk_bf16_f32 v72, v72, v73
    v_cvt_pk_bf16_f32 v73, v74, v75
    s_waitcnt vmcnt(10)
    s_barrier
    s_waitcnt lgkmcnt(2)
    v_mfma_f32_16x16x32_bf16 v[76:79], a[168:171], a[0:3], v[8:11]
    v_mfma_f32_16x16x32_bf16 v[80:83], a[168:171], a[4:7], v[12:15]
    ds_read_b128 a[184:187], v33 offset:34816
    v_add_f32 v216, v216, v8
    v_add_f32 v217, v217, v8
    v_mfma_f32_16x16x32_bf16 v[84:87], a[168:171], a[8:11], v[16:19]
    s_add_u32 m0, s52, 0
    s_nop 0
    buffer_load_dwordx4 v41, s[24:27], s69 offen lds
    s_add_u32 m0, s52, 896
    v_mfma_f32_16x16x32_bf16 v[88:91], a[168:171], a[12:15], v[20:23]
    v_add_f32 v218, v218, v8
    v_add_f32 v219, v219, v8
    v_max3_f32 v1, v1, v216, v217
    v_mfma_f32_16x16x32_bf16 v[92:95], a[168:171], a[16:19], v[24:27]
    ds_read_b128 a[188:191], v33 offset:35840
    v_max3_f32 v1, v1, v218, v219
    v_mfma_f32_16x16x32_bf16 v[76:79], a[172:175], a[20:23], v[76:79]
    v_exp_f32 v216, v216
    v_exp_f32 v217, v217
    v_mfma_f32_16x16x32_bf16 v[80:83], a[172:175], a[24:27], v[80:83]
    v_exp_f32 v218, v218
    v_mfma_f32_16x16x32_bf16 v[84:87], a[172:175], a[28:31], v[84:87]
    buffer_load_dwordx4 v41, s[24:27], s69 offen offset:128 lds
    s_add_u32 m0, s52, 16384
    v_mfma_f32_16x16x32_bf16 v[88:91], a[172:175], a[32:35], v[88:91]
    v_exp_f32 v219, v219
    v_cvt_pk_bf16_f32 v58, v216, v217
    v_mfma_f32_16x16x32_bf16 v[92:95], a[172:175], a[36:39], v[92:95]
    ds_read_b128 a[192:195], v32 offset:34816
    v_cvt_pk_bf16_f32 v59, v218, v219
    v_add_f32 v220, v220, v12
    s_waitcnt lgkmcnt(3)
    v_mfma_f32_16x16x32_bf16 v[76:79], a[176:179], a[80:83], v[76:79]
    v_add_f32 v221, v221, v12
    v_add_f32 v222, v222, v12
    v_add_f32 v223, v223, v12
    v_mfma_f32_16x16x32_bf16 v[80:83], a[176:179], a[84:87], v[80:83]
    s_add_u32 s57, s69, 16384
    buffer_load_dwordx4 v41, s[24:27], s57 offen lds
    s_add_u32 m0, s52, 17280
    v_mfma_f32_16x16x32_bf16 v[84:87], a[176:179], a[88:91], v[84:87]
    v_max3_f32 v2, v2, v220, v221
    v_max3_f32 v2, v2, v222, v223
    ds_read_b128 a[196:199], v32 offset:35840
    v_mfma_f32_16x16x32_bf16 v[88:91], a[176:179], a[92:95], v[88:91]
    v_exp_f32 v220, v220
    v_exp_f32 v221, v221
    v_mfma_f32_16x16x32_bf16 v[92:95], a[176:179], a[96:99], v[92:95]
    v_exp_f32 v222, v222
    v_exp_f32 v223, v223
    v_mfma_f32_16x16x32_bf16 v[76:79], a[180:183], a[100:103], v[76:79]
    v_cvt_pk_bf16_f32 v62, v220, v221
    buffer_load_dwordx4 v41, s[24:27], s57 offen offset:128 lds
    s_add_u32 m0, s52, 1792
    v_mfma_f32_16x16x32_bf16 v[80:83], a[180:183], a[104:107], v[80:83]
    v_cvt_pk_bf16_f32 v63, v222, v223
    v_xor_b32 v32, 0x10000, v32
    v_xor_b32 v33, 0x10000, v33
    ds_read_b128 a[160:163], v33 offset:0
    v_mfma_f32_16x16x32_bf16 v[84:87], a[180:183], a[108:111], v[84:87]
    v_add_f32 v224, v224, v16
    v_add_f32 v225, v225, v16
    v_add_f32 v226, v226, v16
    v_mfma_f32_16x16x32_bf16 v[88:91], a[180:183], a[112:115], v[88:91]
    v_add_f32 v227, v227, v16
    v_max3_f32 v3, v3, v224, v225
    v_max3_f32 v3, v3, v226, v227
    v_mfma_f32_16x16x32_bf16 v[92:95], a[180:183], a[116:119], v[92:95]
    buffer_load_dwordx4 v41, s[24:27], s69 offen offset:256 lds
    s_add_u32 m0, s52, 2688
    s_waitcnt lgkmcnt(3)
    v_mfma_f32_16x16x32_bf16 v[76:79], a[184:187], a[40:43], v[76:79]
    v_exp_f32 v224, v224
    ds_read_b128 a[164:167], v33 offset:1024
    v_mfma_f32_16x16x32_bf16 v[80:83], a[184:187], a[44:47], v[80:83]
    v_exp_f32 v225, v225
    v_mfma_f32_16x16x32_bf16 v[84:87], a[184:187], a[48:51], v[84:87]
    v_exp_f32 v226, v226
    v_mfma_f32_16x16x32_bf16 v[88:91], a[184:187], a[52:55], v[88:91]
    v_exp_f32 v227, v227
    v_cvt_pk_bf16_f32 v66, v224, v225
    v_mfma_f32_16x16x32_bf16 v[92:95], a[184:187], a[56:59], v[92:95]
    v_cvt_pk_bf16_f32 v67, v226, v227
    v_add_f32 v228, v228, v20
    v_mfma_f32_16x16x32_bf16 v[76:79], a[188:191], a[60:63], v[76:79]
    buffer_load_dwordx4 v41, s[24:27], s69 offen offset:384 lds
    s_add_u32 m0, s52, 18176
    v_mfma_f32_16x16x32_bf16 v[80:83], a[188:191], a[64:67], v[80:83]
    ds_read_b128 a[168:171], v32 offset:0
    v_add_f32 v229, v229, v20
    v_add_f32 v230, v230, v20
    v_mfma_f32_16x16x32_bf16 v[84:87], a[188:191], a[68:71], v[84:87]
    v_add_f32 v231, v231, v20
    v_max3_f32 v4, v4, v228, v229
    v_max3_f32 v4, v4, v230, v231
    v_mfma_f32_16x16x32_bf16 v[88:91], a[188:191], a[72:75], v[88:91]
    v_exp_f32 v228, v228
    v_mfma_f32_16x16x32_bf16 v[92:95], a[188:191], a[76:79], v[92:95]
    v_exp_f32 v229, v229
    s_waitcnt lgkmcnt(3)
    v_mfma_f32_16x16x32_bf16 v[76:79], a[192:195], a[120:123], v[76:79]
    buffer_load_dwordx4 v41, s[24:27], s57 offen offset:256 lds
    s_add_u32 m0, s52, 19072
    v_mfma_f32_16x16x32_bf16 v[80:83], a[192:195], a[124:127], v[80:83]
    ds_read_b128 a[172:175], v32 offset:1024
    v_exp_f32 v230, v230
    v_mfma_f32_16x16x32_bf16 v[84:87], a[192:195], a[128:131], v[84:87]
    v_exp_f32 v231, v231
    v_cvt_pk_bf16_f32 v70, v228, v229
    v_mfma_f32_16x16x32_bf16 v[88:91], a[192:195], a[132:135], v[88:91]
    v_cvt_pk_bf16_f32 v71, v230, v231
    v_add_f32 v232, v232, v24
    v_add_f32 v233, v233, v24
    v_mfma_f32_16x16x32_bf16 v[92:95], a[192:195], a[136:139], v[92:95]
    buffer_load_dwordx4 v41, s[24:27], s57 offen offset:384 lds
    v_mfma_f32_16x16x32_bf16 v[76:79], a[196:199], a[140:143], v[76:79]
    v_add_f32 v234, v234, v24
    v_add_f32 v235, v235, v24
    v_max3_f32 v5, v5, v232, v233
    v_mfma_f32_16x16x32_bf16 v[80:83], a[196:199], a[144:147], v[80:83]
    v_max3_f32 v5, v5, v234, v235
    v_exp_f32 v232, v232
    v_mfma_f32_16x16x32_bf16 v[84:87], a[196:199], a[148:151], v[84:87]
    v_exp_f32 v233, v233
    v_mfma_f32_16x16x32_bf16 v[88:91], a[196:199], a[152:155], v[88:91]
    v_exp_f32 v234, v234
    v_exp_f32 v235, v235
    v_mfma_f32_16x16x32_bf16 v[92:95], a[196:199], a[156:159], v[92:95]
    v_cvt_pk_bf16_f32 v74, v232, v233
    v_cvt_pk_bf16_f32 v75, v234, v235
    s_waitcnt vmcnt(12)
    s_barrier
    s_waitcnt lgkmcnt(2)
    v_mfma_f32_16x16x32_bf16 v[216:219], a[160:163], a[0:3], v[8:11]
    v_mfma_f32_16x16x32_bf16 v[220:223], a[160:163], a[4:7], v[12:15]
    ds_read_b128 a[176:179], v33 offset:2048
    v_max3_f32 v1, v1, v76, v77
    v_mfma_f32_16x16x32_bf16 v[224:227], a[160:163], a[8:11], v[16:19]
    v_max3_f32 v1, v1, v78, v79
    v_mfma_f32_16x16x32_bf16 v[228:231], a[160:163], a[12:15], v[20:23]
    s_add_u32 m0, s52, 32768
    s_nop 0
    buffer_load_dwordx4 v41, s[24:27], s70 offen lds
    s_add_u32 m0, s52, 33664
    v_mfma_f32_16x16x32_bf16 v[232:235], a[160:163], a[16:19], v[24:27]
    v_exp_f32 v76, v76
    v_mfma_f32_16x16x32_bf16 v[216:219], a[164:167], a[20:23], v[216:219]
    ds_read_b128 a[180:183], v33 offset:3072
    v_exp_f32 v77, v77
    v_mfma_f32_16x16x32_bf16 v[220:223], a[164:167], a[24:27], v[220:223]
    v_exp_f32 v78, v78
    v_mfma_f32_16x16x32_bf16 v[224:227], a[164:167], a[28:31], v[224:227]
    v_exp_f32 v79, v79
    v_mfma_f32_16x16x32_bf16 v[228:231], a[164:167], a[32:35], v[228:231]
    buffer_load_dwordx4 v41, s[24:27], s70 offen offset:128 lds
    s_add_u32 m0, s52, 49152
    v_mfma_f32_16x16x32_bf16 v[232:235], a[164:167], a[36:39], v[232:235]
    v_cvt_pk_bf16_f32 v76, v76, v77
    ds_read_b128 a[184:187], v32 offset:2048
    s_waitcnt lgkmcnt(3)
    v_mfma_f32_16x16x32_bf16 v[216:219], a[168:171], a[80:83], v[216:219]
    v_cvt_pk_bf16_f32 v77, v78, v79
    v_max3_f32 v2, v2, v80, v81
    v_max3_f32 v2, v2, v82, v83
    v_mfma_f32_16x16x32_bf16 v[220:223], a[168:171], a[84:87], v[220:223]
    v_exp_f32 v80, v80
    v_mfma_f32_16x16x32_bf16 v[224:227], a[168:171], a[88:91], v[224:227]
    s_add_u32 s57, s70, 16384
    buffer_load_dwordx4 v41, s[24:27], s57 offen lds
    s_add_u32 m0, s52, 50048
    v_mfma_f32_16x16x32_bf16 v[228:231], a[168:171], a[92:95], v[228:231]
    v_exp_f32 v81, v81
    v_mfma_f32_16x16x32_bf16 v[232:235], a[168:171], a[96:99], v[232:235]
    ds_read_b128 a[188:191], v32 offset:3072
    v_exp_f32 v82, v82
    v_mfma_f32_16x16x32_bf16 v[216:219], a[172:175], a[100:103], v[216:219]
    v_exp_f32 v83, v83
    v_cvt_pk_bf16_f32 v80, v80, v81
    v_mfma_f32_16x16x32_bf16 v[220:223], a[172:175], a[104:107], v[220:223]
    buffer_load_dwordx4 v41, s[24:27], s57 offen offset:128 lds
    s_add_u32 m0, s52, 34560
    v_mfma_f32_16x16x32_bf16 v[224:227], a[172:175], a[108:111], v[224:227]
    v_cvt_pk_bf16_f32 v81, v82, v83
    ds_read_b128 a[192:195], v33 offset:32768
    v_mfma_f32_16x16x32_bf16 v[228:231], a[172:175], a[112:115], v[228:231]
    v_max3_f32 v3, v3, v84, v85
    v_max3_f32 v3, v3, v86, v87
    v_mfma_f32_16x16x32_bf16 v[232:235], a[172:175], a[116:119], v[232:235]
    v_exp_f32 v84, v84
    s_waitcnt lgkmcnt(3)
    v_mfma_f32_16x16x32_bf16 v[216:219], a[176:179], a[40:43], v[216:219]
    v_exp_f32 v85, v85
    v_mfma_f32_16x16x32_bf16 v[220:223], a[176:179], a[44:47], v[220:223]
    buffer_load_dwordx4 v41, s[24:27], s70 offen offset:256 lds
    s_add_u32 m0, s52, 35456
    v_mfma_f32_16x16x32_bf16 v[224:227], a[176:179], a[48:51], v[224:227]
    v_exp_f32 v86, v86
    v_mfma_f32_16x16x32_bf16 v[228:231], a[176:179], a[52:55], v[228:231]
    ds_read_b128 a[196:199], v33 offset:33792
    v_exp_f32 v87, v87
    v_mfma_f32_16x16x32_bf16 v[232:235], a[176:179], a[56:59], v[232:235]
    v_cvt_pk_bf16_f32 v84, v84, v85
    v_cvt_pk_bf16_f32 v85, v86, v87
    v_mfma_f32_16x16x32_bf16 v[216:219], a[180:183], a[60:63], v[216:219]
    buffer_load_dwordx4 v41, s[24:27], s70 offen offset:384 lds
    s_add_u32 m0, s52, 50944
    v_mfma_f32_16x16x32_bf16 v[220:223], a[180:183], a[64:67], v[220:223]
    v_max3_f32 v4, v4, v88, v89
    ds_read_b128 a[160:163], v32 offset:32768
    v_mfma_f32_16x16x32_bf16 v[224:227], a[180:183], a[68:71], v[224:227]
    v_max3_f32 v4, v4, v90, v91
    v_exp_f32 v88, v88
    v_mfma_f32_16x16x32_bf16 v[228:231], a[180:183], a[72:75], v[228:231]
    v_exp_f32 v89, v89
    v_mfma_f32_16x16x32_bf16 v[232:235], a[180:183], a[76:79], v[232:235]
    v_exp_f32 v90, v90
    s_waitcnt lgkmcnt(3)
    v_mfma_f32_16x16x32_bf16 v[216:219], a[184:187], a[120:123], v[216:219]
    buffer_load_dwordx4 v41, s[24:27], s57 offen offset:256 lds
    s_add_u32 m0, s52, 51840
    v_mfma_f32_16x16x32_bf16 v[220:223], a[184:187], a[124:127], v[220:223]
    ds_read_b128 a[164:167], v32 offset:33792
    v_mfma_f32_16x16x32_bf16 v[224:227], a[184:187], a[128:131], v[224:227]
    v_exp_f32 v91, v91
    v_cvt_pk_bf16_f32 v88, v88, v89
    v_mfma_f32_16x16x32_bf16 v[228:231], a[184:187], a[132:135], v[228:231]
    v_cvt_pk_bf16_f32 v89, v90, v91
    v_max3_f32 v5, v5, v92, v93
    v_mfma_f32_16x16x32_bf16 v[232:235], a[184:187], a[136:139], v[232:235]
    v_max3_f32 v5, v5, v94, v95
    v_mfma_f32_16x16x32_bf16 v[216:219], a[188:191], a[140:143], v[216:219]
    buffer_load_dwordx4 v41, s[24:27], s57 offen offset:384 lds
    v_mfma_f32_16x16x32_bf16 v[220:223], a[188:191], a[144:147], v[220:223]
    v_exp_f32 v92, v92
    v_mfma_f32_16x16x32_bf16 v[224:227], a[188:191], a[148:151], v[224:227]
    v_exp_f32 v93, v93
    v_mfma_f32_16x16x32_bf16 v[228:231], a[188:191], a[152:155], v[228:231]
    v_exp_f32 v94, v94
    v_exp_f32 v95, v95
    v_mfma_f32_16x16x32_bf16 v[232:235], a[188:191], a[156:159], v[232:235]
    v_cvt_pk_bf16_f32 v92, v92, v93
    v_cvt_pk_bf16_f32 v93, v94, v95
    s_waitcnt vmcnt(12)
    s_barrier
    s_waitcnt lgkmcnt(2)
    v_mfma_f32_16x16x32_bf16 v[96:99], a[192:195], a[0:3], v[8:11]
    v_mfma_f32_16x16x32_bf16 v[100:103], a[192:195], a[4:7], v[12:15]
    ds_read_b128 a[168:171], v33 offset:34816
    v_max3_f32 v1, v1, v216, v217
    v_mfma_f32_16x16x32_bf16 v[104:107], a[192:195], a[8:11], v[16:19]
    v_max3_f32 v1, v1, v218, v219
    v_mfma_f32_16x16x32_bf16 v[108:111], a[192:195], a[12:15], v[20:23]
    s_add_u32 m0, s52, 65536
    s_nop 0
    buffer_load_dwordx4 v41, s[24:27], s71 offen lds
    s_add_u32 m0, s52, 66432
    v_mfma_f32_16x16x32_bf16 v[112:115], a[192:195], a[16:19], v[24:27]
    v_exp_f32 v216, v216
    v_mfma_f32_16x16x32_bf16 v[96:99], a[196:199], a[20:23], v[96:99]
    ds_read_b128 a[172:175], v33 offset:35840
    v_exp_f32 v217, v217
    v_mfma_f32_16x16x32_bf16 v[100:103], a[196:199], a[24:27], v[100:103]
    v_exp_f32 v218, v218
    v_mfma_f32_16x16x32_bf16 v[104:107], a[196:199], a[28:31], v[104:107]
    v_exp_f32 v219, v219
    v_mfma_f32_16x16x32_bf16 v[108:111], a[196:199], a[32:35], v[108:111]
    buffer_load_dwordx4 v41, s[24:27], s71 offen offset:128 lds
    s_add_u32 m0, s52, 81920
    v_mfma_f32_16x16x32_bf16 v[112:115], a[196:199], a[36:39], v[112:115]
    v_cvt_pk_bf16_f32 v78, v216, v217
    ds_read_b128 a[176:179], v32 offset:34816
    s_waitcnt lgkmcnt(3)
    v_mfma_f32_16x16x32_bf16 v[96:99], a[160:163], a[80:83], v[96:99]
    v_cvt_pk_bf16_f32 v79, v218, v219
    v_max3_f32 v2, v2, v220, v221
    v_max3_f32 v2, v2, v222, v223
    v_mfma_f32_16x16x32_bf16 v[100:103], a[160:163], a[84:87], v[100:103]
    v_exp_f32 v220, v220
    v_mfma_f32_16x16x32_bf16 v[104:107], a[160:163], a[88:91], v[104:107]
    s_add_u32 s57, s71, 16384
    buffer_load_dwordx4 v41, s[24:27], s57 offen lds
    s_add_u32 m0, s52, 82816
    v_mfma_f32_16x16x32_bf16 v[108:111], a[160:163], a[92:95], v[108:111]
    v_exp_f32 v221, v221
    v_mfma_f32_16x16x32_bf16 v[112:115], a[160:163], a[96:99], v[112:115]
    ds_read_b128 a[180:183], v32 offset:35840
    v_exp_f32 v222, v222
    v_mfma_f32_16x16x32_bf16 v[96:99], a[164:167], a[100:103], v[96:99]
    v_exp_f32 v223, v223
    v_cvt_pk_bf16_f32 v82, v220, v221
    v_mfma_f32_16x16x32_bf16 v[100:103], a[164:167], a[104:107], v[100:103]
    buffer_load_dwordx4 v41, s[24:27], s57 offen offset:128 lds
    s_add_u32 m0, s52, 67328
    v_mfma_f32_16x16x32_bf16 v[104:107], a[164:167], a[108:111], v[104:107]
    v_cvt_pk_bf16_f32 v83, v222, v223
    v_xor_b32 v32, 0x10000, v32
    v_xor_b32 v33, 0x10000, v33
    ds_read_b128 a[184:187], v33 offset:0
    v_mfma_f32_16x16x32_bf16 v[108:111], a[164:167], a[112:115], v[108:111]
    v_max3_f32 v3, v3, v224, v225
    v_max3_f32 v3, v3, v226, v227
    v_mfma_f32_16x16x32_bf16 v[112:115], a[164:167], a[116:119], v[112:115]
    v_exp_f32 v224, v224
    s_waitcnt lgkmcnt(3)
    v_mfma_f32_16x16x32_bf16 v[96:99], a[168:171], a[40:43], v[96:99]
    v_exp_f32 v225, v225
    v_mfma_f32_16x16x32_bf16 v[100:103], a[168:171], a[44:47], v[100:103]
    buffer_load_dwordx4 v41, s[24:27], s71 offen offset:256 lds
    s_add_u32 m0, s52, 68224
    v_mfma_f32_16x16x32_bf16 v[104:107], a[168:171], a[48:51], v[104:107]
    v_exp_f32 v226, v226
    v_mfma_f32_16x16x32_bf16 v[108:111], a[168:171], a[52:55], v[108:111]
    ds_read_b128 a[188:191], v33 offset:1024
    v_exp_f32 v227, v227
    v_mfma_f32_16x16x32_bf16 v[112:115], a[168:171], a[56:59], v[112:115]
    v_cvt_pk_bf16_f32 v86, v224, v225
    v_cvt_pk_bf16_f32 v87, v226, v227
    v_mfma_f32_16x16x32_bf16 v[96:99], a[172:175], a[60:63], v[96:99]
    buffer_load_dwordx4 v41, s[24:27], s71 offen offset:384 lds
    s_add_u32 m0, s52, 83712
    v_mfma_f32_16x16x32_bf16 v[100:103], a[172:175], a[64:67], v[100:103]
    v_max3_f32 v4, v4, v228, v229
    ds_read_b128 a[192:195], v32 offset:0
    v_mfma_f32_16x16x32_bf16 v[104:107], a[172:175], a[68:71], v[104:107]
    v_max3_f32 v4, v4, v230, v231
    v_exp_f32 v228, v228
    v_mfma_f32_16x16x32_bf16 v[108:111], a[172:175], a[72:75], v[108:111]
    v_exp_f32 v229, v229
    v_mfma_f32_16x16x32_bf16 v[112:115], a[172:175], a[76:79], v[112:115]
    v_exp_f32 v230, v230
    s_waitcnt lgkmcnt(3)
    v_mfma_f32_16x16x32_bf16 v[96:99], a[176:179], a[120:123], v[96:99]
    buffer_load_dwordx4 v41, s[24:27], s57 offen offset:256 lds
    s_add_u32 m0, s52, 84608
    v_mfma_f32_16x16x32_bf16 v[100:103], a[176:179], a[124:127], v[100:103]
    ds_read_b128 a[196:199], v32 offset:1024
    v_mfma_f32_16x16x32_bf16 v[104:107], a[176:179], a[128:131], v[104:107]
    v_exp_f32 v231, v231
    v_cvt_pk_bf16_f32 v90, v228, v229
    v_mfma_f32_16x16x32_bf16 v[108:111], a[176:179], a[132:135], v[108:111]
    v_cvt_pk_bf16_f32 v91, v230, v231
    v_max3_f32 v5, v5, v232, v233
    v_mfma_f32_16x16x32_bf16 v[112:115], a[176:179], a[136:139], v[112:115]
    v_max3_f32 v5, v5, v234, v235
    v_mfma_f32_16x16x32_bf16 v[96:99], a[180:183], a[140:143], v[96:99]
    buffer_load_dwordx4 v41, s[24:27], s57 offen offset:384 lds
    v_mfma_f32_16x16x32_bf16 v[100:103], a[180:183], a[144:147], v[100:103]
    v_exp_f32 v232, v232
    v_mfma_f32_16x16x32_bf16 v[104:107], a[180:183], a[148:151], v[104:107]
    v_exp_f32 v233, v233
    v_mfma_f32_16x16x32_bf16 v[108:111], a[180:183], a[152:155], v[108:111]
    v_exp_f32 v234, v234
    v_exp_f32 v235, v235
    v_mfma_f32_16x16x32_bf16 v[112:115], a[180:183], a[156:159], v[112:115]
    v_cvt_pk_bf16_f32 v94, v232, v233
    v_cvt_pk_bf16_f32 v95, v234, v235
    s_waitcnt vmcnt(12)
    s_barrier
    s_waitcnt lgkmcnt(2)
    v_mfma_f32_16x16x32_bf16 v[216:219], a[184:187], a[0:3], v[8:11]
    v_mfma_f32_16x16x32_bf16 v[220:223], a[184:187], a[4:7], v[12:15]
    ds_read_b128 a[160:163], v33 offset:2048
    v_max3_f32 v1, v1, v96, v97
    v_mfma_f32_16x16x32_bf16 v[224:227], a[184:187], a[8:11], v[16:19]
    v_max3_f32 v1, v1, v98, v99
    v_mfma_f32_16x16x32_bf16 v[228:231], a[184:187], a[12:15], v[20:23]
    s_add_u32 m0, s52, 98304
    s_nop 0
    buffer_load_dwordx4 v41, s[24:27], s72 offen lds
    s_add_u32 m0, s52, 99200
    v_mfma_f32_16x16x32_bf16 v[232:235], a[184:187], a[16:19], v[24:27]
    v_exp_f32 v96, v96
    v_mfma_f32_16x16x32_bf16 v[216:219], a[188:191], a[20:23], v[216:219]
    ds_read_b128 a[164:167], v33 offset:3072
    v_exp_f32 v97, v97
    v_mfma_f32_16x16x32_bf16 v[220:223], a[188:191], a[24:27], v[220:223]
    v_exp_f32 v98, v98
    v_mfma_f32_16x16x32_bf16 v[224:227], a[188:191], a[28:31], v[224:227]
    v_exp_f32 v99, v99
    v_mfma_f32_16x16x32_bf16 v[228:231], a[188:191], a[32:35], v[228:231]
    buffer_load_dwordx4 v41, s[24:27], s72 offen offset:128 lds
    s_add_u32 m0, s52, 114688
    v_mfma_f32_16x16x32_bf16 v[232:235], a[188:191], a[36:39], v[232:235]
    v_cvt_pk_bf16_f32 v96, v96, v97
    ds_read_b128 a[168:171], v32 offset:2048
    s_waitcnt lgkmcnt(3)
    v_mfma_f32_16x16x32_bf16 v[216:219], a[192:195], a[80:83], v[216:219]
    v_cvt_pk_bf16_f32 v97, v98, v99
    v_max3_f32 v2, v2, v100, v101
    v_max3_f32 v2, v2, v102, v103
    v_mfma_f32_16x16x32_bf16 v[220:223], a[192:195], a[84:87], v[220:223]
    v_exp_f32 v100, v100
    v_mfma_f32_16x16x32_bf16 v[224:227], a[192:195], a[88:91], v[224:227]
    s_add_u32 s57, s72, 16384
    buffer_load_dwordx4 v41, s[24:27], s57 offen lds
    s_add_u32 m0, s52, 115584
    v_mfma_f32_16x16x32_bf16 v[228:231], a[192:195], a[92:95], v[228:231]
    v_exp_f32 v101, v101
    v_mfma_f32_16x16x32_bf16 v[232:235], a[192:195], a[96:99], v[232:235]
    ds_read_b128 a[172:175], v32 offset:3072
    v_exp_f32 v102, v102
    v_mfma_f32_16x16x32_bf16 v[216:219], a[196:199], a[100:103], v[216:219]
    v_exp_f32 v103, v103
    v_cvt_pk_bf16_f32 v100, v100, v101
    v_mfma_f32_16x16x32_bf16 v[220:223], a[196:199], a[104:107], v[220:223]
    buffer_load_dwordx4 v41, s[24:27], s57 offen offset:128 lds
    s_add_u32 m0, s52, 100096
    v_mfma_f32_16x16x32_bf16 v[224:227], a[196:199], a[108:111], v[224:227]
    v_cvt_pk_bf16_f32 v101, v102, v103
    ds_read_b128 a[176:179], v33 offset:32768
    v_mfma_f32_16x16x32_bf16 v[228:231], a[196:199], a[112:115], v[228:231]
    v_max3_f32 v3, v3, v104, v105
    v_max3_f32 v3, v3, v106, v107
    v_mfma_f32_16x16x32_bf16 v[232:235], a[196:199], a[116:119], v[232:235]
    v_exp_f32 v104, v104
    s_waitcnt lgkmcnt(3)
    v_mfma_f32_16x16x32_bf16 v[216:219], a[160:163], a[40:43], v[216:219]
    v_exp_f32 v105, v105
    v_mfma_f32_16x16x32_bf16 v[220:223], a[160:163], a[44:47], v[220:223]
    buffer_load_dwordx4 v41, s[24:27], s72 offen offset:256 lds
    s_add_u32 m0, s52, 100992
    v_mfma_f32_16x16x32_bf16 v[224:227], a[160:163], a[48:51], v[224:227]
    v_exp_f32 v106, v106
    v_mfma_f32_16x16x32_bf16 v[228:231], a[160:163], a[52:55], v[228:231]
    ds_read_b128 a[180:183], v33 offset:33792
    v_exp_f32 v107, v107
    v_mfma_f32_16x16x32_bf16 v[232:235], a[160:163], a[56:59], v[232:235]
    v_cvt_pk_bf16_f32 v104, v104, v105
    v_cvt_pk_bf16_f32 v105, v106, v107
    v_mfma_f32_16x16x32_bf16 v[216:219], a[164:167], a[60:63], v[216:219]
    buffer_load_dwordx4 v41, s[24:27], s72 offen offset:384 lds
    s_add_u32 m0, s52, 116480
    v_mfma_f32_16x16x32_bf16 v[220:223], a[164:167], a[64:67], v[220:223]
    v_max3_f32 v4, v4, v108, v109
    ds_read_b128 a[184:187], v32 offset:32768
    v_mfma_f32_16x16x32_bf16 v[224:227], a[164:167], a[68:71], v[224:227]
    v_max3_f32 v4, v4, v110, v111
    v_exp_f32 v108, v108
    v_mfma_f32_16x16x32_bf16 v[228:231], a[164:167], a[72:75], v[228:231]
    v_exp_f32 v109, v109
    v_mfma_f32_16x16x32_bf16 v[232:235], a[164:167], a[76:79], v[232:235]
    v_exp_f32 v110, v110
    s_waitcnt lgkmcnt(3)
    v_mfma_f32_16x16x32_bf16 v[216:219], a[168:171], a[120:123], v[216:219]
    buffer_load_dwordx4 v41, s[24:27], s57 offen offset:256 lds
    s_add_u32 m0, s52, 117376
    v_mfma_f32_16x16x32_bf16 v[220:223], a[168:171], a[124:127], v[220:223]
    ds_read_b128 a[188:191], v32 offset:33792
    v_mfma_f32_16x16x32_bf16 v[224:227], a[168:171], a[128:131], v[224:227]
    v_exp_f32 v111, v111
    v_cvt_pk_bf16_f32 v108, v108, v109
    v_mfma_f32_16x16x32_bf16 v[228:231], a[168:171], a[132:135], v[228:231]
    v_cvt_pk_bf16_f32 v109, v110, v111
    v_max3_f32 v5, v5, v112, v113
    v_mfma_f32_16x16x32_bf16 v[232:235], a[168:171], a[136:139], v[232:235]
    v_max3_f32 v5, v5, v114, v115
    v_mfma_f32_16x16x32_bf16 v[216:219], a[172:175], a[140:143], v[216:219]
    buffer_load_dwordx4 v41, s[24:27], s57 offen offset:384 lds
    v_mfma_f32_16x16x32_bf16 v[220:223], a[172:175], a[144:147], v[220:223]
    v_exp_f32 v112, v112
    v_mfma_f32_16x16x32_bf16 v[224:227], a[172:175], a[148:151], v[224:227]
    v_exp_f32 v113, v113
    v_mfma_f32_16x16x32_bf16 v[228:231], a[172:175], a[152:155], v[228:231]
    v_exp_f32 v114, v114
    v_exp_f32 v115, v115
    v_mfma_f32_16x16x32_bf16 v[232:235], a[172:175], a[156:159], v[232:235]
    v_cvt_pk_bf16_f32 v112, v112, v113
    v_cvt_pk_bf16_f32 v113, v114, v115
    s_waitcnt vmcnt(12)
    s_barrier
    s_waitcnt lgkmcnt(2)
    v_mfma_f32_16x16x32_bf16 v[116:119], a[176:179], a[0:3], v[8:11]
    v_mfma_f32_16x16x32_bf16 v[120:123], a[176:179], a[4:7], v[12:15]
    ds_read_b128 a[192:195], v33 offset:34816
    v_max3_f32 v1, v1, v216, v217
    v_mfma_f32_16x16x32_bf16 v[124:127], a[176:179], a[8:11], v[16:19]
    v_max3_f32 v1, v1, v218, v219
    v_mfma_f32_16x16x32_bf16 v[128:131], a[176:179], a[12:15], v[20:23]
    s_add_u32 m0, s52, 0
    s_nop 0
    buffer_load_dwordx4 v41, s[24:27], s73 offen lds
    s_add_u32 m0, s52, 896
    v_mfma_f32_16x16x32_bf16 v[132:135], a[176:179], a[16:19], v[24:27]
    v_exp_f32 v216, v216
    v_mfma_f32_16x16x32_bf16 v[116:119], a[180:183], a[20:23], v[116:119]
    ds_read_b128 a[196:199], v33 offset:35840
    v_exp_f32 v217, v217
    v_mfma_f32_16x16x32_bf16 v[120:123], a[180:183], a[24:27], v[120:123]
    v_exp_f32 v218, v218
    v_mfma_f32_16x16x32_bf16 v[124:127], a[180:183], a[28:31], v[124:127]
    v_exp_f32 v219, v219
    v_mfma_f32_16x16x32_bf16 v[128:131], a[180:183], a[32:35], v[128:131]
    buffer_load_dwordx4 v41, s[24:27], s73 offen offset:128 lds
    s_add_u32 m0, s52, 16384
    v_mfma_f32_16x16x32_bf16 v[132:135], a[180:183], a[36:39], v[132:135]
    v_cvt_pk_bf16_f32 v98, v216, v217
    ds_read_b128 a[160:163], v32 offset:34816
    s_waitcnt lgkmcnt(3)
    v_mfma_f32_16x16x32_bf16 v[116:119], a[184:187], a[80:83], v[116:119]
    v_cvt_pk_bf16_f32 v99, v218, v219
    v_max3_f32 v2, v2, v220, v221
    v_max3_f32 v2, v2, v222, v223
    v_mfma_f32_16x16x32_bf16 v[120:123], a[184:187], a[84:87], v[120:123]
    v_exp_f32 v220, v220
    v_mfma_f32_16x16x32_bf16 v[124:127], a[184:187], a[88:91], v[124:127]
    s_add_u32 s57, s73, 16384
    buffer_load_dwordx4 v41, s[24:27], s57 offen lds
    s_add_u32 m0, s52, 17280
    v_mfma_f32_16x16x32_bf16 v[128:131], a[184:187], a[92:95], v[128:131]
    v_exp_f32 v221, v221
    v_mfma_f32_16x16x32_bf16 v[132:135], a[184:187], a[96:99], v[132:135]
    ds_read_b128 a[164:167], v32 offset:35840
    v_exp_f32 v222, v222
    v_mfma_f32_16x16x32_bf16 v[116:119], a[188:191], a[100:103], v[116:119]
    v_exp_f32 v223, v223
    v_cvt_pk_bf16_f32 v102, v220, v221
    v_mfma_f32_16x16x32_bf16 v[120:123], a[188:191], a[104:107], v[120:123]
    buffer_load_dwordx4 v41, s[24:27], s57 offen offset:128 lds
    s_add_u32 m0, s52, 1792
    v_mfma_f32_16x16x32_bf16 v[124:127], a[188:191], a[108:111], v[124:127]
    v_cvt_pk_bf16_f32 v103, v222, v223
    v_xor_b32 v32, 0x10000, v32
    v_xor_b32 v33, 0x10000, v33
    ds_read_b128 a[168:171], v33 offset:0
    v_mfma_f32_16x16x32_bf16 v[128:131], a[188:191], a[112:115], v[128:131]
    v_max3_f32 v3, v3, v224, v225
    v_max3_f32 v3, v3, v226, v227
    v_mfma_f32_16x16x32_bf16 v[132:135], a[188:191], a[116:119], v[132:135]
    v_exp_f32 v224, v224
    s_waitcnt lgkmcnt(3)
    v_mfma_f32_16x16x32_bf16 v[116:119], a[192:195], a[40:43], v[116:119]
    v_exp_f32 v225, v225
    v_mfma_f32_16x16x32_bf16 v[120:123], a[192:195], a[44:47], v[120:123]
    buffer_load_dwordx4 v41, s[24:27], s73 offen offset:256 lds
    s_add_u32 m0, s52, 2688
    v_mfma_f32_16x16x32_bf16 v[124:127], a[192:195], a[48:51], v[124:127]
    v_exp_f32 v226, v226
    v_mfma_f32_16x16x32_bf16 v[128:131], a[192:195], a[52:55], v[128:131]
    ds_read_b128 a[172:175], v33 offset:1024
    v_exp_f32 v227, v227
    v_mfma_f32_16x16x32_bf16 v[132:135], a[192:195], a[56:59], v[132:135]
    v_cvt_pk_bf16_f32 v106, v224, v225
    v_cvt_pk_bf16_f32 v107, v226, v227
    v_mfma_f32_16x16x32_bf16 v[116:119], a[196:199], a[60:63], v[116:119]
    buffer_load_dwordx4 v41, s[24:27], s73 offen offset:384 lds
    s_add_u32 m0, s52, 18176
    v_mfma_f32_16x16x32_bf16 v[120:123], a[196:199], a[64:67], v[120:123]
    v_max3_f32 v4, v4, v228, v229
    ds_read_b128 a[176:179], v32 offset:0
    v_mfma_f32_16x16x32_bf16 v[124:127], a[196:199], a[68:71], v[124:127]
    v_max3_f32 v4, v4, v230, v231
    v_exp_f32 v228, v228
    v_mfma_f32_16x16x32_bf16 v[128:131], a[196:199], a[72:75], v[128:131]
    v_exp_f32 v229, v229
    v_mfma_f32_16x16x32_bf16 v[132:135], a[196:199], a[76:79], v[132:135]
    v_exp_f32 v230, v230
    s_waitcnt lgkmcnt(3)
    v_mfma_f32_16x16x32_bf16 v[116:119], a[160:163], a[120:123], v[116:119]
    buffer_load_dwordx4 v41, s[24:27], s57 offen offset:256 lds
    s_add_u32 m0, s52, 19072
    v_mfma_f32_16x16x32_bf16 v[120:123], a[160:163], a[124:127], v[120:123]
    ds_read_b128 a[180:183], v32 offset:1024
    v_mfma_f32_16x16x32_bf16 v[124:127], a[160:163], a[128:131], v[124:127]
    v_exp_f32 v231, v231
    v_cvt_pk_bf16_f32 v110, v228, v229
    v_mfma_f32_16x16x32_bf16 v[128:131], a[160:163], a[132:135], v[128:131]
    v_cvt_pk_bf16_f32 v111, v230, v231
    v_max3_f32 v5, v5, v232, v233
    v_mfma_f32_16x16x32_bf16 v[132:135], a[160:163], a[136:139], v[132:135]
    v_max3_f32 v5, v5, v234, v235
    v_mfma_f32_16x16x32_bf16 v[116:119], a[164:167], a[140:143], v[116:119]
    buffer_load_dwordx4 v41, s[24:27], s57 offen offset:384 lds
    v_mfma_f32_16x16x32_bf16 v[120:123], a[164:167], a[144:147], v[120:123]
    v_exp_f32 v232, v232
    v_mfma_f32_16x16x32_bf16 v[124:127], a[164:167], a[148:151], v[124:127]
    v_exp_f32 v233, v233
    v_mfma_f32_16x16x32_bf16 v[128:131], a[164:167], a[152:155], v[128:131]
    v_exp_f32 v234, v234
    v_exp_f32 v235, v235
    v_mfma_f32_16x16x32_bf16 v[132:135], a[164:167], a[156:159], v[132:135]
    v_cvt_pk_bf16_f32 v114, v232, v233
    v_cvt_pk_bf16_f32 v115, v234, v235
    s_waitcnt vmcnt(12)
    s_barrier
    s_waitcnt lgkmcnt(2)
    v_mfma_f32_16x16x32_bf16 v[216:219], a[168:171], a[0:3], v[8:11]
    v_mfma_f32_16x16x32_bf16 v[220:223], a[168:171], a[4:7], v[12:15]
    ds_read_b128 a[184:187], v33 offset:2048
    v_max3_f32 v1, v1, v116, v117
    v_mfma_f32_16x16x32_bf16 v[224:227], a[168:171], a[8:11], v[16:19]
    v_max3_f32 v1, v1, v118, v119
    v_mfma_f32_16x16x32_bf16 v[228:231], a[168:171], a[12:15], v[20:23]
    s_add_u32 m0, s52, 32768
    s_nop 0
    buffer_load_dwordx4 v41, s[24:27], s74 offen lds
    s_add_u32 m0, s52, 33664
    v_mfma_f32_16x16x32_bf16 v[232:235], a[168:171], a[16:19], v[24:27]
    v_exp_f32 v116, v116
    v_mfma_f32_16x16x32_bf16 v[216:219], a[172:175], a[20:23], v[216:219]
    ds_read_b128 a[188:191], v33 offset:3072
    v_exp_f32 v117, v117
    v_mfma_f32_16x16x32_bf16 v[220:223], a[172:175], a[24:27], v[220:223]
    v_exp_f32 v118, v118
    v_mfma_f32_16x16x32_bf16 v[224:227], a[172:175], a[28:31], v[224:227]
    v_exp_f32 v119, v119
    v_mfma_f32_16x16x32_bf16 v[228:231], a[172:175], a[32:35], v[228:231]
    buffer_load_dwordx4 v41, s[24:27], s74 offen offset:128 lds
    s_add_u32 m0, s52, 49152
    v_mfma_f32_16x16x32_bf16 v[232:235], a[172:175], a[36:39], v[232:235]
    v_cvt_pk_bf16_f32 v116, v116, v117
    ds_read_b128 a[192:195], v32 offset:2048
    s_waitcnt lgkmcnt(3)
    v_mfma_f32_16x16x32_bf16 v[216:219], a[176:179], a[80:83], v[216:219]
    v_cvt_pk_bf16_f32 v117, v118, v119
    v_max3_f32 v2, v2, v120, v121
    v_max3_f32 v2, v2, v122, v123
    v_mfma_f32_16x16x32_bf16 v[220:223], a[176:179], a[84:87], v[220:223]
    v_exp_f32 v120, v120
    v_mfma_f32_16x16x32_bf16 v[224:227], a[176:179], a[88:91], v[224:227]
    s_add_u32 s57, s74, 16384
    buffer_load_dwordx4 v41, s[24:27], s57 offen lds
    s_add_u32 m0, s52, 50048
    v_mfma_f32_16x16x32_bf16 v[228:231], a[176:179], a[92:95], v[228:231]
    v_exp_f32 v121, v121
    v_mfma_f32_16x16x32_bf16 v[232:235], a[176:179], a[96:99], v[232:235]
    ds_read_b128 a[196:199], v32 offset:3072
    v_exp_f32 v122, v122
    v_mfma_f32_16x16x32_bf16 v[216:219], a[180:183], a[100:103], v[216:219]
    v_exp_f32 v123, v123
    v_cvt_pk_bf16_f32 v120, v120, v121
    v_mfma_f32_16x16x32_bf16 v[220:223], a[180:183], a[104:107], v[220:223]
    buffer_load_dwordx4 v41, s[24:27], s57 offen offset:128 lds
    s_add_u32 m0, s52, 34560
    v_mfma_f32_16x16x32_bf16 v[224:227], a[180:183], a[108:111], v[224:227]
    v_cvt_pk_bf16_f32 v121, v122, v123
    ds_read_b128 a[160:163], v33 offset:32768
    v_mfma_f32_16x16x32_bf16 v[228:231], a[180:183], a[112:115], v[228:231]
    v_max3_f32 v3, v3, v124, v125
    v_max3_f32 v3, v3, v126, v127
    v_mfma_f32_16x16x32_bf16 v[232:235], a[180:183], a[116:119], v[232:235]
    v_exp_f32 v124, v124
    s_waitcnt lgkmcnt(3)
    v_mfma_f32_16x16x32_bf16 v[216:219], a[184:187], a[40:43], v[216:219]
    v_exp_f32 v125, v125
    v_mfma_f32_16x16x32_bf16 v[220:223], a[184:187], a[44:47], v[220:223]
    buffer_load_dwordx4 v41, s[24:27], s74 offen offset:256 lds
    s_add_u32 m0, s52, 35456
    v_mfma_f32_16x16x32_bf16 v[224:227], a[184:187], a[48:51], v[224:227]
    v_exp_f32 v126, v126
    v_mfma_f32_16x16x32_bf16 v[228:231], a[184:187], a[52:55], v[228:231]
    ds_read_b128 a[164:167], v33 offset:33792
    v_exp_f32 v127, v127
    v_mfma_f32_16x16x32_bf16 v[232:235], a[184:187], a[56:59], v[232:235]
    v_cvt_pk_bf16_f32 v124, v124, v125
    v_cvt_pk_bf16_f32 v125, v126, v127
    v_mfma_f32_16x16x32_bf16 v[216:219], a[188:191], a[60:63], v[216:219]
    buffer_load_dwordx4 v41, s[24:27], s74 offen offset:384 lds
    s_add_u32 m0, s52, 50944
    v_mfma_f32_16x16x32_bf16 v[220:223], a[188:191], a[64:67], v[220:223]
    v_max3_f32 v4, v4, v128, v129
    ds_read_b128 a[168:171], v32 offset:32768
    v_mfma_f32_16x16x32_bf16 v[224:227], a[188:191], a[68:71], v[224:227]
    v_max3_f32 v4, v4, v130, v131
    v_exp_f32 v128, v128
    v_mfma_f32_16x16x32_bf16 v[228:231], a[188:191], a[72:75], v[228:231]
    v_exp_f32 v129, v129
    v_mfma_f32_16x16x32_bf16 v[232:235], a[188:191], a[76:79], v[232:235]
    v_exp_f32 v130, v130
    s_waitcnt lgkmcnt(3)
    v_mfma_f32_16x16x32_bf16 v[216:219], a[192:195], a[120:123], v[216:219]
    buffer_load_dwordx4 v41, s[24:27], s57 offen offset:256 lds
    s_add_u32 m0, s52, 51840
    v_mfma_f32_16x16x32_bf16 v[220:223], a[192:195], a[124:127], v[220:223]
    ds_read_b128 a[172:175], v32 offset:33792
    v_mfma_f32_16x16x32_bf16 v[224:227], a[192:195], a[128:131], v[224:227]
    v_exp_f32 v131, v131
    v_cvt_pk_bf16_f32 v128, v128, v129
    v_mfma_f32_16x16x32_bf16 v[228:231], a[192:195], a[132:135], v[228:231]
    v_cvt_pk_bf16_f32 v129, v130, v131
    v_max3_f32 v5, v5, v132, v133
    v_mfma_f32_16x16x32_bf16 v[232:235], a[192:195], a[136:139], v[232:235]
    v_max3_f32 v5, v5, v134, v135
    v_mfma_f32_16x16x32_bf16 v[216:219], a[196:199], a[140:143], v[216:219]
    buffer_load_dwordx4 v41, s[24:27], s57 offen offset:384 lds
    v_mfma_f32_16x16x32_bf16 v[220:223], a[196:199], a[144:147], v[220:223]
    v_exp_f32 v132, v132
    v_mfma_f32_16x16x32_bf16 v[224:227], a[196:199], a[148:151], v[224:227]
    v_exp_f32 v133, v133
    v_mfma_f32_16x16x32_bf16 v[228:231], a[196:199], a[152:155], v[228:231]
    v_exp_f32 v134, v134
    v_exp_f32 v135, v135
    v_mfma_f32_16x16x32_bf16 v[232:235], a[196:199], a[156:159], v[232:235]
    v_cvt_pk_bf16_f32 v132, v132, v133
    v_cvt_pk_bf16_f32 v133, v134, v135
    s_waitcnt vmcnt(12)
    s_barrier
    s_waitcnt lgkmcnt(2)
    v_mfma_f32_16x16x32_bf16 v[136:139], a[160:163], a[0:3], v[8:11]
    v_mfma_f32_16x16x32_bf16 v[140:143], a[160:163], a[4:7], v[12:15]
    ds_read_b128 a[176:179], v33 offset:34816
    v_max3_f32 v1, v1, v216, v217
    v_mfma_f32_16x16x32_bf16 v[144:147], a[160:163], a[8:11], v[16:19]
    v_max3_f32 v1, v1, v218, v219
    v_mfma_f32_16x16x32_bf16 v[148:151], a[160:163], a[12:15], v[20:23]
    s_add_u32 m0, s52, 65536
    s_nop 0
    buffer_load_dwordx4 v41, s[24:27], s75 offen lds
    s_add_u32 m0, s52, 66432
    v_mfma_f32_16x16x32_bf16 v[152:155], a[160:163], a[16:19], v[24:27]
    v_exp_f32 v216, v216
    v_mfma_f32_16x16x32_bf16 v[136:139], a[164:167], a[20:23], v[136:139]
    ds_read_b128 a[180:183], v33 offset:35840
    v_exp_f32 v217, v217
    v_mfma_f32_16x16x32_bf16 v[140:143], a[164:167], a[24:27], v[140:143]
    v_exp_f32 v218, v218
    v_mfma_f32_16x16x32_bf16 v[144:147], a[164:167], a[28:31], v[144:147]
    v_exp_f32 v219, v219
    v_mfma_f32_16x16x32_bf16 v[148:151], a[164:167], a[32:35], v[148:151]
    buffer_load_dwordx4 v41, s[24:27], s75 offen offset:128 lds
    s_add_u32 m0, s52, 81920
    v_mfma_f32_16x16x32_bf16 v[152:155], a[164:167], a[36:39], v[152:155]
    v_cvt_pk_bf16_f32 v118, v216, v217
    ds_read_b128 a[184:187], v32 offset:34816
    s_waitcnt lgkmcnt(3)
    v_mfma_f32_16x16x32_bf16 v[136:139], a[168:171], a[80:83], v[136:139]
    v_cvt_pk_bf16_f32 v119, v218, v219
    v_max3_f32 v2, v2, v220, v221
    v_max3_f32 v2, v2, v222, v223
    v_mfma_f32_16x16x32_bf16 v[140:143], a[168:171], a[84:87], v[140:143]
    v_exp_f32 v220, v220
    v_mfma_f32_16x16x32_bf16 v[144:147], a[168:171], a[88:91], v[144:147]
    s_add_u32 s57, s75, 16384
    buffer_load_dwordx4 v41, s[24:27], s57 offen lds
    s_add_u32 m0, s52, 82816
    v_mfma_f32_16x16x32_bf16 v[148:151], a[168:171], a[92:95], v[148:151]
    v_exp_f32 v221, v221
    v_mfma_f32_16x16x32_bf16 v[152:155], a[168:171], a[96:99], v[152:155]
    ds_read_b128 a[188:191], v32 offset:35840
    v_exp_f32 v222, v222
    v_mfma_f32_16x16x32_bf16 v[136:139], a[172:175], a[100:103], v[136:139]
    v_exp_f32 v223, v223
    v_cvt_pk_bf16_f32 v122, v220, v221
    v_mfma_f32_16x16x32_bf16 v[140:143], a[172:175], a[104:107], v[140:143]
    buffer_load_dwordx4 v41, s[24:27], s57 offen offset:128 lds
    s_add_u32 m0, s52, 67328
    v_mfma_f32_16x16x32_bf16 v[144:147], a[172:175], a[108:111], v[144:147]
    v_cvt_pk_bf16_f32 v123, v222, v223
    v_xor_b32 v32, 0x10000, v32
    v_xor_b32 v33, 0x10000, v33
    ds_read_b128 a[192:195], v33 offset:0
    v_mfma_f32_16x16x32_bf16 v[148:151], a[172:175], a[112:115], v[148:151]
    v_max3_f32 v3, v3, v224, v225
    v_max3_f32 v3, v3, v226, v227
    v_mfma_f32_16x16x32_bf16 v[152:155], a[172:175], a[116:119], v[152:155]
    v_exp_f32 v224, v224
    s_waitcnt lgkmcnt(3)
    v_mfma_f32_16x16x32_bf16 v[136:139], a[176:179], a[40:43], v[136:139]
    v_exp_f32 v225, v225
    v_mfma_f32_16x16x32_bf16 v[140:143], a[176:179], a[44:47], v[140:143]
    buffer_load_dwordx4 v41, s[24:27], s75 offen offset:256 lds
    s_add_u32 m0, s52, 68224
    v_mfma_f32_16x16x32_bf16 v[144:147], a[176:179], a[48:51], v[144:147]
    v_exp_f32 v226, v226
    v_mfma_f32_16x16x32_bf16 v[148:151], a[176:179], a[52:55], v[148:151]
    ds_read_b128 a[196:199], v33 offset:1024
    v_exp_f32 v227, v227
    v_mfma_f32_16x16x32_bf16 v[152:155], a[176:179], a[56:59], v[152:155]
    v_cvt_pk_bf16_f32 v126, v224, v225
    v_cvt_pk_bf16_f32 v127, v226, v227
    v_mfma_f32_16x16x32_bf16 v[136:139], a[180:183], a[60:63], v[136:139]
    buffer_load_dwordx4 v41, s[24:27], s75 offen offset:384 lds
    s_add_u32 m0, s52, 83712
    v_mfma_f32_16x16x32_bf16 v[140:143], a[180:183], a[64:67], v[140:143]
    v_max3_f32 v4, v4, v228, v229
    ds_read_b128 a[160:163], v32 offset:0
    v_mfma_f32_16x16x32_bf16 v[144:147], a[180:183], a[68:71], v[144:147]
    v_max3_f32 v4, v4, v230, v231
    v_exp_f32 v228, v228
    v_mfma_f32_16x16x32_bf16 v[148:151], a[180:183], a[72:75], v[148:151]
    v_exp_f32 v229, v229
    v_mfma_f32_16x16x32_bf16 v[152:155], a[180:183], a[76:79], v[152:155]
    v_exp_f32 v230, v230
    s_waitcnt lgkmcnt(3)
    v_mfma_f32_16x16x32_bf16 v[136:139], a[184:187], a[120:123], v[136:139]
    buffer_load_dwordx4 v41, s[24:27], s57 offen offset:256 lds
    s_add_u32 m0, s52, 84608
    v_mfma_f32_16x16x32_bf16 v[140:143], a[184:187], a[124:127], v[140:143]
    ds_read_b128 a[164:167], v32 offset:1024
    v_mfma_f32_16x16x32_bf16 v[144:147], a[184:187], a[128:131], v[144:147]
    v_exp_f32 v231, v231
    v_cvt_pk_bf16_f32 v130, v228, v229
    v_mfma_f32_16x16x32_bf16 v[148:151], a[184:187], a[132:135], v[148:151]
    v_cvt_pk_bf16_f32 v131, v230, v231
    v_max3_f32 v5, v5, v232, v233
    v_mfma_f32_16x16x32_bf16 v[152:155], a[184:187], a[136:139], v[152:155]
    v_max3_f32 v5, v5, v234, v235
    v_mfma_f32_16x16x32_bf16 v[136:139], a[188:191], a[140:143], v[136:139]
    buffer_load_dwordx4 v41, s[24:27], s57 offen offset:384 lds
    v_mfma_f32_16x16x32_bf16 v[140:143], a[188:191], a[144:147], v[140:143]
    v_exp_f32 v232, v232
    v_mfma_f32_16x16x32_bf16 v[144:147], a[188:191], a[148:151], v[144:147]
    v_exp_f32 v233, v233
    v_mfma_f32_16x16x32_bf16 v[148:151], a[188:191], a[152:155], v[148:151]
    v_exp_f32 v234, v234
    v_exp_f32 v235, v235
    v_mfma_f32_16x16x32_bf16 v[152:155], a[188:191], a[156:159], v[152:155]
    v_cvt_pk_bf16_f32 v134, v232, v233
    v_cvt_pk_bf16_f32 v135, v234, v235
    s_waitcnt vmcnt(12)
    s_barrier
    s_waitcnt lgkmcnt(2)
    v_mfma_f32_16x16x32_bf16 v[216:219], a[192:195], a[0:3], v[8:11]
    v_mfma_f32_16x16x32_bf16 v[220:223], a[192:195], a[4:7], v[12:15]
    ds_read_b128 a[168:171], v33 offset:2048
    v_max3_f32 v1, v1, v136, v137
    v_mfma_f32_16x16x32_bf16 v[224:227], a[192:195], a[8:11], v[16:19]
    v_max3_f32 v1, v1, v138, v139
    v_mfma_f32_16x16x32_bf16 v[228:231], a[192:195], a[12:15], v[20:23]
    s_add_u32 m0, s52, 98304
    s_nop 0
    buffer_load_dwordx4 v41, s[24:27], s76 offen lds
    s_add_u32 m0, s52, 99200
    v_mfma_f32_16x16x32_bf16 v[232:235], a[192:195], a[16:19], v[24:27]
    v_exp_f32 v136, v136
    v_mfma_f32_16x16x32_bf16 v[216:219], a[196:199], a[20:23], v[216:219]
    ds_read_b128 a[172:175], v33 offset:3072
    v_exp_f32 v137, v137
    v_mfma_f32_16x16x32_bf16 v[220:223], a[196:199], a[24:27], v[220:223]
    v_exp_f32 v138, v138
    v_mfma_f32_16x16x32_bf16 v[224:227], a[196:199], a[28:31], v[224:227]
    v_exp_f32 v139, v139
    v_mfma_f32_16x16x32_bf16 v[228:231], a[196:199], a[32:35], v[228:231]
    buffer_load_dwordx4 v41, s[24:27], s76 offen offset:128 lds
    s_add_u32 m0, s52, 114688
    v_mfma_f32_16x16x32_bf16 v[232:235], a[196:199], a[36:39], v[232:235]
    v_cvt_pk_bf16_f32 v136, v136, v137
    ds_read_b128 a[176:179], v32 offset:2048
    s_waitcnt lgkmcnt(3)
    v_mfma_f32_16x16x32_bf16 v[216:219], a[160:163], a[80:83], v[216:219]
    v_cvt_pk_bf16_f32 v137, v138, v139
    v_max3_f32 v2, v2, v140, v141
    v_max3_f32 v2, v2, v142, v143
    v_mfma_f32_16x16x32_bf16 v[220:223], a[160:163], a[84:87], v[220:223]
    v_exp_f32 v140, v140
    v_mfma_f32_16x16x32_bf16 v[224:227], a[160:163], a[88:91], v[224:227]
    s_add_u32 s57, s76, 16384
    buffer_load_dwordx4 v41, s[24:27], s57 offen lds
    s_add_u32 m0, s52, 115584
    v_mfma_f32_16x16x32_bf16 v[228:231], a[160:163], a[92:95], v[228:231]
    v_exp_f32 v141, v141
    v_mfma_f32_16x16x32_bf16 v[232:235], a[160:163], a[96:99], v[232:235]
    ds_read_b128 a[180:183], v32 offset:3072
    v_exp_f32 v142, v142
    v_mfma_f32_16x16x32_bf16 v[216:219], a[164:167], a[100:103], v[216:219]
    v_exp_f32 v143, v143
    v_cvt_pk_bf16_f32 v140, v140, v141
    v_mfma_f32_16x16x32_bf16 v[220:223], a[164:167], a[104:107], v[220:223]
    buffer_load_dwordx4 v41, s[24:27], s57 offen offset:128 lds
    s_add_u32 m0, s52, 100096
    v_mfma_f32_16x16x32_bf16 v[224:227], a[164:167], a[108:111], v[224:227]
    v_cvt_pk_bf16_f32 v141, v142, v143
    ds_read_b128 a[184:187], v33 offset:32768
    v_mfma_f32_16x16x32_bf16 v[228:231], a[164:167], a[112:115], v[228:231]
    v_max3_f32 v3, v3, v144, v145
    v_max3_f32 v3, v3, v146, v147
    v_mfma_f32_16x16x32_bf16 v[232:235], a[164:167], a[116:119], v[232:235]
    v_exp_f32 v144, v144
    s_waitcnt lgkmcnt(3)
    v_mfma_f32_16x16x32_bf16 v[216:219], a[168:171], a[40:43], v[216:219]
    v_exp_f32 v145, v145
    v_mfma_f32_16x16x32_bf16 v[220:223], a[168:171], a[44:47], v[220:223]
    buffer_load_dwordx4 v41, s[24:27], s76 offen offset:256 lds
    s_add_u32 m0, s52, 100992
    v_mfma_f32_16x16x32_bf16 v[224:227], a[168:171], a[48:51], v[224:227]
    v_exp_f32 v146, v146
    v_mfma_f32_16x16x32_bf16 v[228:231], a[168:171], a[52:55], v[228:231]
    ds_read_b128 a[188:191], v33 offset:33792
    v_exp_f32 v147, v147
    v_mfma_f32_16x16x32_bf16 v[232:235], a[168:171], a[56:59], v[232:235]
    v_cvt_pk_bf16_f32 v144, v144, v145
    v_cvt_pk_bf16_f32 v145, v146, v147
    v_mfma_f32_16x16x32_bf16 v[216:219], a[172:175], a[60:63], v[216:219]
    buffer_load_dwordx4 v41, s[24:27], s76 offen offset:384 lds
    s_add_u32 m0, s52, 116480
    v_mfma_f32_16x16x32_bf16 v[220:223], a[172:175], a[64:67], v[220:223]
    v_max3_f32 v4, v4, v148, v149
    ds_read_b128 a[192:195], v32 offset:32768
    v_mfma_f32_16x16x32_bf16 v[224:227], a[172:175], a[68:71], v[224:227]
    v_max3_f32 v4, v4, v150, v151
    v_exp_f32 v148, v148
    v_mfma_f32_16x16x32_bf16 v[228:231], a[172:175], a[72:75], v[228:231]
    v_exp_f32 v149, v149
    v_mfma_f32_16x16x32_bf16 v[232:235], a[172:175], a[76:79], v[232:235]
    v_exp_f32 v150, v150
    s_waitcnt lgkmcnt(3)
    v_mfma_f32_16x16x32_bf16 v[216:219], a[176:179], a[120:123], v[216:219]
    buffer_load_dwordx4 v41, s[24:27], s57 offen offset:256 lds
    s_add_u32 m0, s52, 117376
    v_mfma_f32_16x16x32_bf16 v[220:223], a[176:179], a[124:127], v[220:223]
    ds_read_b128 a[196:199], v32 offset:33792
    v_mfma_f32_16x16x32_bf16 v[224:227], a[176:179], a[128:131], v[224:227]
    v_exp_f32 v151, v151
    v_cvt_pk_bf16_f32 v148, v148, v149
    v_mfma_f32_16x16x32_bf16 v[228:231], a[176:179], a[132:135], v[228:231]
    v_cvt_pk_bf16_f32 v149, v150, v151
    v_max3_f32 v5, v5, v152, v153
    v_mfma_f32_16x16x32_bf16 v[232:235], a[176:179], a[136:139], v[232:235]
    v_max3_f32 v5, v5, v154, v155
    v_mfma_f32_16x16x32_bf16 v[216:219], a[180:183], a[140:143], v[216:219]
    buffer_load_dwordx4 v41, s[24:27], s57 offen offset:384 lds
    v_mfma_f32_16x16x32_bf16 v[220:223], a[180:183], a[144:147], v[220:223]
    v_exp_f32 v152, v152
    v_mfma_f32_16x16x32_bf16 v[224:227], a[180:183], a[148:151], v[224:227]
    v_exp_f32 v153, v153
    v_mfma_f32_16x16x32_bf16 v[228:231], a[180:183], a[152:155], v[228:231]
    v_exp_f32 v154, v154
    v_exp_f32 v155, v155
    v_mfma_f32_16x16x32_bf16 v[232:235], a[180:183], a[156:159], v[232:235]
    v_cvt_pk_bf16_f32 v152, v152, v153
    v_cvt_pk_bf16_f32 v153, v154, v155
    s_waitcnt vmcnt(12)
    s_barrier
    s_waitcnt lgkmcnt(2)
    v_mfma_f32_16x16x32_bf16 v[156:159], a[184:187], a[0:3], v[8:11]
    v_mfma_f32_16x16x32_bf16 v[160:163], a[184:187], a[4:7], v[12:15]
    ds_read_b128 a[160:163], v33 offset:34816
    v_max3_f32 v1, v1, v216, v217
    v_mfma_f32_16x16x32_bf16 v[164:167], a[184:187], a[8:11], v[16:19]
    v_max3_f32 v1, v1, v218, v219
    v_mfma_f32_16x16x32_bf16 v[168:171], a[184:187], a[12:15], v[20:23]
    s_add_u32 m0, s52, 0
    s_nop 0
    buffer_load_dwordx4 v41, s[24:27], s77 offen lds
    s_add_u32 m0, s52, 896
    v_mfma_f32_16x16x32_bf16 v[172:175], a[184:187], a[16:19], v[24:27]
    v_exp_f32 v216, v216
    v_mfma_f32_16x16x32_bf16 v[156:159], a[188:191], a[20:23], v[156:159]
    ds_read_b128 a[164:167], v33 offset:35840
    v_exp_f32 v217, v217
    v_mfma_f32_16x16x32_bf16 v[160:163], a[188:191], a[24:27], v[160:163]
    v_exp_f32 v218, v218
    v_mfma_f32_16x16x32_bf16 v[164:167], a[188:191], a[28:31], v[164:167]
    v_exp_f32 v219, v219
    v_mfma_f32_16x16x32_bf16 v[168:171], a[188:191], a[32:35], v[168:171]
    buffer_load_dwordx4 v41, s[24:27], s77 offen offset:128 lds
    s_add_u32 m0, s52, 16384
    v_mfma_f32_16x16x32_bf16 v[172:175], a[188:191], a[36:39], v[172:175]
    v_cvt_pk_bf16_f32 v138, v216, v217
    ds_read_b128 a[168:171], v32 offset:34816
    s_waitcnt lgkmcnt(3)
    v_mfma_f32_16x16x32_bf16 v[156:159], a[192:195], a[80:83], v[156:159]
    v_cvt_pk_bf16_f32 v139, v218, v219
    v_max3_f32 v2, v2, v220, v221
    v_max3_f32 v2, v2, v222, v223
    v_mfma_f32_16x16x32_bf16 v[160:163], a[192:195], a[84:87], v[160:163]
    v_exp_f32 v220, v220
    v_mfma_f32_16x16x32_bf16 v[164:167], a[192:195], a[88:91], v[164:167]
    s_add_u32 s57, s77, 16384
    buffer_load_dwordx4 v41, s[24:27], s57 offen lds
    s_add_u32 m0, s52, 17280
    v_mfma_f32_16x16x32_bf16 v[168:171], a[192:195], a[92:95], v[168:171]
    v_exp_f32 v221, v221
    v_mfma_f32_16x16x32_bf16 v[172:175], a[192:195], a[96:99], v[172:175]
    ds_read_b128 a[172:175], v32 offset:35840
    v_exp_f32 v222, v222
    v_mfma_f32_16x16x32_bf16 v[156:159], a[196:199], a[100:103], v[156:159]
    v_exp_f32 v223, v223
    v_cvt_pk_bf16_f32 v142, v220, v221
    v_mfma_f32_16x16x32_bf16 v[160:163], a[196:199], a[104:107], v[160:163]
    buffer_load_dwordx4 v41, s[24:27], s57 offen offset:128 lds
    s_add_u32 m0, s52, 1792
    v_mfma_f32_16x16x32_bf16 v[164:167], a[196:199], a[108:111], v[164:167]
    v_cvt_pk_bf16_f32 v143, v222, v223
    v_xor_b32 v32, 0x10000, v32
    v_xor_b32 v33, 0x10000, v33
    ds_read_b128 a[176:179], v33 offset:0
    v_mfma_f32_16x16x32_bf16 v[168:171], a[196:199], a[112:115], v[168:171]
    v_max3_f32 v3, v3, v224, v225
    v_max3_f32 v3, v3, v226, v227
    v_mfma_f32_16x16x32_bf16 v[172:175], a[196:199], a[116:119], v[172:175]
    v_exp_f32 v224, v224
    s_waitcnt lgkmcnt(3)
    v_mfma_f32_16x16x32_bf16 v[156:159], a[160:163], a[40:43], v[156:159]
    v_exp_f32 v225, v225
    v_mfma_f32_16x16x32_bf16 v[160:163], a[160:163], a[44:47], v[160:163]
    buffer_load_dwordx4 v41, s[24:27], s77 offen offset:256 lds
    s_add_u32 m0, s52, 2688
    v_mfma_f32_16x16x32_bf16 v[164:167], a[160:163], a[48:51], v[164:167]
    v_exp_f32 v226, v226
    v_mfma_f32_16x16x32_bf16 v[168:171], a[160:163], a[52:55], v[168:171]
    ds_read_b128 a[180:183], v33 offset:1024
    v_exp_f32 v227, v227
    v_mfma_f32_16x16x32_bf16 v[172:175], a[160:163], a[56:59], v[172:175]
    v_cvt_pk_bf16_f32 v146, v224, v225
    v_cvt_pk_bf16_f32 v147, v226, v227
    v_mfma_f32_16x16x32_bf16 v[156:159], a[164:167], a[60:63], v[156:159]
    buffer_load_dwordx4 v41, s[24:27], s77 offen offset:384 lds
    s_add_u32 m0, s52, 18176
    v_mfma_f32_16x16x32_bf16 v[160:163], a[164:167], a[64:67], v[160:163]
    v_max3_f32 v4, v4, v228, v229
    ds_read_b128 a[184:187], v32 offset:0
    v_mfma_f32_16x16x32_bf16 v[164:167], a[164:167], a[68:71], v[164:167]
    v_max3_f32 v4, v4, v230, v231
    v_exp_f32 v228, v228
    v_mfma_f32_16x16x32_bf16 v[168:171], a[164:167], a[72:75], v[168:171]
    v_exp_f32 v229, v229
    v_mfma_f32_16x16x32_bf16 v[172:175], a[164:167], a[76:79], v[172:175]
    v_exp_f32 v230, v230
    s_waitcnt lgkmcnt(3)
    v_mfma_f32_16x16x32_bf16 v[156:159], a[168:171], a[120:123], v[156:159]
    buffer_load_dwordx4 v41, s[24:27], s57 offen offset:256 lds
    s_add_u32 m0, s52, 19072
    v_mfma_f32_16x16x32_bf16 v[160:163], a[168:171], a[124:127], v[160:163]
    ds_read_b128 a[188:191], v32 offset:1024
    v_mfma_f32_16x16x32_bf16 v[164:167], a[168:171], a[128:131], v[164:167]
    v_exp_f32 v231, v231
    v_cvt_pk_bf16_f32 v150, v228, v229
    v_mfma_f32_16x16x32_bf16 v[168:171], a[168:171], a[132:135], v[168:171]
    v_cvt_pk_bf16_f32 v151, v230, v231
    v_max3_f32 v5, v5, v232, v233
    v_mfma_f32_16x16x32_bf16 v[172:175], a[168:171], a[136:139], v[172:175]
    v_max3_f32 v5, v5, v234, v235
    v_mfma_f32_16x16x32_bf16 v[156:159], a[172:175], a[140:143], v[156:159]
    buffer_load_dwordx4 v41, s[24:27], s57 offen offset:384 lds
    v_mfma_f32_16x16x32_bf16 v[160:163], a[172:175], a[144:147], v[160:163]
    v_exp_f32 v232, v232
    v_mfma_f32_16x16x32_bf16 v[164:167], a[172:175], a[148:151], v[164:167]
    v_exp_f32 v233, v233
    v_mfma_f32_16x16x32_bf16 v[168:171], a[172:175], a[152:155], v[168:171]
    v_exp_f32 v234, v234
    v_exp_f32 v235, v235
    v_mfma_f32_16x16x32_bf16 v[172:175], a[172:175], a[156:159], v[172:175]
    v_cvt_pk_bf16_f32 v154, v232, v233
    v_cvt_pk_bf16_f32 v155, v234, v235
    s_waitcnt vmcnt(12)
    s_barrier
    s_waitcnt lgkmcnt(2)
    v_mfma_f32_16x16x32_bf16 v[216:219], a[176:179], a[0:3], v[8:11]
    v_mfma_f32_16x16x32_bf16 v[220:223], a[176:179], a[4:7], v[12:15]
    ds_read_b128 a[192:195], v33 offset:2048
    v_max3_f32 v1, v1, v156, v157
    v_mfma_f32_16x16x32_bf16 v[224:227], a[176:179], a[8:11], v[16:19]
    v_max3_f32 v1, v1, v158, v159
    v_mfma_f32_16x16x32_bf16 v[228:231], a[176:179], a[12:15], v[20:23]
    s_add_u32 m0, s52, 32768
    s_nop 0
    buffer_load_dwordx4 v41, s[24:27], s78 offen lds
    s_add_u32 m0, s52, 33664
    v_mfma_f32_16x16x32_bf16 v[232:235], a[176:179], a[16:19], v[24:27]
    v_exp_f32 v156, v156
    v_mfma_f32_16x16x32_bf16 v[216:219], a[180:183], a[20:23], v[216:219]
    ds_read_b128 a[196:199], v33 offset:3072
    v_exp_f32 v157, v157
    v_mfma_f32_16x16x32_bf16 v[220:223], a[180:183], a[24:27], v[220:223]
    v_exp_f32 v158, v158
    v_mfma_f32_16x16x32_bf16 v[224:227], a[180:183], a[28:31], v[224:227]
    v_exp_f32 v159, v159
    v_mfma_f32_16x16x32_bf16 v[228:231], a[180:183], a[32:35], v[228:231]
    buffer_load_dwordx4 v41, s[24:27], s78 offen offset:128 lds
    s_add_u32 m0, s52, 49152
    v_mfma_f32_16x16x32_bf16 v[232:235], a[180:183], a[36:39], v[232:235]
    v_cvt_pk_bf16_f32 v156, v156, v157
    ds_read_b128 a[160:163], v32 offset:2048
    s_waitcnt lgkmcnt(3)
    v_mfma_f32_16x16x32_bf16 v[216:219], a[184:187], a[80:83], v[216:219]
    v_cvt_pk_bf16_f32 v157, v158, v159
    v_max3_f32 v2, v2, v160, v161
    v_max3_f32 v2, v2, v162, v163
    v_mfma_f32_16x16x32_bf16 v[220:223], a[184:187], a[84:87], v[220:223]
    v_exp_f32 v160, v160
    v_mfma_f32_16x16x32_bf16 v[224:227], a[184:187], a[88:91], v[224:227]
    s_add_u32 s57, s78, 16384
    buffer_load_dwordx4 v41, s[24:27], s57 offen lds
    s_add_u32 m0, s52, 50048
    v_mfma_f32_16x16x32_bf16 v[228:231], a[184:187], a[92:95], v[228:231]
    v_exp_f32 v161, v161
    v_mfma_f32_16x16x32_bf16 v[232:235], a[184:187], a[96:99], v[232:235]
    ds_read_b128 a[164:167], v32 offset:3072
    v_exp_f32 v162, v162
    v_mfma_f32_16x16x32_bf16 v[216:219], a[188:191], a[100:103], v[216:219]
    v_exp_f32 v163, v163
    v_cvt_pk_bf16_f32 v160, v160, v161
    v_mfma_f32_16x16x32_bf16 v[220:223], a[188:191], a[104:107], v[220:223]
    buffer_load_dwordx4 v41, s[24:27], s57 offen offset:128 lds
    s_add_u32 m0, s52, 34560
    v_mfma_f32_16x16x32_bf16 v[224:227], a[188:191], a[108:111], v[224:227]
    v_cvt_pk_bf16_f32 v161, v162, v163
    ds_read_b128 a[168:171], v33 offset:32768
    v_mfma_f32_16x16x32_bf16 v[228:231], a[188:191], a[112:115], v[228:231]
    v_max3_f32 v3, v3, v164, v165
    v_max3_f32 v3, v3, v166, v167
    v_mfma_f32_16x16x32_bf16 v[232:235], a[188:191], a[116:119], v[232:235]
    v_exp_f32 v164, v164
    s_waitcnt lgkmcnt(3)
    v_mfma_f32_16x16x32_bf16 v[216:219], a[192:195], a[40:43], v[216:219]
    v_exp_f32 v165, v165
    v_mfma_f32_16x16x32_bf16 v[220:223], a[192:195], a[44:47], v[220:223]
    buffer_load_dwordx4 v41, s[24:27], s78 offen offset:256 lds
    s_add_u32 m0, s52, 35456
    v_mfma_f32_16x16x32_bf16 v[224:227], a[192:195], a[48:51], v[224:227]
    v_exp_f32 v166, v166
    v_mfma_f32_16x16x32_bf16 v[228:231], a[192:195], a[52:55], v[228:231]
    ds_read_b128 a[172:175], v33 offset:33792
    v_exp_f32 v167, v167
    v_mfma_f32_16x16x32_bf16 v[232:235], a[192:195], a[56:59], v[232:235]
    v_cvt_pk_bf16_f32 v164, v164, v165
    v_cvt_pk_bf16_f32 v165, v166, v167
    v_mfma_f32_16x16x32_bf16 v[216:219], a[196:199], a[60:63], v[216:219]
    buffer_load_dwordx4 v41, s[24:27], s78 offen offset:384 lds
    s_add_u32 m0, s52, 50944
    v_mfma_f32_16x16x32_bf16 v[220:223], a[196:199], a[64:67], v[220:223]
    v_max3_f32 v4, v4, v168, v169
    ds_read_b128 a[176:179], v32 offset:32768
    v_mfma_f32_16x16x32_bf16 v[224:227], a[196:199], a[68:71], v[224:227]
    v_max3_f32 v4, v4, v170, v171
    v_exp_f32 v168, v168
    v_mfma_f32_16x16x32_bf16 v[228:231], a[196:199], a[72:75], v[228:231]
    v_exp_f32 v169, v169
    v_mfma_f32_16x16x32_bf16 v[232:235], a[196:199], a[76:79], v[232:235]
    v_exp_f32 v170, v170
    s_waitcnt lgkmcnt(3)
    v_mfma_f32_16x16x32_bf16 v[216:219], a[160:163], a[120:123], v[216:219]
    buffer_load_dwordx4 v41, s[24:27], s57 offen offset:256 lds
    s_add_u32 m0, s52, 51840
    v_mfma_f32_16x16x32_bf16 v[220:223], a[160:163], a[124:127], v[220:223]
    ds_read_b128 a[180:183], v32 offset:33792
    v_mfma_f32_16x16x32_bf16 v[224:227], a[160:163], a[128:131], v[224:227]
    v_exp_f32 v171, v171
    v_cvt_pk_bf16_f32 v168, v168, v169
    v_mfma_f32_16x16x32_bf16 v[228:231], a[160:163], a[132:135], v[228:231]
    v_cvt_pk_bf16_f32 v169, v170, v171
    v_max3_f32 v5, v5, v172, v173
    v_mfma_f32_16x16x32_bf16 v[232:235], a[160:163], a[136:139], v[232:235]
    v_max3_f32 v5, v5, v174, v175
    v_mfma_f32_16x16x32_bf16 v[216:219], a[164:167], a[140:143], v[216:219]
    buffer_load_dwordx4 v41, s[24:27], s57 offen offset:384 lds
    v_mfma_f32_16x16x32_bf16 v[220:223], a[164:167], a[144:147], v[220:223]
    v_exp_f32 v172, v172
    v_mfma_f32_16x16x32_bf16 v[224:227], a[164:167], a[148:151], v[224:227]
    v_exp_f32 v173, v173
    v_mfma_f32_16x16x32_bf16 v[228:231], a[164:167], a[152:155], v[228:231]
    v_exp_f32 v174, v174
    v_exp_f32 v175, v175
    v_mfma_f32_16x16x32_bf16 v[232:235], a[164:167], a[156:159], v[232:235]
    v_cvt_pk_bf16_f32 v172, v172, v173
    v_cvt_pk_bf16_f32 v173, v174, v175
    s_waitcnt vmcnt(12)
    s_barrier
    s_waitcnt lgkmcnt(2)
    v_mfma_f32_16x16x32_bf16 v[176:179], a[168:171], a[0:3], v[8:11]
    v_mfma_f32_16x16x32_bf16 v[180:183], a[168:171], a[4:7], v[12:15]
    ds_read_b128 a[184:187], v33 offset:34816
    v_max3_f32 v1, v1, v216, v217
    v_mfma_f32_16x16x32_bf16 v[184:187], a[168:171], a[8:11], v[16:19]
    v_max3_f32 v1, v1, v218, v219
    v_mfma_f32_16x16x32_bf16 v[188:191], a[168:171], a[12:15], v[20:23]
    s_add_u32 m0, s52, 65536
    s_nop 0
    buffer_load_dwordx4 v41, s[24:27], s79 offen lds
    s_add_u32 m0, s52, 66432
    v_mfma_f32_16x16x32_bf16 v[192:195], a[168:171], a[16:19], v[24:27]
    v_exp_f32 v216, v216
    v_mfma_f32_16x16x32_bf16 v[176:179], a[172:175], a[20:23], v[176:179]
    ds_read_b128 a[188:191], v33 offset:35840
    v_exp_f32 v217, v217
    v_mfma_f32_16x16x32_bf16 v[180:183], a[172:175], a[24:27], v[180:183]
    v_exp_f32 v218, v218
    v_mfma_f32_16x16x32_bf16 v[184:187], a[172:175], a[28:31], v[184:187]
    v_exp_f32 v219, v219
    v_mfma_f32_16x16x32_bf16 v[188:191], a[172:175], a[32:35], v[188:191]
    buffer_load_dwordx4 v41, s[24:27], s79 offen offset:128 lds
    s_add_u32 m0, s52, 81920
    v_mfma_f32_16x16x32_bf16 v[192:195], a[172:175], a[36:39], v[192:195]
    v_cvt_pk_bf16_f32 v158, v216, v217
    ds_read_b128 a[192:195], v32 offset:34816
    s_waitcnt lgkmcnt(3)
    v_mfma_f32_16x16x32_bf16 v[176:179], a[176:179], a[80:83], v[176:179]
    v_cvt_pk_bf16_f32 v159, v218, v219
    v_max3_f32 v2, v2, v220, v221
    v_max3_f32 v2, v2, v222, v223
    v_mfma_f32_16x16x32_bf16 v[180:183], a[176:179], a[84:87], v[180:183]
    v_exp_f32 v220, v220
    v_mfma_f32_16x16x32_bf16 v[184:187], a[176:179], a[88:91], v[184:187]
    s_add_u32 s57, s79, 16384
    buffer_load_dwordx4 v41, s[24:27], s57 offen lds
    s_add_u32 m0, s52, 82816
    v_mfma_f32_16x16x32_bf16 v[188:191], a[176:179], a[92:95], v[188:191]
    v_exp_f32 v221, v221
    v_mfma_f32_16x16x32_bf16 v[192:195], a[176:179], a[96:99], v[192:195]
    ds_read_b128 a[196:199], v32 offset:35840
    v_exp_f32 v222, v222
    v_mfma_f32_16x16x32_bf16 v[176:179], a[180:183], a[100:103], v[176:179]
    v_exp_f32 v223, v223
    v_cvt_pk_bf16_f32 v162, v220, v221
    v_mfma_f32_16x16x32_bf16 v[180:183], a[180:183], a[104:107], v[180:183]
    buffer_load_dwordx4 v41, s[24:27], s57 offen offset:128 lds
    s_add_u32 m0, s52, 67328
    v_mfma_f32_16x16x32_bf16 v[184:187], a[180:183], a[108:111], v[184:187]
    v_cvt_pk_bf16_f32 v163, v222, v223
    v_xor_b32 v32, 0x10000, v32
    v_xor_b32 v33, 0x10000, v33
    ds_read_b128 a[160:163], v33 offset:0
    v_mfma_f32_16x16x32_bf16 v[188:191], a[180:183], a[112:115], v[188:191]
    v_max3_f32 v3, v3, v224, v225
    v_max3_f32 v3, v3, v226, v227
    v_mfma_f32_16x16x32_bf16 v[192:195], a[180:183], a[116:119], v[192:195]
    v_exp_f32 v224, v224
    s_waitcnt lgkmcnt(3)
    v_mfma_f32_16x16x32_bf16 v[176:179], a[184:187], a[40:43], v[176:179]
    v_exp_f32 v225, v225
    v_mfma_f32_16x16x32_bf16 v[180:183], a[184:187], a[44:47], v[180:183]
    buffer_load_dwordx4 v41, s[24:27], s79 offen offset:256 lds
    s_add_u32 m0, s52, 68224
    v_mfma_f32_16x16x32_bf16 v[184:187], a[184:187], a[48:51], v[184:187]
    v_exp_f32 v226, v226
    v_mfma_f32_16x16x32_bf16 v[188:191], a[184:187], a[52:55], v[188:191]
    ds_read_b128 a[164:167], v33 offset:1024
    v_exp_f32 v227, v227
    v_mfma_f32_16x16x32_bf16 v[192:195], a[184:187], a[56:59], v[192:195]
    v_cvt_pk_bf16_f32 v166, v224, v225
    v_cvt_pk_bf16_f32 v167, v226, v227
    v_mfma_f32_16x16x32_bf16 v[176:179], a[188:191], a[60:63], v[176:179]
    buffer_load_dwordx4 v41, s[24:27], s79 offen offset:384 lds
    s_add_u32 m0, s52, 83712
    v_mfma_f32_16x16x32_bf16 v[180:183], a[188:191], a[64:67], v[180:183]
    v_max3_f32 v4, v4, v228, v229
    ds_read_b128 a[168:171], v32 offset:0
    v_mfma_f32_16x16x32_bf16 v[184:187], a[188:191], a[68:71], v[184:187]
    v_max3_f32 v4, v4, v230, v231
    v_exp_f32 v228, v228
    v_mfma_f32_16x16x32_bf16 v[188:191], a[188:191], a[72:75], v[188:191]
    v_exp_f32 v229, v229
    v_mfma_f32_16x16x32_bf16 v[192:195], a[188:191], a[76:79], v[192:195]
    v_exp_f32 v230, v230
    s_waitcnt lgkmcnt(3)
    v_mfma_f32_16x16x32_bf16 v[176:179], a[192:195], a[120:123], v[176:179]
    buffer_load_dwordx4 v41, s[24:27], s57 offen offset:256 lds
    s_add_u32 m0, s52, 84608
    v_mfma_f32_16x16x32_bf16 v[180:183], a[192:195], a[124:127], v[180:183]
    ds_read_b128 a[172:175], v32 offset:1024
    v_mfma_f32_16x16x32_bf16 v[184:187], a[192:195], a[128:131], v[184:187]
    v_exp_f32 v231, v231
    v_cvt_pk_bf16_f32 v170, v228, v229
    v_mfma_f32_16x16x32_bf16 v[188:191], a[192:195], a[132:135], v[188:191]
    v_cvt_pk_bf16_f32 v171, v230, v231
    v_max3_f32 v5, v5, v232, v233
    v_mfma_f32_16x16x32_bf16 v[192:195], a[192:195], a[136:139], v[192:195]
    v_max3_f32 v5, v5, v234, v235
    v_mfma_f32_16x16x32_bf16 v[176:179], a[196:199], a[140:143], v[176:179]
    buffer_load_dwordx4 v41, s[24:27], s57 offen offset:384 lds
    v_mfma_f32_16x16x32_bf16 v[180:183], a[196:199], a[144:147], v[180:183]
    v_exp_f32 v232, v232
    v_mfma_f32_16x16x32_bf16 v[184:187], a[196:199], a[148:151], v[184:187]
    v_exp_f32 v233, v233
    v_mfma_f32_16x16x32_bf16 v[188:191], a[196:199], a[152:155], v[188:191]
    v_exp_f32 v234, v234
    v_exp_f32 v235, v235
    v_mfma_f32_16x16x32_bf16 v[192:195], a[196:199], a[156:159], v[192:195]
    v_cvt_pk_bf16_f32 v174, v232, v233
    v_cvt_pk_bf16_f32 v175, v234, v235
    s_waitcnt vmcnt(12)
    s_barrier
    s_waitcnt lgkmcnt(2)
    v_mfma_f32_16x16x32_bf16 v[216:219], a[160:163], a[0:3], v[8:11]
    v_mfma_f32_16x16x32_bf16 v[220:223], a[160:163], a[4:7], v[12:15]
    ds_read_b128 a[176:179], v33 offset:2048
    v_max3_f32 v1, v1, v176, v177
    v_mfma_f32_16x16x32_bf16 v[224:227], a[160:163], a[8:11], v[16:19]
    v_max3_f32 v1, v1, v178, v179
    v_mfma_f32_16x16x32_bf16 v[228:231], a[160:163], a[12:15], v[20:23]
    s_add_u32 m0, s52, 98304
    s_cmp_eq_u32 s63, 0
    s_cselect_b32 s61, s64, s65
    s_add_u32 s61, s61, s50
    buffer_load_dwordx4 v42, s[28:31], s61 offen lds
    s_add_u32 m0, s52, 99200
    v_mfma_f32_16x16x32_bf16 v[232:235], a[160:163], a[16:19], v[24:27]
    v_exp_f32 v176, v176
    v_mfma_f32_16x16x32_bf16 v[216:219], a[164:167], a[20:23], v[216:219]
    ds_read_b128 a[180:183], v33 offset:3072
    v_exp_f32 v177, v177
    v_mfma_f32_16x16x32_bf16 v[220:223], a[164:167], a[24:27], v[220:223]
    v_exp_f32 v178, v178
    v_mfma_f32_16x16x32_bf16 v[224:227], a[164:167], a[28:31], v[224:227]
    v_exp_f32 v179, v179
    v_mfma_f32_16x16x32_bf16 v[228:231], a[164:167], a[32:35], v[228:231]
    buffer_load_dwordx4 v42, s[28:31], s61 offen offset:128 lds
    s_add_u32 m0, s52, 100096
    v_mfma_f32_16x16x32_bf16 v[232:235], a[164:167], a[36:39], v[232:235]
    v_cvt_pk_bf16_f32 v176, v176, v177
    ds_read_b128 a[184:187], v32 offset:2048
    s_waitcnt lgkmcnt(3)
    v_mfma_f32_16x16x32_bf16 v[216:219], a[168:171], a[80:83], v[216:219]
    v_cvt_pk_bf16_f32 v177, v178, v179
    v_max3_f32 v2, v2, v180, v181
    v_max3_f32 v2, v2, v182, v183
    v_mfma_f32_16x16x32_bf16 v[220:223], a[168:171], a[84:87], v[220:223]
    v_exp_f32 v180, v180
    v_mfma_f32_16x16x32_bf16 v[224:227], a[168:171], a[88:91], v[224:227]
    buffer_load_dwordx4 v42, s[28:31], s61 offen offset:256 lds
    s_add_u32 m0, s52, 100992
    v_mfma_f32_16x16x32_bf16 v[228:231], a[168:171], a[92:95], v[228:231]
    v_exp_f32 v181, v181
    v_mfma_f32_16x16x32_bf16 v[232:235], a[168:171], a[96:99], v[232:235]
    ds_read_b128 a[188:191], v32 offset:3072
    v_exp_f32 v182, v182
    v_mfma_f32_16x16x32_bf16 v[216:219], a[172:175], a[100:103], v[216:219]
    v_exp_f32 v183, v183
    v_cvt_pk_bf16_f32 v180, v180, v181
    v_mfma_f32_16x16x32_bf16 v[220:223], a[172:175], a[104:107], v[220:223]
    buffer_load_dwordx4 v42, s[28:31], s61 offen offset:384 lds
    s_add_u32 m0, s52, 114688
    v_mfma_f32_16x16x32_bf16 v[224:227], a[172:175], a[108:111], v[224:227]
    v_cvt_pk_bf16_f32 v181, v182, v183
    ds_read_b128 a[192:195], v33 offset:32768
    v_mfma_f32_16x16x32_bf16 v[228:231], a[172:175], a[112:115], v[228:231]
    v_max3_f32 v3, v3, v184, v185
    v_max3_f32 v3, v3, v186, v187
    v_mfma_f32_16x16x32_bf16 v[232:235], a[172:175], a[116:119], v[232:235]
    v_exp_f32 v184, v184
    s_waitcnt lgkmcnt(3)
    v_mfma_f32_16x16x32_bf16 v[216:219], a[176:179], a[40:43], v[216:219]
    v_exp_f32 v185, v185
    v_mfma_f32_16x16x32_bf16 v[220:223], a[176:179], a[44:47], v[220:223]
    s_add_u32 s57, s61, 8192
    buffer_load_dwordx4 v42, s[28:31], s57 offen lds
    s_add_u32 m0, s52, 115584
    v_mfma_f32_16x16x32_bf16 v[224:227], a[176:179], a[48:51], v[224:227]
    v_exp_f32 v186, v186
    v_mfma_f32_16x16x32_bf16 v[228:231], a[176:179], a[52:55], v[228:231]
    ds_read_b128 a[196:199], v33 offset:33792
    v_exp_f32 v187, v187
    v_mfma_f32_16x16x32_bf16 v[232:235], a[176:179], a[56:59], v[232:235]
    v_cvt_pk_bf16_f32 v184, v184, v185
    v_cvt_pk_bf16_f32 v185, v186, v187
    v_mfma_f32_16x16x32_bf16 v[216:219], a[180:183], a[60:63], v[216:219]
    buffer_load_dwordx4 v42, s[28:31], s57 offen offset:128 lds
    s_add_u32 m0, s52, 116480
    v_mfma_f32_16x16x32_bf16 v[220:223], a[180:183], a[64:67], v[220:223]
    v_max3_f32 v4, v4, v188, v189
    ds_read_b128 a[160:163], v32 offset:32768
    v_mfma_f32_16x16x32_bf16 v[224:227], a[180:183], a[68:71], v[224:227]
    v_max3_f32 v4, v4, v190, v191
    v_exp_f32 v188, v188
    v_mfma_f32_16x16x32_bf16 v[228:231], a[180:183], a[72:75], v[228:231]
    v_exp_f32 v189, v189
    v_mfma_f32_16x16x32_bf16 v[232:235], a[180:183], a[76:79], v[232:235]
    v_exp_f32 v190, v190
    s_waitcnt lgkmcnt(3)
    v_mfma_f32_16x16x32_bf16 v[216:219], a[184:187], a[120:123], v[216:219]
    buffer_load_dwordx4 v42, s[28:31], s57 offen offset:256 lds
    s_add_u32 m0, s52, 117376
    v_mfma_f32_16x16x32_bf16 v[220:223], a[184:187], a[124:127], v[220:223]
    ds_read_b128 a[164:167], v32 offset:33792
    v_mfma_f32_16x16x32_bf16 v[224:227], a[184:187], a[128:131], v[224:227]
    v_exp_f32 v191, v191
    v_cvt_pk_bf16_f32 v188, v188, v189
    v_mfma_f32_16x16x32_bf16 v[228:231], a[184:187], a[132:135], v[228:231]
    v_cvt_pk_bf16_f32 v189, v190, v191
    v_max3_f32 v5, v5, v192, v193
    v_mfma_f32_16x16x32_bf16 v[232:235], a[184:187], a[136:139], v[232:235]
    v_max3_f32 v5, v5, v194, v195
    v_mfma_f32_16x16x32_bf16 v[216:219], a[188:191], a[140:143], v[216:219]
    buffer_load_dwordx4 v42, s[28:31], s57 offen offset:384 lds
    v_mfma_f32_16x16x32_bf16 v[220:223], a[188:191], a[144:147], v[220:223]
    v_exp_f32 v192, v192
    v_mfma_f32_16x16x32_bf16 v[224:227], a[188:191], a[148:151], v[224:227]
    v_exp_f32 v193, v193
    v_mfma_f32_16x16x32_bf16 v[228:231], a[188:191], a[152:155], v[228:231]
    v_exp_f32 v194, v194
    v_exp_f32 v195, v195
    v_mfma_f32_16x16x32_bf16 v[232:235], a[188:191], a[156:159], v[232:235]
    v_cvt_pk_bf16_f32 v192, v192, v193
    v_cvt_pk_bf16_f32 v193, v194, v195
    s_waitcnt vmcnt(12)
    s_barrier
    ds_write_b128 v36, v[56:59] offset:0
    ds_write_b128 v36, v[60:63] offset:1024
    ds_write_b128 v36, v[64:67] offset:2048
    ds_write_b128 v36, v[68:71] offset:3072
    ds_write_b128 v36, v[72:75] offset:4096
    s_waitcnt lgkmcnt(7)
    v_mfma_f32_16x16x32_bf16 v[196:199], a[192:195], a[0:3], v[8:11]
    v_mfma_f32_16x16x32_bf16 v[200:203], a[192:195], a[4:7], v[12:15]
    ds_read_b128 a[168:171], v33 offset:34816
    v_max3_f32 v1, v1, v216, v217
    v_mfma_f32_16x16x32_bf16 v[204:207], a[192:195], a[8:11], v[16:19]
    v_max3_f32 v1, v1, v218, v219
    v_mfma_f32_16x16x32_bf16 v[208:211], a[192:195], a[12:15], v[20:23]
    s_add_u32 m0, s52, 0
    s_xor_b32 s61, s61, 16384
    buffer_load_dwordx4 v42, s[28:31], s61 offen lds
    s_add_u32 m0, s52, 896
    v_mfma_f32_16x16x32_bf16 v[212:215], a[192:195], a[16:19], v[24:27]
    v_exp_f32 v216, v216
    v_mfma_f32_16x16x32_bf16 v[196:199], a[196:199], a[20:23], v[196:199]
    ds_read_b128 a[172:175], v33 offset:35840
    v_exp_f32 v217, v217
    v_mfma_f32_16x16x32_bf16 v[200:203], a[196:199], a[24:27], v[200:203]
    v_exp_f32 v218, v218
    v_mfma_f32_16x16x32_bf16 v[204:207], a[196:199], a[28:31], v[204:207]
    v_exp_f32 v219, v219
    v_mfma_f32_16x16x32_bf16 v[208:211], a[196:199], a[32:35], v[208:211]
    buffer_load_dwordx4 v42, s[28:31], s61 offen offset:128 lds
    s_add_u32 m0, s52, 1792
    v_mfma_f32_16x16x32_bf16 v[212:215], a[196:199], a[36:39], v[212:215]
    v_cvt_pk_bf16_f32 v178, v216, v217
    ds_read_b128 a[176:179], v32 offset:34816
    s_waitcnt lgkmcnt(8)
    v_mfma_f32_16x16x32_bf16 v[196:199], a[160:163], a[80:83], v[196:199]
    v_cvt_pk_bf16_f32 v179, v218, v219
    v_max3_f32 v2, v2, v220, v221
    v_max3_f32 v2, v2, v222, v223
    v_mfma_f32_16x16x32_bf16 v[200:203], a[160:163], a[84:87], v[200:203]
    v_exp_f32 v220, v220
    v_mfma_f32_16x16x32_bf16 v[204:207], a[160:163], a[88:91], v[204:207]
    buffer_load_dwordx4 v42, s[28:31], s61 offen offset:256 lds
    s_add_u32 m0, s52, 2688
    v_mfma_f32_16x16x32_bf16 v[208:211], a[160:163], a[92:95], v[208:211]
    v_exp_f32 v221, v221
    v_mfma_f32_16x16x32_bf16 v[212:215], a[160:163], a[96:99], v[212:215]
    ds_read_b128 a[180:183], v32 offset:35840
    v_exp_f32 v222, v222
    v_mfma_f32_16x16x32_bf16 v[196:199], a[164:167], a[100:103], v[196:199]
    v_exp_f32 v223, v223
    v_cvt_pk_bf16_f32 v182, v220, v221
    v_mfma_f32_16x16x32_bf16 v[200:203], a[164:167], a[104:107], v[200:203]
    buffer_load_dwordx4 v42, s[28:31], s61 offen offset:384 lds
    s_add_u32 m0, s52, 16384
    v_mfma_f32_16x16x32_bf16 v[204:207], a[164:167], a[108:111], v[204:207]
    v_cvt_pk_bf16_f32 v183, v222, v223
    v_xor_b32 v32, 0x10000, v32
    v_xor_b32 v33, 0x10000, v33
    ds_read_b128 a[184:187], v33 offset:0
    v_mfma_f32_16x16x32_bf16 v[208:211], a[164:167], a[112:115], v[208:211]
    v_max3_f32 v3, v3, v224, v225
    v_max3_f32 v3, v3, v226, v227
    v_mfma_f32_16x16x32_bf16 v[212:215], a[164:167], a[116:119], v[212:215]
    v_exp_f32 v224, v224
    s_waitcnt lgkmcnt(3)
    v_mfma_f32_16x16x32_bf16 v[196:199], a[168:171], a[40:43], v[196:199]
    v_exp_f32 v225, v225
    v_mfma_f32_16x16x32_bf16 v[200:203], a[168:171], a[44:47], v[200:203]
    s_add_u32 s57, s61, 8192
    buffer_load_dwordx4 v42, s[28:31], s57 offen lds
    s_add_u32 m0, s52, 17280
    v_mfma_f32_16x16x32_bf16 v[204:207], a[168:171], a[48:51], v[204:207]
    v_exp_f32 v226, v226
    v_mfma_f32_16x16x32_bf16 v[208:211], a[168:171], a[52:55], v[208:211]
    ds_read_b128 a[188:191], v33 offset:1024
    v_exp_f32 v227, v227
    v_mfma_f32_16x16x32_bf16 v[212:215], a[168:171], a[56:59], v[212:215]
    v_cvt_pk_bf16_f32 v186, v224, v225
    v_cvt_pk_bf16_f32 v187, v226, v227
    v_mfma_f32_16x16x32_bf16 v[196:199], a[172:175], a[60:63], v[196:199]
    buffer_load_dwordx4 v42, s[28:31], s57 offen offset:128 lds
    s_add_u32 m0, s52, 18176
    v_mfma_f32_16x16x32_bf16 v[200:203], a[172:175], a[64:67], v[200:203]
    v_max3_f32 v4, v4, v228, v229
    ds_read_b128 a[192:195], v32 offset:0
    v_mfma_f32_16x16x32_bf16 v[204:207], a[172:175], a[68:71], v[204:207]
    v_max3_f32 v4, v4, v230, v231
    v_exp_f32 v228, v228
    v_mfma_f32_16x16x32_bf16 v[208:211], a[172:175], a[72:75], v[208:211]
    v_exp_f32 v229, v229
    v_mfma_f32_16x16x32_bf16 v[212:215], a[172:175], a[76:79], v[212:215]
    v_exp_f32 v230, v230
    s_waitcnt lgkmcnt(3)
    v_mfma_f32_16x16x32_bf16 v[196:199], a[176:179], a[120:123], v[196:199]
    buffer_load_dwordx4 v42, s[28:31], s57 offen offset:256 lds
    s_add_u32 m0, s52, 19072
    v_mfma_f32_16x16x32_bf16 v[200:203], a[176:179], a[124:127], v[200:203]
    ds_read_b128 a[196:199], v32 offset:1024
    v_mfma_f32_16x16x32_bf16 v[204:207], a[176:179], a[128:131], v[204:207]
    v_exp_f32 v231, v231
    v_cvt_pk_bf16_f32 v190, v228, v229
    v_mfma_f32_16x16x32_bf16 v[208:211], a[176:179], a[132:135], v[208:211]
    v_cvt_pk_bf16_f32 v191, v230, v231
    v_max3_f32 v5, v5, v232, v233
    v_mfma_f32_16x16x32_bf16 v[212:215], a[176:179], a[136:139], v[212:215]
    v_max3_f32 v5, v5, v234, v235
    v_mfma_f32_16x16x32_bf16 v[196:199], a[180:183], a[140:143], v[196:199]
    buffer_load_dwordx4 v42, s[28:31], s57 offen offset:384 lds
    v_mfma_f32_16x16x32_bf16 v[200:203], a[180:183], a[144:147], v[200:203]
    v_exp_f32 v232, v232
    v_mfma_f32_16x16x32_bf16 v[204:207], a[180:183], a[148:151], v[204:207]
    v_exp_f32 v233, v233
    v_mfma_f32_16x16x32_bf16 v[208:211], a[180:183], a[152:155], v[208:211]
    v_exp_f32 v234, v234
    v_exp_f32 v235, v235
    v_mfma_f32_16x16x32_bf16 v[212:215], a[180:183], a[156:159], v[212:215]
    v_cvt_pk_bf16_f32 v194, v232, v233
    v_cvt_pk_bf16_f32 v195, v234, v235
    s_waitcnt vmcnt(12)
    s_barrier
    s_waitcnt lgkmcnt(2)
    v_mfma_f32_16x16x32_bf16 v[216:219], a[184:187], a[0:3], v[8:11]
    ds_read_b128 a[160:163], v33 offset:2048
    v_mfma_f32_16x16x32_bf16 v[220:223], a[184:187], a[4:7], v[12:15]
    v_mfma_f32_16x16x32_bf16 v[224:227], a[184:187], a[8:11], v[16:19]
    v_max3_f32 v1, v1, v196, v197
    v_mfma_f32_16x16x32_bf16 v[228:231], a[184:187], a[12:15], v[20:23]
    v_max3_f32 v1, v1, v198, v199
    s_add_u32 m0, s52, 32768
    s_cmp_eq_u32 s63, 0
    s_cselect_b32 s61, s66, s67
    s_add_u32 s61, s61, s50
    buffer_load_dwordx4 v42, s[28:31], s61 offen lds
    s_add_u32 m0, s52, 33664
    v_exp_f32 v196, v196
    v_mfma_f32_16x16x32_bf16 v[232:235], a[184:187], a[16:19], v[24:27]
    ds_read_b128 a[164:167], v33 offset:3072
    v_exp_f32 v197, v197
    v_mfma_f32_16x16x32_bf16 v[216:219], a[188:191], a[20:23], v[216:219]
    v_exp_f32 v198, v198
    v_mfma_f32_16x16x32_bf16 v[220:223], a[188:191], a[24:27], v[220:223]
    v_exp_f32 v199, v199
    v_mfma_f32_16x16x32_bf16 v[224:227], a[188:191], a[28:31], v[224:227]
    buffer_load_dwordx4 v42, s[28:31], s61 offen offset:128 lds
    s_add_u32 m0, s52, 34560
    v_cvt_pk_bf16_f32 v196, v196, v197
    v_mfma_f32_16x16x32_bf16 v[228:231], a[188:191], a[32:35], v[228:231]
    ds_read_b128 a[168:171], v32 offset:2048
    v_cvt_pk_bf16_f32 v197, v198, v199
    v_mfma_f32_16x16x32_bf16 v[232:235], a[188:191], a[36:39], v[232:235]
    v_max3_f32 v2, v2, v200, v201
    s_waitcnt lgkmcnt(3)
    v_mfma_f32_16x16x32_bf16 v[216:219], a[192:195], a[80:83], v[216:219]
    v_max3_f32 v2, v2, v202, v203
    v_mfma_f32_16x16x32_bf16 v[220:223], a[192:195], a[84:87], v[220:223]
    ds_read_b128 a[0:3], v35 offset:32768
    v_exp_f32 v200, v200
    buffer_load_dwordx4 v42, s[28:31], s61 offen offset:256 lds
    s_add_u32 m0, s52, 35456
    v_mfma_f32_16x16x32_bf16 v[224:227], a[192:195], a[88:91], v[224:227]
    v_exp_f32 v201, v201
    ds_read_b128 a[172:175], v32 offset:3072
    v_mfma_f32_16x16x32_bf16 v[228:231], a[192:195], a[92:95], v[228:231]
    ds_read_b128 a[4:7], v35 offset:33792
    v_exp_f32 v202, v202
    v_mfma_f32_16x16x32_bf16 v[232:235], a[192:195], a[96:99], v[232:235]
    v_exp_f32 v203, v203
    v_mfma_f32_16x16x32_bf16 v[216:219], a[196:199], a[100:103], v[216:219]
    ds_read_b128 a[8:11], v35 offset:34816
    v_cvt_pk_bf16_f32 v200, v200, v201
    v_mfma_f32_16x16x32_bf16 v[220:223], a[196:199], a[104:107], v[220:223]
    buffer_load_dwordx4 v42, s[28:31], s61 offen offset:384 lds
    s_add_u32 m0, s52, 49152
    v_cvt_pk_bf16_f32 v201, v202, v203
    v_mfma_f32_16x16x32_bf16 v[224:227], a[196:199], a[108:111], v[224:227]
    ds_read_b64_tr_b16 a[176:177], v28 offset:32768
    ds_read_b128 a[12:15], v35 offset:35840
    v_max3_f32 v3, v3, v204, v205
    v_mfma_f32_16x16x32_bf16 v[228:231], a[196:199], a[112:115], v[228:231]
    ds_read_b64_tr_b16 a[178:179], v28 offset:40960
    v_max3_f32 v3, v3, v206, v207
    v_mfma_f32_16x16x32_bf16 v[232:235], a[196:199], a[116:119], v[232:235]
    ds_read_b128 a[16:19], v35 offset:36864
    v_exp_f32 v204, v204
    s_waitcnt lgkmcnt(9)
    v_mfma_f32_16x16x32_bf16 v[216:219], a[160:163], a[40:43], v[216:219]
    v_exp_f32 v205, v205
    s_add_u32 s57, s61, 8192
    buffer_load_dwordx4 v42, s[28:31], s57 offen lds
    s_add_u32 m0, s52, 50048
    v_mfma_f32_16x16x32_bf16 v[220:223], a[160:163], a[44:47], v[220:223]
    ds_read_b128 a[20:23], v35 offset:37888
    v_exp_f32 v206, v206
    ds_read_b64_tr_b16 a[180:181], v29 offset:32768
    v_mfma_f32_16x16x32_bf16 v[224:227], a[160:163], a[48:51], v[224:227]
    v_exp_f32 v207, v207
    ds_read_b64_tr_b16 a[182:183], v29 offset:40960
    v_mfma_f32_16x16x32_bf16 v[228:231], a[160:163], a[52:55], v[228:231]
    ds_read_b128 a[24:27], v35 offset:38912
    v_cvt_pk_bf16_f32 v204, v204, v205
    v_mfma_f32_16x16x32_bf16 v[232:235], a[160:163], a[56:59], v[232:235]
    v_cvt_pk_bf16_f32 v205, v206, v207
    v_mfma_f32_16x16x32_bf16 v[216:219], a[164:167], a[60:63], v[216:219]
    ds_read_b128 a[28:31], v35 offset:39936
    buffer_load_dwordx4 v42, s[28:31], s57 offen offset:128 lds
    s_add_u32 m0, s52, 50944
    v_max3_f32 v4, v4, v208, v209
    ds_read_b64_tr_b16 a[184:185], v30 offset:32768
    v_mfma_f32_16x16x32_bf16 v[220:223], a[164:167], a[64:67], v[220:223]
    v_max3_f32 v4, v4, v210, v211
    ds_read_b64_tr_b16 a[186:187], v30 offset:40960
    v_mfma_f32_16x16x32_bf16 v[224:227], a[164:167], a[68:71], v[224:227]
    ds_read_b128 a[32:35], v35 offset:40960
    v_exp_f32 v208, v208
    v_exp_f32 v209, v209
    v_mfma_f32_16x16x32_bf16 v[228:231], a[164:167], a[72:75], v[228:231]
    v_exp_f32 v210, v210
    v_mfma_f32_16x16x32_bf16 v[232:235], a[164:167], a[76:79], v[232:235]
    ds_read_b128 a[36:39], v35 offset:41984
    buffer_load_dwordx4 v42, s[28:31], s57 offen offset:256 lds
    s_add_u32 m0, s52, 51840
    ds_read_b64_tr_b16 a[188:189], v31 offset:32768
    v_exp_f32 v211, v211
    s_waitcnt lgkmcnt(15)
    v_mfma_f32_16x16x32_bf16 v[216:219], a[168:171], a[120:123], v[216:219]
    ds_read_b64_tr_b16 a[190:191], v31 offset:40960
    v_cvt_pk_bf16_f32 v208, v208, v209
    v_mfma_f32_16x16x32_bf16 v[220:223], a[168:171], a[124:127], v[220:223]
    v_cvt_pk_bf16_f32 v209, v210, v211
    v_mfma_f32_16x16x32_bf16 v[224:227], a[168:171], a[128:131], v[224:227]
    v_max3_f32 v5, v5, v212, v213
    v_mfma_f32_16x16x32_bf16 v[228:231], a[168:171], a[132:135], v[228:231]
    v_max3_f32 v5, v5, v214, v215
    buffer_load_dwordx4 v42, s[28:31], s57 offen offset:384 lds
    v_mfma_f32_16x16x32_bf16 v[232:235], a[168:171], a[136:139], v[232:235]
    v_exp_f32 v212, v212
    v_mfma_f32_16x16x32_bf16 v[216:219], a[172:175], a[140:143], v[216:219]
    v_exp_f32 v213, v213
    v_mfma_f32_16x16x32_bf16 v[220:223], a[172:175], a[144:147], v[220:223]
    v_exp_f32 v214, v214
    v_mfma_f32_16x16x32_bf16 v[224:227], a[172:175], a[148:151], v[224:227]
    v_exp_f32 v215, v215
    v_mfma_f32_16x16x32_bf16 v[228:231], a[172:175], a[152:155], v[228:231]
    v_cvt_pk_bf16_f32 v212, v212, v213
    v_mfma_f32_16x16x32_bf16 v[232:235], a[172:175], a[156:159], v[232:235]
    v_cvt_pk_bf16_f32 v213, v214, v215
    s_waitcnt lgkmcnt(2)
    s_waitcnt vmcnt(12)
    s_barrier
    ds_write_b128 v38, v[76:79] offset:0
    ds_write_b128 v38, v[80:83] offset:1024
    ds_write_b128 v38, v[84:87] offset:2048
    ds_write_b128 v38, v[88:91] offset:3072
    ds_write_b128 v38, v[92:95] offset:4096
    v_mfma_f32_16x16x32_bf16 a[80:83], a[176:179], a[0:3], 0
    v_mfma_f32_16x16x32_bf16 a[84:87], a[176:179], a[4:7], 0
    ds_read_b64_tr_b16 a[192:193], v28 offset:49152
    ds_read_b64_tr_b16 a[194:195], v28 offset:57344
    v_mfma_f32_16x16x32_bf16 a[88:91], a[176:179], a[8:11], 0
    v_max3_f32 v1, v1, v216, v217
    v_max3_f32 v1, v1, v218, v219
    v_mfma_f32_16x16x32_bf16 a[92:95], a[176:179], a[12:15], 0
    s_add_u32 m0, s52, 65536
    s_xor_b32 s61, s61, 16384
    buffer_load_dwordx4 v42, s[28:31], s61 offen lds
    s_add_u32 m0, s52, 66432
    v_mfma_f32_16x16x32_bf16 a[96:99], a[176:179], a[16:19], 0
    ds_read_b128 a[40:43], v35 offset:43008
    v_exp_f32 v216, v216
    v_mfma_f32_16x16x32_bf16 a[100:103], a[180:183], a[0:3], 0
    ds_read_b64_tr_b16 a[196:197], v29 offset:49152
    v_exp_f32 v217, v217
    v_mfma_f32_16x16x32_bf16 a[104:107], a[180:183], a[4:7], 0
    ds_read_b64_tr_b16 a[198:199], v29 offset:57344
    v_exp_f32 v218, v218
    v_mfma_f32_16x16x32_bf16 a[108:111], a[180:183], a[8:11], 0
    v_exp_f32 v219, v219
    ds_read_b128 a[44:47], v35 offset:44032
    v_mfma_f32_16x16x32_bf16 a[112:115], a[180:183], a[12:15], 0
    buffer_load_dwordx4 v42, s[28:31], s61 offen offset:128 lds
    s_add_u32 m0, s52, 67328
    v_mfma_f32_16x16x32_bf16 a[116:119], a[180:183], a[16:19], 0
    v_cvt_pk_bf16_f32 v198, v216, v217
    ds_read_b64_tr_b16 a[160:161], v30 offset:49152
    v_cvt_pk_bf16_f32 v199, v218, v219
    s_waitcnt lgkmcnt(12)
    v_mfma_f32_16x16x32_bf16 a[120:123], a[184:187], a[0:3], 0
    ds_read_b64_tr_b16 a[162:163], v30 offset:57344
    v_max3_f32 v2, v2, v220, v221
    ds_read_b128 a[48:51], v35 offset:45056
    v_mfma_f32_16x16x32_bf16 a[124:127], a[184:187], a[4:7], 0
    v_max3_f32 v2, v2, v222, v223
    v_exp_f32 v220, v220
    v_mfma_f32_16x16x32_bf16 a[128:131], a[184:187], a[8:11], 0
    buffer_load_dwordx4 v42, s[28:31], s61 offen offset:256 lds
    s_add_u32 m0, s52, 68224
    v_mfma_f32_16x16x32_bf16 a[132:135], a[184:187], a[12:15], 0
    v_exp_f32 v221, v221
    ds_read_b128 a[52:55], v35 offset:46080
    v_mfma_f32_16x16x32_bf16 a[136:139], a[184:187], a[16:19], 0
    ds_read_b64_tr_b16 a[164:165], v31 offset:49152
    v_exp_f32 v222, v222
    v_mfma_f32_16x16x32_bf16 a[140:143], a[188:191], a[0:3], 0
    ds_read_b64_tr_b16 a[166:167], v31 offset:57344
    v_exp_f32 v223, v223
    v_mfma_f32_16x16x32_bf16 a[144:147], a[188:191], a[4:7], 0
    v_cvt_pk_bf16_f32 v202, v220, v221
    ds_read_b128 a[56:59], v35 offset:47104
    v_mfma_f32_16x16x32_bf16 a[148:151], a[188:191], a[8:11], 0
    buffer_load_dwordx4 v42, s[28:31], s61 offen offset:384 lds
    s_add_u32 m0, s52, 81920
    v_mfma_f32_16x16x32_bf16 a[152:155], a[188:191], a[12:15], 0
    v_cvt_pk_bf16_f32 v203, v222, v223
    v_xor_b32 v28, 0x10000, v28
    v_xor_b32 v29, 0x10000, v29
    v_xor_b32 v30, 0x10000, v30
    v_xor_b32 v31, 0x10000, v31
    ds_read_b64_tr_b16 a[168:169], v28 offset:0
    v_max3_f32 v3, v3, v224, v225
    v_mfma_f32_16x16x32_bf16 a[156:159], a[188:191], a[16:19], 0
    ds_read_b64_tr_b16 a[170:171], v28 offset:8192
    v_max3_f32 v3, v3, v226, v227
    ds_read_b128 a[60:63], v35 offset:48128
    s_waitcnt lgkmcnt(11)
    v_mfma_f32_16x16x32_bf16 a[80:83], a[192:195], a[20:23], a[80:83]
    v_exp_f32 v224, v224
    v_exp_f32 v225, v225
    v_mfma_f32_16x16x32_bf16 a[84:87], a[192:195], a[24:27], a[84:87]
    s_add_u32 s57, s61, 8192
    buffer_load_dwordx4 v42, s[28:31], s57 offen lds
    s_add_u32 m0, s52, 82816
    v_mfma_f32_16x16x32_bf16 a[88:91], a[192:195], a[28:31], a[88:91]
    v_exp_f32 v226, v226
    ds_read_b64_tr_b16 a[172:173], v29 offset:0
    v_mfma_f32_16x16x32_bf16 a[92:95], a[192:195], a[32:35], a[92:95]
    ds_read_b128 a[64:67], v35 offset:49152
    v_exp_f32 v227, v227
    v_mfma_f32_16x16x32_bf16 a[96:99], a[192:195], a[36:39], a[96:99]
    ds_read_b64_tr_b16 a[174:175], v29 offset:8192
    v_cvt_pk_bf16_f32 v206, v224, v225
    v_cvt_pk_bf16_f32 v207, v226, v227
    v_mfma_f32_16x16x32_bf16 a[100:103], a[196:199], a[20:23], a[100:103]
    ds_read_b128 a[68:71], v35 offset:50176
    v_mfma_f32_16x16x32_bf16 a[104:107], a[196:199], a[24:27], a[104:107]
    buffer_load_dwordx4 v42, s[28:31], s57 offen offset:128 lds
    s_add_u32 m0, s52, 83712
    v_mfma_f32_16x16x32_bf16 a[108:111], a[196:199], a[28:31], a[108:111]
    v_max3_f32 v4, v4, v228, v229
    ds_read_b64_tr_b16 a[176:177], v30 offset:0
    v_max3_f32 v4, v4, v230, v231
    v_mfma_f32_16x16x32_bf16 a[112:115], a[196:199], a[32:35], a[112:115]
    ds_read_b64_tr_b16 a[178:179], v30 offset:8192
    v_exp_f32 v228, v228
    v_mfma_f32_16x16x32_bf16 a[116:119], a[196:199], a[36:39], a[116:119]
    ds_read_b128 a[72:75], v35 offset:51200
    v_exp_f32 v229, v229
    s_waitcnt lgkmcnt(11)
    v_mfma_f32_16x16x32_bf16 a[120:123], a[160:163], a[20:23], a[120:123]
    v_exp_f32 v230, v230
    v_mfma_f32_16x16x32_bf16 a[124:127], a[160:163], a[24:27], a[124:127]
    buffer_load_dwordx4 v42, s[28:31], s57 offen offset:256 lds
    s_add_u32 m0, s52, 84608
    v_mfma_f32_16x16x32_bf16 a[128:131], a[160:163], a[28:31], a[128:131]
    ds_read_b64_tr_b16 a[180:181], v31 offset:0
    v_exp_f32 v231, v231
    v_mfma_f32_16x16x32_bf16 a[132:135], a[160:163], a[32:35], a[132:135]
    ds_read_b128 a[76:79], v35 offset:52224
    ds_read_b64_tr_b16 a[182:183], v31 offset:8192
    v_mfma_f32_16x16x32_bf16 a[136:139], a[160:163], a[36:39], a[136:139]
    v_cvt_pk_bf16_f32 v210, v228, v229
    v_cvt_pk_bf16_f32 v211, v230, v231
    v_max3_f32 v5, v5, v232, v233
    v_mfma_f32_16x16x32_bf16 a[140:143], a[164:167], a[20:23], a[140:143]
    v_max3_f32 v5, v5, v234, v235
    buffer_load_dwordx4 v42, s[28:31], s57 offen offset:384 lds
    v_mfma_f32_16x16x32_bf16 a[144:147], a[164:167], a[24:27], a[144:147]
    v_exp_f32 v232, v232
    v_mfma_f32_16x16x32_bf16 a[148:151], a[164:167], a[28:31], a[148:151]
    v_exp_f32 v233, v233
    v_mfma_f32_16x16x32_bf16 a[152:155], a[164:167], a[32:35], a[152:155]
    v_exp_f32 v234, v234
    v_exp_f32 v235, v235
    v_mfma_f32_16x16x32_bf16 a[156:159], a[164:167], a[36:39], a[156:159]
    v_cvt_pk_bf16_f32 v214, v232, v233
    v_cvt_pk_bf16_f32 v215, v234, v235
    s_waitcnt lgkmcnt(1)
    s_waitcnt vmcnt(12)
    s_barrier
    v_mfma_f32_16x16x32_bf16 a[80:83], a[168:171], a[40:43], a[80:83]
    v_mfma_f32_16x16x32_bf16 a[84:87], a[168:171], a[44:47], a[84:87]
    ds_read_b64_tr_b16 a[184:185], v28 offset:16384
    v_mfma_f32_16x16x32_bf16 a[88:91], a[168:171], a[48:51], a[88:91]
    ds_read_b64_tr_b16 a[186:187], v28 offset:24576
    v_mfma_f32_16x16x32_bf16 a[92:95], a[168:171], a[52:55], a[92:95]
    s_add_u32 m0, s52, 98304
    s_cmp_eq_u32 s63, 0
    s_cselect_b32 s61, s68, s69
    s_add_u32 s61, s61, s50
    buffer_load_dwordx4 v42, s[28:31], s61 offen lds
    s_add_u32 m0, s52, 99200
    v_mfma_f32_16x16x32_bf16 a[96:99], a[168:171], a[56:59], a[96:99]
    ds_read_b128 a[0:3], v35 offset:53248
    v_mfma_f32_16x16x32_bf16 a[100:103], a[172:175], a[40:43], a[100:103]
    v_max3_f32 v6, v1, v2, v3
    v_max3_f32 v6, v6, v4, v5
    v_cmp_nge_f32 vcc, 0x41c00000, v6
    s_nop 4
    s_cbranch_vccz L_safe
    v_mov_b32 v6, 1
    v_mov_b32 v7, 163072
    ds_write_b32 v7, v6
    s_waitcnt lgkmcnt(0)
L_safe:
    v_mfma_f32_16x16x32_bf16 a[104:107], a[172:175], a[44:47], a[104:107]
    ds_read_b64_tr_b16 a[188:189], v29 offset:16384
    v_mfma_f32_16x16x32_bf16 a[108:111], a[172:175], a[48:51], a[108:111]
    ds_read_b64_tr_b16 a[190:191], v29 offset:24576
    v_mfma_f32_16x16x32_bf16 a[112:115], a[172:175], a[52:55], a[112:115]
    ds_read_b128 a[4:7], v35 offset:54272
    v_mfma_f32_16x16x32_bf16 a[116:119], a[172:175], a[56:59], a[116:119]
    buffer_load_dwordx4 v42, s[28:31], s61 offen offset:128 lds
    s_add_u32 m0, s52, 100096
    s_waitcnt lgkmcnt(6)
    v_mfma_f32_16x16x32_bf16 a[120:123], a[176:179], a[40:43], a[120:123]
    ds_read_b64_tr_b16 a[192:193], v30 offset:16384
    v_mfma_f32_16x16x32_bf16 a[124:127], a[176:179], a[44:47], a[124:127]
    ds_read_b64_tr_b16 a[194:195], v30 offset:24576
    v_mfma_f32_16x16x32_bf16 a[128:131], a[176:179], a[48:51], a[128:131]
    ds_read_b128 a[8:11], v35 offset:55296
    v_mfma_f32_16x16x32_bf16 a[132:135], a[176:179], a[52:55], a[132:135]
    buffer_load_dwordx4 v42, s[28:31], s61 offen offset:256 lds
    s_add_u32 m0, s52, 100992
    v_mfma_f32_16x16x32_bf16 a[136:139], a[176:179], a[56:59], a[136:139]
    ds_read_b128 a[12:15], v35 offset:56320
    v_mfma_f32_16x16x32_bf16 a[140:143], a[180:183], a[40:43], a[140:143]
    ds_read_b64_tr_b16 a[196:197], v31 offset:16384
    v_mfma_f32_16x16x32_bf16 a[144:147], a[180:183], a[44:47], a[144:147]
    ds_read_b64_tr_b16 a[198:199], v31 offset:24576
    v_mfma_f32_16x16x32_bf16 a[148:151], a[180:183], a[48:51], a[148:151]
    ds_read_b128 a[16:19], v35 offset:57344
    v_mfma_f32_16x16x32_bf16 a[152:155], a[180:183], a[52:55], a[152:155]
    buffer_load_dwordx4 v42, s[28:31], s61 offen offset:384 lds
    s_add_u32 m0, s52, 114688
    v_mfma_f32_16x16x32_bf16 a[156:159], a[180:183], a[56:59], a[156:159]
    ds_read_b64_tr_b16 a[160:161], v28 offset:32768
    s_waitcnt lgkmcnt(9)
    v_mfma_f32_16x16x32_bf16 a[80:83], a[184:187], a[60:63], a[80:83]
    ds_read_b64_tr_b16 a[162:163], v28 offset:40960
    v_mfma_f32_16x16x32_bf16 a[84:87], a[184:187], a[64:67], a[84:87]
    ds_read_b128 a[20:23], v35 offset:58368
    v_mfma_f32_16x16x32_bf16 a[88:91], a[184:187], a[68:71], a[88:91]
    s_add_u32 s57, s61, 8192
    buffer_load_dwordx4 v42, s[28:31], s57 offen lds
    s_add_u32 m0, s52, 115584
    v_mfma_f32_16x16x32_bf16 a[92:95], a[184:187], a[72:75], a[92:95]
    ds_read_b64_tr_b16 a[164:165], v29 offset:32768
    v_mfma_f32_16x16x32_bf16 a[96:99], a[184:187], a[76:79], a[96:99]
    ds_read_b128 a[24:27], v35 offset:59392
    v_mfma_f32_16x16x32_bf16 a[100:103], a[188:191], a[60:63], a[100:103]
    ds_read_b64_tr_b16 a[166:167], v29 offset:40960
    v_mfma_f32_16x16x32_bf16 a[104:107], a[188:191], a[64:67], a[104:107]
    ds_read_b128 a[28:31], v35 offset:60416
    v_mfma_f32_16x16x32_bf16 a[108:111], a[188:191], a[68:71], a[108:111]
    buffer_load_dwordx4 v42, s[28:31], s57 offen offset:128 lds
    s_add_u32 m0, s52, 116480
    v_mfma_f32_16x16x32_bf16 a[112:115], a[188:191], a[72:75], a[112:115]
    ds_read_b64_tr_b16 a[168:169], v30 offset:32768
    v_mfma_f32_16x16x32_bf16 a[116:119], a[188:191], a[76:79], a[116:119]
    ds_read_b64_tr_b16 a[170:171], v30 offset:40960
    s_waitcnt lgkmcnt(10)
    v_mfma_f32_16x16x32_bf16 a[120:123], a[192:195], a[60:63], a[120:123]
    ds_read_b128 a[32:35], v35 offset:61440
    v_mfma_f32_16x16x32_bf16 a[124:127], a[192:195], a[64:67], a[124:127]
    buffer_load_dwordx4 v42, s[28:31], s57 offen offset:256 lds
    s_add_u32 m0, s52, 117376
    v_mfma_f32_16x16x32_bf16 a[128:131], a[192:195], a[68:71], a[128:131]
    ds_read_b64_tr_b16 a[172:173], v31 offset:32768
    v_mfma_f32_16x16x32_bf16 a[132:135], a[192:195], a[72:75], a[132:135]
    ds_read_b128 a[36:39], v35 offset:62464
    v_mfma_f32_16x16x32_bf16 a[136:139], a[192:195], a[76:79], a[136:139]
    ds_read_b64_tr_b16 a[174:175], v31 offset:40960
    v_mfma_f32_16x16x32_bf16 a[140:143], a[196:199], a[60:63], a[140:143]
    buffer_load_dwordx4 v42, s[28:31], s57 offen offset:384 lds
    v_mfma_f32_16x16x32_bf16 a[144:147], a[196:199], a[64:67], a[144:147]
    v_mfma_f32_16x16x32_bf16 a[148:151], a[196:199], a[68:71], a[148:151]
    v_mfma_f32_16x16x32_bf16 a[152:155], a[196:199], a[72:75], a[152:155]
    v_mfma_f32_16x16x32_bf16 a[156:159], a[196:199], a[76:79], a[156:159]
    s_waitcnt lgkmcnt(1)
    s_waitcnt vmcnt(12)
    s_barrier
    ds_write_b128 v37, v[96:99] offset:0
    ds_write_b128 v37, v[100:103] offset:1024
    ds_write_b128 v37, v[104:107] offset:2048
    ds_write_b128 v37, v[108:111] offset:3072
    ds_write_b128 v37, v[112:115] offset:4096
    v_mfma_f32_16x16x32_bf16 a[80:83], a[160:163], a[0:3], a[80:83]
    v_mfma_f32_16x16x32_bf16 a[84:87], a[160:163], a[4:7], a[84:87]
    ds_read_b64_tr_b16 a[176:177], v28 offset:49152
    v_mfma_f32_16x16x32_bf16 a[88:91], a[160:163], a[8:11], a[88:91]
    ds_read_b64_tr_b16 a[178:179], v28 offset:57344
    v_mfma_f32_16x16x32_bf16 a[92:95], a[160:163], a[12:15], a[92:95]
    s_add_u32 m0, s52, 0
    s_xor_b32 s61, s61, 16384
    buffer_load_dwordx4 v42, s[28:31], s61 offen lds
    s_add_u32 m0, s52, 896
    v_mfma_f32_16x16x32_bf16 a[96:99], a[160:163], a[16:19], a[96:99]
    ds_read_b128 a[40:43], v35 offset:32768
    v_mfma_f32_16x16x32_bf16 a[100:103], a[164:167], a[0:3], a[100:103]
    ds_read_b64_tr_b16 a[180:181], v29 offset:49152
    v_mfma_f32_16x16x32_bf16 a[104:107], a[164:167], a[4:7], a[104:107]
    ds_read_b64_tr_b16 a[182:183], v29 offset:57344
    v_mfma_f32_16x16x32_bf16 a[108:111], a[164:167], a[8:11], a[108:111]
    ds_read_b128 a[44:47], v35 offset:33792
    v_mfma_f32_16x16x32_bf16 a[112:115], a[164:167], a[12:15], a[112:115]
    buffer_load_dwordx4 v42, s[28:31], s61 offen offset:128 lds
    s_add_u32 m0, s52, 1792
    v_mfma_f32_16x16x32_bf16 a[116:119], a[164:167], a[16:19], a[116:119]
    ds_read_b64_tr_b16 a[184:185], v30 offset:49152
    s_waitcnt lgkmcnt(12)
    v_mfma_f32_16x16x32_bf16 a[120:123], a[168:171], a[0:3], a[120:123]
    ds_read_b64_tr_b16 a[186:187], v30 offset:57344
    v_mfma_f32_16x16x32_bf16 a[124:127], a[168:171], a[4:7], a[124:127]
    ds_read_b128 a[48:51], v35 offset:34816
    v_mfma_f32_16x16x32_bf16 a[128:131], a[168:171], a[8:11], a[128:131]
    buffer_load_dwordx4 v42, s[28:31], s61 offen offset:256 lds
    s_add_u32 m0, s52, 2688
    v_mfma_f32_16x16x32_bf16 a[132:135], a[168:171], a[12:15], a[132:135]
    ds_read_b128 a[52:55], v35 offset:35840
    v_mfma_f32_16x16x32_bf16 a[136:139], a[168:171], a[16:19], a[136:139]
    ds_read_b64_tr_b16 a[188:189], v31 offset:49152
    v_mfma_f32_16x16x32_bf16 a[140:143], a[172:175], a[0:3], a[140:143]
    ds_read_b64_tr_b16 a[190:191], v31 offset:57344
    v_mfma_f32_16x16x32_bf16 a[144:147], a[172:175], a[4:7], a[144:147]
    ds_read_b128 a[56:59], v35 offset:36864
    v_mfma_f32_16x16x32_bf16 a[148:151], a[172:175], a[8:11], a[148:151]
    buffer_load_dwordx4 v42, s[28:31], s61 offen offset:384 lds
    s_add_u32 m0, s52, 16384
    v_mfma_f32_16x16x32_bf16 a[152:155], a[172:175], a[12:15], a[152:155]
    v_xor_b32 v28, 0x10000, v28
    v_xor_b32 v29, 0x10000, v29
    v_xor_b32 v30, 0x10000, v30
    v_xor_b32 v31, 0x10000, v31
    ds_read_b64_tr_b16 a[192:193], v28 offset:0
    v_mfma_f32_16x16x32_bf16 a[156:159], a[172:175], a[16:19], a[156:159]
    ds_read_b64_tr_b16 a[194:195], v28 offset:8192
    s_waitcnt lgkmcnt(10)
    v_mfma_f32_16x16x32_bf16 a[80:83], a[176:179], a[20:23], a[80:83]
    ds_read_b128 a[60:63], v35 offset:37888
    v_mfma_f32_16x16x32_bf16 a[84:87], a[176:179], a[24:27], a[84:87]
    s_add_u32 s57, s61, 8192
    buffer_load_dwordx4 v42, s[28:31], s57 offen lds
    s_add_u32 m0, s52, 17280
    v_mfma_f32_16x16x32_bf16 a[88:91], a[176:179], a[28:31], a[88:91]
    ds_read_b64_tr_b16 a[196:197], v29 offset:0
    v_mfma_f32_16x16x32_bf16 a[92:95], a[176:179], a[32:35], a[92:95]
    ds_read_b128 a[64:67], v35 offset:38912
    v_mfma_f32_16x16x32_bf16 a[96:99], a[176:179], a[36:39], a[96:99]
    ds_read_b64_tr_b16 a[198:199], v29 offset:8192
    v_mfma_f32_16x16x32_bf16 a[100:103], a[180:183], a[20:23], a[100:103]
    ds_read_b128 a[68:71], v35 offset:39936
    v_mfma_f32_16x16x32_bf16 a[104:107], a[180:183], a[24:27], a[104:107]
    buffer_load_dwordx4 v42, s[28:31], s57 offen offset:128 lds
    s_add_u32 m0, s52, 18176
    v_mfma_f32_16x16x32_bf16 a[108:111], a[180:183], a[28:31], a[108:111]
    ds_read_b64_tr_b16 a[160:161], v30 offset:0
    v_mfma_f32_16x16x32_bf16 a[112:115], a[180:183], a[32:35], a[112:115]
    ds_read_b64_tr_b16 a[162:163], v30 offset:8192
    v_mfma_f32_16x16x32_bf16 a[116:119], a[180:183], a[36:39], a[116:119]
    ds_read_b128 a[72:75], v35 offset:40960
    s_waitcnt lgkmcnt(11)
    v_mfma_f32_16x16x32_bf16 a[120:123], a[184:187], a[20:23], a[120:123]
    buffer_load_dwordx4 v42, s[28:31], s57 offen offset:256 lds
    s_add_u32 m0, s52, 19072
    v_mfma_f32_16x16x32_bf16 a[124:127], a[184:187], a[24:27], a[124:127]
    ds_read_b64_tr_b16 a[164:165], v31 offset:0
    v_mfma_f32_16x16x32_bf16 a[128:131], a[184:187], a[28:31], a[128:131]
    ds_read_b128 a[76:79], v35 offset:41984
    v_mfma_f32_16x16x32_bf16 a[132:135], a[184:187], a[32:35], a[132:135]
    ds_read_b64_tr_b16 a[166:167], v31 offset:8192
    v_mfma_f32_16x16x32_bf16 a[136:139], a[184:187], a[36:39], a[136:139]
    v_mfma_f32_16x16x32_bf16 a[140:143], a[188:191], a[20:23], a[140:143]
    buffer_load_dwordx4 v42, s[28:31], s57 offen offset:384 lds
    v_mfma_f32_16x16x32_bf16 a[144:147], a[188:191], a[24:27], a[144:147]
    v_mfma_f32_16x16x32_bf16 a[148:151], a[188:191], a[28:31], a[148:151]
    v_mfma_f32_16x16x32_bf16 a[152:155], a[188:191], a[32:35], a[152:155]
    v_mfma_f32_16x16x32_bf16 a[156:159], a[188:191], a[36:39], a[156:159]
    s_waitcnt lgkmcnt(1)
    s_waitcnt vmcnt(12)
    s_barrier
    v_mfma_f32_16x16x32_bf16 a[80:83], a[192:195], a[40:43], a[80:83]
    v_mfma_f32_16x16x32_bf16 a[84:87], a[192:195], a[44:47], a[84:87]
    ds_read_b64_tr_b16 a[168:169], v28 offset:16384
    v_mfma_f32_16x16x32_bf16 a[88:91], a[192:195], a[48:51], a[88:91]
    ds_read_b64_tr_b16 a[170:171], v28 offset:24576
    v_mfma_f32_16x16x32_bf16 a[92:95], a[192:195], a[52:55], a[92:95]
    v_mov_b32 v7, 163072
    ds_read_b32 v6, v7 offset:0
    v_mfma_f32_16x16x32_bf16 a[96:99], a[192:195], a[56:59], a[96:99]
    s_add_u32 m0, s52, 32768
    s_cmp_eq_u32 s63, 0
    s_cselect_b32 s61, s70, s71
    s_add_u32 s61, s61, s50
    buffer_load_dwordx4 v42, s[28:31], s61 offen lds
    s_add_u32 m0, s52, 33664
    v_mfma_f32_16x16x32_bf16 a[100:103], a[196:199], a[40:43], a[100:103]
    ds_read_b128 a[0:3], v35 offset:43008
    v_mfma_f32_16x16x32_bf16 a[104:107], a[196:199], a[44:47], a[104:107]
    ds_read_b64_tr_b16 a[172:173], v29 offset:16384
    v_mfma_f32_16x16x32_bf16 a[108:111], a[196:199], a[48:51], a[108:111]
    ds_read_b64_tr_b16 a[174:175], v29 offset:24576
    v_mfma_f32_16x16x32_bf16 a[112:115], a[196:199], a[52:55], a[112:115]
    ds_read_b128 a[4:7], v35 offset:44032
    v_mfma_f32_16x16x32_bf16 a[116:119], a[196:199], a[56:59], a[116:119]
    buffer_load_dwordx4 v42, s[28:31], s61 offen offset:128 lds
    s_add_u32 m0, s52, 34560
    s_waitcnt lgkmcnt(7)
    v_mfma_f32_16x16x32_bf16 a[120:123], a[160:163], a[40:43], a[120:123]
    ds_read_b64_tr_b16 a[176:177], v30 offset:16384
    v_mfma_f32_16x16x32_bf16 a[124:127], a[160:163], a[44:47], a[124:127]
    ds_read_b64_tr_b16 a[178:179], v30 offset:24576
    v_mfma_f32_16x16x32_bf16 a[128:131], a[160:163], a[48:51], a[128:131]
    ds_read_b128 a[8:11], v35 offset:45056
    v_mfma_f32_16x16x32_bf16 a[132:135], a[160:163], a[52:55], a[132:135]
    buffer_load_dwordx4 v42, s[28:31], s61 offen offset:256 lds
    s_add_u32 m0, s52, 35456
    v_mfma_f32_16x16x32_bf16 a[136:139], a[160:163], a[56:59], a[136:139]
    ds_read_b128 a[12:15], v35 offset:46080
    v_mfma_f32_16x16x32_bf16 a[140:143], a[164:167], a[40:43], a[140:143]
    ds_read_b64_tr_b16 a[180:181], v31 offset:16384
    v_mfma_f32_16x16x32_bf16 a[144:147], a[164:167], a[44:47], a[144:147]
    ds_read_b64_tr_b16 a[182:183], v31 offset:24576
    v_mfma_f32_16x16x32_bf16 a[148:151], a[164:167], a[48:51], a[148:151]
    ds_read_b128 a[16:19], v35 offset:47104
    v_mfma_f32_16x16x32_bf16 a[152:155], a[164:167], a[52:55], a[152:155]
    buffer_load_dwordx4 v42, s[28:31], s61 offen offset:384 lds
    s_add_u32 m0, s52, 49152
    v_mfma_f32_16x16x32_bf16 a[156:159], a[164:167], a[56:59], a[156:159]
    ds_read_b64_tr_b16 a[184:185], v28 offset:32768
    s_waitcnt lgkmcnt(9)
    v_mfma_f32_16x16x32_bf16 a[80:83], a[168:171], a[60:63], a[80:83]
    ds_read_b64_tr_b16 a[186:187], v28 offset:40960
    v_mfma_f32_16x16x32_bf16 a[84:87], a[168:171], a[64:67], a[84:87]
    ds_read_b128 a[20:23], v35 offset:48128
    v_mfma_f32_16x16x32_bf16 a[88:91], a[168:171], a[68:71], a[88:91]
    s_add_u32 s57, s61, 8192
    buffer_load_dwordx4 v42, s[28:31], s57 offen lds
    s_add_u32 m0, s52, 50048
    v_mfma_f32_16x16x32_bf16 a[92:95], a[168:171], a[72:75], a[92:95]
    ds_read_b64_tr_b16 a[188:189], v29 offset:32768
    v_mfma_f32_16x16x32_bf16 a[96:99], a[168:171], a[76:79], a[96:99]
    ds_read_b128 a[24:27], v35 offset:49152
    v_mfma_f32_16x16x32_bf16 a[100:103], a[172:175], a[60:63], a[100:103]
    ds_read_b64_tr_b16 a[190:191], v29 offset:40960
    v_mfma_f32_16x16x32_bf16 a[104:107], a[172:175], a[64:67], a[104:107]
    ds_read_b128 a[28:31], v35 offset:50176
    v_mfma_f32_16x16x32_bf16 a[108:111], a[172:175], a[68:71], a[108:111]
    buffer_load_dwordx4 v42, s[28:31], s57 offen offset:128 lds
    s_add_u32 m0, s52, 50944
    v_mfma_f32_16x16x32_bf16 a[112:115], a[172:175], a[72:75], a[112:115]
    ds_read_b64_tr_b16 a[192:193], v30 offset:32768
    v_mfma_f32_16x16x32_bf16 a[116:119], a[172:175], a[76:79], a[116:119]
    ds_read_b64_tr_b16 a[194:195], v30 offset:40960
    s_waitcnt lgkmcnt(10)
    v_mfma_f32_16x16x32_bf16 a[120:123], a[176:179], a[60:63], a[120:123]
    ds_read_b128 a[32:35], v35 offset:51200
    v_mfma_f32_16x16x32_bf16 a[124:127], a[176:179], a[64:67], a[124:127]
    buffer_load_dwordx4 v42, s[28:31], s57 offen offset:256 lds
    s_add_u32 m0, s52, 51840
    v_mfma_f32_16x16x32_bf16 a[128:131], a[176:179], a[68:71], a[128:131]
    ds_read_b64_tr_b16 a[196:197], v31 offset:32768
    v_mfma_f32_16x16x32_bf16 a[132:135], a[176:179], a[72:75], a[132:135]
    ds_read_b128 a[36:39], v35 offset:52224
    v_mfma_f32_16x16x32_bf16 a[136:139], a[176:179], a[76:79], a[136:139]
    ds_read_b64_tr_b16 a[198:199], v31 offset:40960
    v_mfma_f32_16x16x32_bf16 a[140:143], a[180:183], a[60:63], a[140:143]
    buffer_load_dwordx4 v42, s[28:31], s57 offen offset:384 lds
    v_mfma_f32_16x16x32_bf16 a[144:147], a[180:183], a[64:67], a[144:147]
    v_mfma_f32_16x16x32_bf16 a[148:151], a[180:183], a[68:71], a[148:151]
    v_mfma_f32_16x16x32_bf16 a[152:155], a[180:183], a[72:75], a[152:155]
    v_mfma_f32_16x16x32_bf16 a[156:159], a[180:183], a[76:79], a[156:159]
    v_readfirstlane_b32 s59, v6
    s_nop 0
    s_andn2_b32 s59, s59, s54
    s_cbranch_scc1 L_redo
    s_waitcnt lgkmcnt(1)
    s_waitcnt vmcnt(12)
    s_barrier
    ds_write_b128 v36, v[116:119] offset:0
    ds_write_b128 v36, v[120:123] offset:1024
    ds_write_b128 v36, v[124:127] offset:2048
    ds_write_b128 v36, v[128:131] offset:3072
    ds_write_b128 v36, v[132:135] offset:4096
    v_mfma_f32_16x16x32_bf16 a[80:83], a[184:187], a[0:3], a[80:83]
    v_mfma_f32_16x16x32_bf16 a[84:87], a[184:187], a[4:7], a[84:87]
    ds_read_b64_tr_b16 a[160:161], v28 offset:49152
    v_mfma_f32_16x16x32_bf16 a[88:91], a[184:187], a[8:11], a[88:91]
    ds_read_b64_tr_b16 a[162:163], v28 offset:57344
    v_mfma_f32_16x16x32_bf16 a[92:95], a[184:187], a[12:15], a[92:95]
    s_add_u32 m0, s52, 65536
    s_xor_b32 s61, s61, 16384
    buffer_load_dwordx4 v42, s[28:31], s61 offen lds
    s_add_u32 m0, s52, 66432
    v_mfma_f32_16x16x32_bf16 a[96:99], a[184:187], a[16:19], a[96:99]
    ds_read_b128 a[40:43], v35 offset:53248
    v_mfma_f32_16x16x32_bf16 a[100:103], a[188:191], a[0:3], a[100:103]
    ds_read_b64_tr_b16 a[164:165], v29 offset:49152
    v_mfma_f32_16x16x32_bf16 a[104:107], a[188:191], a[4:7], a[104:107]
    ds_read_b64_tr_b16 a[166:167], v29 offset:57344
    v_mfma_f32_16x16x32_bf16 v[216:219], v[236:239], v[56:59], 0
    v_mfma_f32_16x16x32_bf16 a[108:111], a[188:191], a[8:11], a[108:111]
    ds_read_b128 a[44:47], v35 offset:54272
    v_mfma_f32_16x16x32_bf16 a[112:115], a[188:191], a[12:15], a[112:115]
    buffer_load_dwordx4 v42, s[28:31], s61 offen offset:128 lds
    s_add_u32 m0, s52, 67328
    v_mfma_f32_16x16x32_bf16 a[116:119], a[188:191], a[16:19], a[116:119]
    ds_read_b64_tr_b16 a[168:169], v30 offset:49152
    s_waitcnt lgkmcnt(12)
    v_mfma_f32_16x16x32_bf16 a[120:123], a[192:195], a[0:3], a[120:123]
    ds_read_b64_tr_b16 a[170:171], v30 offset:57344
    v_mfma_f32_16x16x32_bf16 a[124:127], a[192:195], a[4:7], a[124:127]
    ds_read_b128 a[48:51], v35 offset:55296
    v_mfma_f32_16x16x32_bf16 a[128:131], a[192:195], a[8:11], a[128:131]
    buffer_load_dwordx4 v42, s[28:31], s61 offen offset:256 lds
    s_add_u32 m0, s52, 68224
    v_mfma_f32_16x16x32_bf16 a[132:135], a[192:195], a[12:15], a[132:135]
    ds_read_b128 a[52:55], v35 offset:56320
    v_mfma_f32_16x16x32_bf16 v[220:223], v[236:239], v[60:63], 0
    v_mfma_f32_16x16x32_bf16 a[136:139], a[192:195], a[16:19], a[136:139]
    ds_read_b64_tr_b16 a[172:173], v31 offset:49152
    v_mfma_f32_16x16x32_bf16 a[140:143], a[196:199], a[0:3], a[140:143]
    ds_read_b64_tr_b16 a[174:175], v31 offset:57344
    v_mfma_f32_16x16x32_bf16 a[144:147], a[196:199], a[4:7], a[144:147]
    ds_read_b128 a[56:59], v35 offset:57344
    v_mfma_f32_16x16x32_bf16 a[148:151], a[196:199], a[8:11], a[148:151]
    buffer_load_dwordx4 v42, s[28:31], s61 offen offset:384 lds
    s_add_u32 m0, s52, 81920
    v_mfma_f32_16x16x32_bf16 a[152:155], a[196:199], a[12:15], a[152:155]
    v_xor_b32 v28, 0x10000, v28
    v_xor_b32 v29, 0x10000, v29
    v_xor_b32 v30, 0x10000, v30
    v_xor_b32 v31, 0x10000, v31
    ds_read_b64_tr_b16 a[176:177], v28 offset:0
    v_mfma_f32_16x16x32_bf16 a[156:159], a[196:199], a[16:19], a[156:159]
    ds_read_b64_tr_b16 a[178:179], v28 offset:8192
    s_waitcnt lgkmcnt(10)
    v_mfma_f32_16x16x32_bf16 a[80:83], a[160:163], a[20:23], a[80:83]
    ds_read_b128 a[60:63], v35 offset:58368
    v_mfma_f32_16x16x32_bf16 v[224:227], v[236:239], v[64:67], 0
    v_mfma_f32_16x16x32_bf16 a[84:87], a[160:163], a[24:27], a[84:87]
    s_add_u32 s57, s61, 8192
    buffer_load_dwordx4 v42, s[28:31], s57 offen lds
    s_add_u32 m0, s52, 82816
    v_mfma_f32_16x16x32_bf16 a[88:91], a[160:163], a[28:31], a[88:91]
    ds_read_b64_tr_b16 a[180:181], v29 offset:0
    v_mfma_f32_16x16x32_bf16 a[92:95], a[160:163], a[32:35], a[92:95]
    ds_read_b128 a[64:67], v35 offset:59392
    v_mfma_f32_16x16x32_bf16 a[96:99], a[160:163], a[36:39], a[96:99]
    ds_read_b64_tr_b16 a[182:183], v29 offset:8192
    v_mfma_f32_16x16x32_bf16 a[100:103], a[164:167], a[20:23], a[100:103]
    ds_read_b128 a[68:71], v35 offset:60416
    v_mfma_f32_16x16x32_bf16 a[104:107], a[164:167], a[24:27], a[104:107]
    buffer_load_dwordx4 v42, s[28:31], s57 offen offset:128 lds
    s_add_u32 m0, s52, 83712
    v_mfma_f32_16x16x32_bf16 a[108:111], a[164:167], a[28:31], a[108:111]
    ds_read_b64_tr_b16 a[184:185], v30 offset:0
    v_mfma_f32_16x16x32_bf16 a[112:115], a[164:167], a[32:35], a[112:115]
    v_mfma_f32_16x16x32_bf16 v[228:231], v[236:239], v[68:71], 0
    ds_read_b64_tr_b16 a[186:187], v30 offset:8192
    v_mfma_f32_16x16x32_bf16 a[116:119], a[164:167], a[36:39], a[116:119]
    ds_read_b128 a[72:75], v35 offset:61440
    s_waitcnt lgkmcnt(11)
    v_mfma_f32_16x16x32_bf16 a[120:123], a[168:171], a[20:23], a[120:123]
    buffer_load_dwordx4 v42, s[28:31], s57 offen offset:256 lds
    s_add_u32 m0, s52, 84608
    v_mfma_f32_16x16x32_bf16 a[124:127], a[168:171], a[24:27], a[124:127]
    ds_read_b64_tr_b16 a[188:189], v31 offset:0
    v_mfma_f32_16x16x32_bf16 a[128:131], a[168:171], a[28:31], a[128:131]
    ds_read_b128 a[76:79], v35 offset:62464
    v_mfma_f32_16x16x32_bf16 a[132:135], a[168:171], a[32:35], a[132:135]
    ds_read_b64_tr_b16 a[190:191], v31 offset:8192
    v_mfma_f32_16x16x32_bf16 a[136:139], a[168:171], a[36:39], a[136:139]
    v_mfma_f32_16x16x32_bf16 v[232:235], v[236:239], v[72:75], 0
    v_mfma_f32_16x16x32_bf16 a[140:143], a[172:175], a[20:23], a[140:143]
    buffer_load_dwordx4 v42, s[28:31], s57 offen offset:384 lds
    v_mfma_f32_16x16x32_bf16 a[144:147], a[172:175], a[24:27], a[144:147]
    v_mfma_f32_16x16x32_bf16 a[148:151], a[172:175], a[28:31], a[148:151]
    v_mfma_f32_16x16x32_bf16 a[152:155], a[172:175], a[32:35], a[152:155]
    v_mfma_f32_16x16x32_bf16 a[156:159], a[172:175], a[36:39], a[156:159]
    s_waitcnt lgkmcnt(1)
    s_waitcnt vmcnt(12)
    s_barrier
    v_mfma_f32_16x16x32_bf16 a[80:83], a[176:179], a[40:43], a[80:83]
    v_mfma_f32_16x16x32_bf16 a[84:87], a[176:179], a[44:47], a[84:87]
    ds_read_b64_tr_b16 a[192:193], v28 offset:16384
    v_mfma_f32_16x16x32_bf16 a[88:91], a[176:179], a[48:51], a[88:91]
    ds_read_b64_tr_b16 a[194:195], v28 offset:24576
    v_mfma_f32_16x16x32_bf16 a[92:95], a[176:179], a[52:55], a[92:95]
    s_add_u32 m0, s52, 98304
    s_cmp_eq_u32 s63, 0
    s_cselect_b32 s61, s72, s73
    s_add_u32 s61, s61, s50
    buffer_load_dwordx4 v42, s[28:31], s61 offen lds
    s_add_u32 m0, s52, 99200
    v_mfma_f32_16x16x32_bf16 a[96:99], a[176:179], a[56:59], a[96:99]
    ds_read_b128 a[0:3], v35 offset:32768
    v_mfma_f32_16x16x32_bf16 a[100:103], a[180:183], a[40:43], a[100:103]
    ds_read_b64_tr_b16 a[196:197], v29 offset:16384
    v_mfma_f32_16x16x32_bf16 a[104:107], a[180:183], a[44:47], a[104:107]
    ds_read_b64_tr_b16 a[198:199], v29 offset:24576
    v_mfma_f32_16x16x32_bf16 v[216:219], v[236:239], v[76:79], v[216:219]
    v_mfma_f32_16x16x32_bf16 a[108:111], a[180:183], a[48:51], a[108:111]
    ds_read_b128 a[4:7], v35 offset:33792
    v_mfma_f32_16x16x32_bf16 a[112:115], a[180:183], a[52:55], a[112:115]
    buffer_load_dwordx4 v42, s[28:31], s61 offen offset:128 lds
    s_add_u32 m0, s52, 100096
    v_mfma_f32_16x16x32_bf16 a[116:119], a[180:183], a[56:59], a[116:119]
    ds_read_b64_tr_b16 a[160:161], v30 offset:16384
    s_waitcnt lgkmcnt(7)
    v_mfma_f32_16x16x32_bf16 a[120:123], a[184:187], a[40:43], a[120:123]
    ds_read_b64_tr_b16 a[162:163], v30 offset:24576
    v_mfma_f32_16x16x32_bf16 a[124:127], a[184:187], a[44:47], a[124:127]
    ds_read_b128 a[8:11], v35 offset:34816
    v_mfma_f32_16x16x32_bf16 a[128:131], a[184:187], a[48:51], a[128:131]
    buffer_load_dwordx4 v42, s[28:31], s61 offen offset:256 lds
    s_add_u32 m0, s52, 100992
    v_mfma_f32_16x16x32_bf16 a[132:135], a[184:187], a[52:55], a[132:135]
    ds_read_b128 a[12:15], v35 offset:35840
    v_mfma_f32_16x16x32_bf16 v[220:223], v[236:239], v[80:83], v[220:223]
    v_mfma_f32_16x16x32_bf16 a[136:139], a[184:187], a[56:59], a[136:139]
    ds_read_b64_tr_b16 a[164:165], v31 offset:16384
    v_mfma_f32_16x16x32_bf16 a[140:143], a[188:191], a[40:43], a[140:143]
    ds_read_b64_tr_b16 a[166:167], v31 offset:24576
    v_mfma_f32_16x16x32_bf16 a[144:147], a[188:191], a[44:47], a[144:147]
    ds_read_b128 a[16:19], v35 offset:36864
    v_mfma_f32_16x16x32_bf16 a[148:151], a[188:191], a[48:51], a[148:151]
    buffer_load_dwordx4 v42, s[28:31], s61 offen offset:384 lds
    s_add_u32 m0, s52, 114688
    v_mfma_f32_16x16x32_bf16 a[152:155], a[188:191], a[52:55], a[152:155]
    ds_read_b64_tr_b16 a[168:169], v28 offset:32768
    v_mfma_f32_16x16x32_bf16 a[156:159], a[188:191], a[56:59], a[156:159]
    ds_read_b64_tr_b16 a[170:171], v28 offset:40960
    s_waitcnt lgkmcnt(10)
    v_mfma_f32_16x16x32_bf16 a[80:83], a[192:195], a[60:63], a[80:83]
    ds_read_b128 a[20:23], v35 offset:37888
    v_mfma_f32_16x16x32_bf16 v[224:227], v[236:239], v[84:87], v[224:227]
    v_mfma_f32_16x16x32_bf16 a[84:87], a[192:195], a[64:67], a[84:87]
    s_add_u32 s57, s61, 8192
    buffer_load_dwordx4 v42, s[28:31], s57 offen lds
    s_add_u32 m0, s52, 115584
    v_mfma_f32_16x16x32_bf16 a[88:91], a[192:195], a[68:71], a[88:91]
    ds_read_b64_tr_b16 a[172:173], v29 offset:32768
    v_mfma_f32_16x16x32_bf16 a[92:95], a[192:195], a[72:75], a[92:95]
    ds_read_b128 a[24:27], v35 offset:38912
    v_mfma_f32_16x16x32_bf16 a[96:99], a[192:195], a[76:79], a[96:99]
    ds_read_b64_tr_b16 a[174:175], v29 offset:40960
    v_mfma_f32_16x16x32_bf16 a[100:103], a[196:199], a[60:63], a[100:103]
    ds_read_b128 a[28:31], v35 offset:39936
    v_mfma_f32_16x16x32_bf16 a[104:107], a[196:199], a[64:67], a[104:107]
    buffer_load_dwordx4 v42, s[28:31], s57 offen offset:128 lds
    s_add_u32 m0, s52, 116480
    v_mfma_f32_16x16x32_bf16 a[108:111], a[196:199], a[68:71], a[108:111]
    ds_read_b64_tr_b16 a[176:177], v30 offset:32768
    v_mfma_f32_16x16x32_bf16 a[112:115], a[196:199], a[72:75], a[112:115]
    v_mfma_f32_16x16x32_bf16 v[228:231], v[236:239], v[88:91], v[228:231]
    ds_read_b64_tr_b16 a[178:179], v30 offset:40960
    v_mfma_f32_16x16x32_bf16 a[116:119], a[196:199], a[76:79], a[116:119]
    ds_read_b128 a[32:35], v35 offset:40960
    s_waitcnt lgkmcnt(11)
    v_mfma_f32_16x16x32_bf16 a[120:123], a[160:163], a[60:63], a[120:123]
    buffer_load_dwordx4 v42, s[28:31], s57 offen offset:256 lds
    s_add_u32 m0, s52, 117376
    v_mfma_f32_16x16x32_bf16 a[124:127], a[160:163], a[64:67], a[124:127]
    ds_read_b64_tr_b16 a[180:181], v31 offset:32768
    v_mfma_f32_16x16x32_bf16 a[128:131], a[160:163], a[68:71], a[128:131]
    ds_read_b128 a[36:39], v35 offset:41984
    v_mfma_f32_16x16x32_bf16 a[132:135], a[160:163], a[72:75], a[132:135]
    ds_read_b64_tr_b16 a[182:183], v31 offset:40960
    v_mfma_f32_16x16x32_bf16 a[136:139], a[160:163], a[76:79], a[136:139]
    v_mfma_f32_16x16x32_bf16 v[232:235], v[236:239], v[92:95], v[232:235]
    v_mfma_f32_16x16x32_bf16 a[140:143], a[164:167], a[60:63], a[140:143]
    buffer_load_dwordx4 v42, s[28:31], s57 offen offset:384 lds
    v_mfma_f32_16x16x32_bf16 a[144:147], a[164:167], a[64:67], a[144:147]
    v_mfma_f32_16x16x32_bf16 a[148:151], a[164:167], a[68:71], a[148:151]
    v_mfma_f32_16x16x32_bf16 a[152:155], a[164:167], a[72:75], a[152:155]
    v_mfma_f32_16x16x32_bf16 a[156:159], a[164:167], a[76:79], a[156:159]
    s_waitcnt lgkmcnt(1)
    s_waitcnt vmcnt(12)
    s_barrier
    ds_write_b128 v38, v[136:139] offset:0
    ds_write_b128 v38, v[140:143] offset:1024
    ds_write_b128 v38, v[144:147] offset:2048
    ds_write_b128 v38, v[148:151] offset:3072
    ds_write_b128 v38, v[152:155] offset:4096
    v_mfma_f32_16x16x32_bf16 a[80:83], a[168:171], a[0:3], a[80:83]
    v_mfma_f32_16x16x32_bf16 a[84:87], a[168:171], a[4:7], a[84:87]
    ds_read_b64_tr_b16 a[184:185], v28 offset:49152
    v_mfma_f32_16x16x32_bf16 a[88:91], a[168:171], a[8:11], a[88:91]
    ds_read_b64_tr_b16 a[186:187], v28 offset:57344
    v_mfma_f32_16x16x32_bf16 a[92:95], a[168:171], a[12:15], a[92:95]
    s_add_u32 m0, s52, 0
    s_xor_b32 s61, s61, 16384
    buffer_load_dwordx4 v42, s[28:31], s61 offen lds
    s_add_u32 m0, s52, 896
    v_mfma_f32_16x16x32_bf16 a[96:99], a[168:171], a[16:19], a[96:99]
    ds_read_b128 a[40:43], v35 offset:43008
    v_mfma_f32_16x16x32_bf16 a[100:103], a[172:175], a[0:3], a[100:103]
    ds_read_b64_tr_b16 a[188:189], v29 offset:49152
    v_mfma_f32_16x16x32_bf16 a[104:107], a[172:175], a[4:7], a[104:107]
    ds_read_b64_tr_b16 a[190:191], v29 offset:57344
    v_mfma_f32_16x16x32_bf16 v[216:219], v[236:239], v[96:99], v[216:219]
    v_mfma_f32_16x16x32_bf16 a[108:111], a[172:175], a[8:11], a[108:111]
    ds_read_b128 a[44:47], v35 offset:44032
    v_mfma_f32_16x16x32_bf16 a[112:115], a[172:175], a[12:15], a[112:115]
    buffer_load_dwordx4 v42, s[28:31], s61 offen offset:128 lds
    s_add_u32 m0, s52, 1792
    v_mfma_f32_16x16x32_bf16 a[116:119], a[172:175], a[16:19], a[116:119]
    ds_read_b64_tr_b16 a[192:193], v30 offset:49152
    s_waitcnt lgkmcnt(12)
    v_mfma_f32_16x16x32_bf16 a[120:123], a[176:179], a[0:3], a[120:123]
    ds_read_b64_tr_b16 a[194:195], v30 offset:57344
    v_mfma_f32_16x16x32_bf16 a[124:127], a[176:179], a[4:7], a[124:127]
    ds_read_b128 a[48:51], v35 offset:45056
    v_mfma_f32_16x16x32_bf16 a[128:131], a[176:179], a[8:11], a[128:131]
    buffer_load_dwordx4 v42, s[28:31], s61 offen offset:256 lds
    s_add_u32 m0, s52, 2688
    v_mfma_f32_16x16x32_bf16 a[132:135], a[176:179], a[12:15], a[132:135]
    ds_read_b128 a[52:55], v35 offset:46080
    v_mfma_f32_16x16x32_bf16 v[220:223], v[236:239], v[100:103], v[220:223]
    v_mfma_f32_16x16x32_bf16 a[136:139], a[176:179], a[16:19], a[136:139]
    ds_read_b64_tr_b16 a[196:197], v31 offset:49152
    v_mfma_f32_16x16x32_bf16 a[140:143], a[180:183], a[0:3], a[140:143]
    ds_read_b64_tr_b16 a[198:199], v31 offset:57344
    v_mfma_f32_16x16x32_bf16 a[144:147], a[180:183], a[4:7], a[144:147]
    ds_read_b128 a[56:59], v35 offset:47104
    v_mfma_f32_16x16x32_bf16 a[148:151], a[180:183], a[8:11], a[148:151]
    buffer_load_dwordx4 v42, s[28:31], s61 offen offset:384 lds
    s_add_u32 m0, s52, 16384
    v_mfma_f32_16x16x32_bf16 a[152:155], a[180:183], a[12:15], a[152:155]
    v_xor_b32 v28, 0x10000, v28
    v_xor_b32 v29, 0x10000, v29
    v_xor_b32 v30, 0x10000, v30
    v_xor_b32 v31, 0x10000, v31
    ds_read_b64_tr_b16 a[160:161], v28 offset:0
    v_mfma_f32_16x16x32_bf16 a[156:159], a[180:183], a[16:19], a[156:159]
    ds_read_b64_tr_b16 a[162:163], v28 offset:8192
    s_waitcnt lgkmcnt(10)
    v_mfma_f32_16x16x32_bf16 a[80:83], a[184:187], a[20:23], a[80:83]
    ds_read_b128 a[60:63], v35 offset:48128
    v_mfma_f32_16x16x32_bf16 v[224:227], v[236:239], v[104:107], v[224:227]
    v_mfma_f32_16x16x32_bf16 a[84:87], a[184:187], a[24:27], a[84:87]
    s_add_u32 s57, s61, 8192
    buffer_load_dwordx4 v42, s[28:31], s57 offen lds
    s_add_u32 m0, s52, 17280
    v_mfma_f32_16x16x32_bf16 a[88:91], a[184:187], a[28:31], a[88:91]
    ds_read_b64_tr_b16 a[164:165], v29 offset:0
    v_mfma_f32_16x16x32_bf16 a[92:95], a[184:187], a[32:35], a[92:95]
    ds_read_b128 a[64:67], v35 offset:49152
    v_mfma_f32_16x16x32_bf16 a[96:99], a[184:187], a[36:39], a[96:99]
    ds_read_b64_tr_b16 a[166:167], v29 offset:8192
    v_mfma_f32_16x16x32_bf16 a[100:103], a[188:191], a[20:23], a[100:103]
    ds_read_b128 a[68:71], v35 offset:50176
    v_mfma_f32_16x16x32_bf16 a[104:107], a[188:191], a[24:27], a[104:107]
    buffer_load_dwordx4 v42, s[28:31], s57 offen offset:128 lds
    s_add_u32 m0, s52, 18176
    v_mfma_f32_16x16x32_bf16 a[108:111], a[188:191], a[28:31], a[108:111]
    ds_read_b64_tr_b16 a[168:169], v30 offset:0
    v_mfma_f32_16x16x32_bf16 a[112:115], a[188:191], a[32:35], a[112:115]
    v_mfma_f32_16x16x32_bf16 v[228:231], v[236:239], v[108:111], v[228:231]
    ds_read_b64_tr_b16 a[170:171], v30 offset:8192
    v_mfma_f32_16x16x32_bf16 a[116:119], a[188:191], a[36:39], a[116:119]
    ds_read_b128 a[72:75], v35 offset:51200
    s_waitcnt lgkmcnt(11)
    v_mfma_f32_16x16x32_bf16 a[120:123], a[192:195], a[20:23], a[120:123]
    buffer_load_dwordx4 v42, s[28:31], s57 offen offset:256 lds
    s_add_u32 m0, s52, 19072
    v_mfma_f32_16x16x32_bf16 a[124:127], a[192:195], a[24:27], a[124:127]
    ds_read_b64_tr_b16 a[172:173], v31 offset:0
    v_mfma_f32_16x16x32_bf16 a[128:131], a[192:195], a[28:31], a[128:131]
    ds_read_b128 a[76:79], v35 offset:52224
    v_mfma_f32_16x16x32_bf16 a[132:135], a[192:195], a[32:35], a[132:135]
    ds_read_b64_tr_b16 a[174:175], v31 offset:8192
    v_mfma_f32_16x16x32_bf16 a[136:139], a[192:195], a[36:39], a[136:139]
    v_mfma_f32_16x16x32_bf16 v[232:235], v[236:239], v[112:115], v[232:235]
    v_mfma_f32_16x16x32_bf16 a[140:143], a[196:199], a[20:23], a[140:143]
    buffer_load_dwordx4 v42, s[28:31], s57 offen offset:384 lds
    v_mfma_f32_16x16x32_bf16 a[144:147], a[196:199], a[24:27], a[144:147]
    v_mfma_f32_16x16x32_bf16 a[148:151], a[196:199], a[28:31], a[148:151]
    v_mfma_f32_16x16x32_bf16 a[152:155], a[196:199], a[32:35], a[152:155]
    v_mfma_f32_16x16x32_bf16 a[156:159], a[196:199], a[36:39], a[156:159]
    s_waitcnt lgkmcnt(1)
    s_waitcnt vmcnt(12)
    s_barrier
    v_mfma_f32_16x16x32_bf16 a[80:83], a[160:163], a[40:43], a[80:83]
    v_mfma_f32_16x16x32_bf16 a[84:87], a[160:163], a[44:47], a[84:87]
    ds_read_b64_tr_b16 a[176:177], v28 offset:16384
    v_mfma_f32_16x16x32_bf16 a[88:91], a[160:163], a[48:51], a[88:91]
    ds_read_b64_tr_b16 a[178:179], v28 offset:24576
    v_mfma_f32_16x16x32_bf16 a[92:95], a[160:163], a[52:55], a[92:95]
    s_add_u32 m0, s52, 32768
    s_cmp_eq_u32 s63, 0
    s_cselect_b32 s61, s74, s75
    s_add_u32 s61, s61, s50
    buffer_load_dwordx4 v42, s[28:31], s61 offen lds
    s_add_u32 m0, s52, 33664
    v_mfma_f32_16x16x32_bf16 a[96:99], a[160:163], a[56:59], a[96:99]
    ds_read_b128 a[0:3], v35 offset:53248
    v_mfma_f32_16x16x32_bf16 a[100:103], a[164:167], a[40:43], a[100:103]
    ds_read_b64_tr_b16 a[180:181], v29 offset:16384
    v_mfma_f32_16x16x32_bf16 a[104:107], a[164:167], a[44:47], a[104:107]
    ds_read_b64_tr_b16 a[182:183], v29 offset:24576
    v_mfma_f32_16x16x32_bf16 v[216:219], v[236:239], v[116:119], v[216:219]
    v_mfma_f32_16x16x32_bf16 a[108:111], a[164:167], a[48:51], a[108:111]
    ds_read_b128 a[4:7], v35 offset:54272
    v_mfma_f32_16x16x32_bf16 a[112:115], a[164:167], a[52:55], a[112:115]
    buffer_load_dwordx4 v42, s[28:31], s61 offen offset:128 lds
    s_add_u32 m0, s52, 34560
    v_mfma_f32_16x16x32_bf16 a[116:119], a[164:167], a[56:59], a[116:119]
    ds_read_b64_tr_b16 a[184:185], v30 offset:16384
    s_waitcnt lgkmcnt(7)
    v_mfma_f32_16x16x32_bf16 a[120:123], a[168:171], a[40:43], a[120:123]
    ds_read_b64_tr_b16 a[186:187], v30 offset:24576
    v_mfma_f32_16x16x32_bf16 a[124:127], a[168:171], a[44:47], a[124:127]
    ds_read_b128 a[8:11], v35 offset:55296
    v_mfma_f32_16x16x32_bf16 a[128:131], a[168:171], a[48:51], a[128:131]
    buffer_load_dwordx4 v42, s[28:31], s61 offen offset:256 lds
    s_add_u32 m0, s52, 35456
    v_mfma_f32_16x16x32_bf16 a[132:135], a[168:171], a[52:55], a[132:135]
    ds_read_b128 a[12:15], v35 offset:56320
    v_mfma_f32_16x16x32_bf16 v[220:223], v[236:239], v[120:123], v[220:223]
    v_mfma_f32_16x16x32_bf16 a[136:139], a[168:171], a[56:59], a[136:139]
    ds_read_b64_tr_b16 a[188:189], v31 offset:16384
    v_mfma_f32_16x16x32_bf16 a[140:143], a[172:175], a[40:43], a[140:143]
    ds_read_b64_tr_b16 a[190:191], v31 offset:24576
    v_mfma_f32_16x16x32_bf16 a[144:147], a[172:175], a[44:47], a[144:147]
    ds_read_b128 a[16:19], v35 offset:57344
    v_mfma_f32_16x16x32_bf16 a[148:151], a[172:175], a[48:51], a[148:151]
    buffer_load_dwordx4 v42, s[28:31], s61 offen offset:384 lds
    s_add_u32 m0, s52, 49152
    v_mfma_f32_16x16x32_bf16 a[152:155], a[172:175], a[52:55], a[152:155]
    ds_read_b64_tr_b16 a[192:193], v28 offset:32768
    v_mfma_f32_16x16x32_bf16 a[156:159], a[172:175], a[56:59], a[156:159]
    ds_read_b64_tr_b16 a[194:195], v28 offset:40960
    s_waitcnt lgkmcnt(10)
    v_mfma_f32_16x16x32_bf16 a[80:83], a[176:179], a[60:63], a[80:83]
    ds_read_b128 a[20:23], v35 offset:58368
    v_mfma_f32_16x16x32_bf16 v[224:227], v[236:239], v[124:127], v[224:227]
    v_mfma_f32_16x16x32_bf16 a[84:87], a[176:179], a[64:67], a[84:87]
    s_add_u32 s57, s61, 8192
    buffer_load_dwordx4 v42, s[28:31], s57 offen lds
    s_add_u32 m0, s52, 50048
    v_mfma_f32_16x16x32_bf16 a[88:91], a[176:179], a[68:71], a[88:91]
    ds_read_b64_tr_b16 a[196:197], v29 offset:32768
    v_mfma_f32_16x16x32_bf16 a[92:95], a[176:179], a[72:75], a[92:95]
    ds_read_b128 a[24:27], v35 offset:59392
    v_mfma_f32_16x16x32_bf16 a[96:99], a[176:179], a[76:79], a[96:99]
    ds_read_b64_tr_b16 a[198:199], v29 offset:40960
    v_mfma_f32_16x16x32_bf16 a[100:103], a[180:183], a[60:63], a[100:103]
    ds_read_b128 a[28:31], v35 offset:60416
    v_mfma_f32_16x16x32_bf16 a[104:107], a[180:183], a[64:67], a[104:107]
    buffer_load_dwordx4 v42, s[28:31], s57 offen offset:128 lds
    s_add_u32 m0, s52, 50944
    v_mfma_f32_16x16x32_bf16 a[108:111], a[180:183], a[68:71], a[108:111]
    ds_read_b64_tr_b16 a[160:161], v30 offset:32768
    v_mfma_f32_16x16x32_bf16 a[112:115], a[180:183], a[72:75], a[112:115]
    v_mfma_f32_16x16x32_bf16 v[228:231], v[236:239], v[128:131], v[228:231]
    ds_read_b64_tr_b16 a[162:163], v30 offset:40960
    v_mfma_f32_16x16x32_bf16 a[116:119], a[180:183], a[76:79], a[116:119]
    ds_read_b128 a[32:35], v35 offset:61440
    s_waitcnt lgkmcnt(11)
    v_mfma_f32_16x16x32_bf16 a[120:123], a[184:187], a[60:63], a[120:123]
    buffer_load_dwordx4 v42, s[28:31], s57 offen offset:256 lds
    s_add_u32 m0, s52, 51840
    v_mfma_f32_16x16x32_bf16 a[124:127], a[184:187], a[64:67], a[124:127]
    ds_read_b64_tr_b16 a[164:165], v31 offset:32768
    v_mfma_f32_16x16x32_bf16 a[128:131], a[184:187], a[68:71], a[128:131]
    ds_read_b128 a[36:39], v35 offset:62464
    v_mfma_f32_16x16x32_bf16 a[132:135], a[184:187], a[72:75], a[132:135]
    ds_read_b64_tr_b16 a[166:167], v31 offset:40960
    v_mfma_f32_16x16x32_bf16 a[136:139], a[184:187], a[76:79], a[136:139]
    v_mfma_f32_16x16x32_bf16 v[232:235], v[236:239], v[132:135], v[232:235]
    v_mfma_f32_16x16x32_bf16 a[140:143], a[188:191], a[60:63], a[140:143]
    buffer_load_dwordx4 v42, s[28:31], s57 offen offset:384 lds
    v_mfma_f32_16x16x32_bf16 a[144:147], a[188:191], a[64:67], a[144:147]
    v_mfma_f32_16x16x32_bf16 a[148:151], a[188:191], a[68:71], a[148:151]
    v_mfma_f32_16x16x32_bf16 a[152:155], a[188:191], a[72:75], a[152:155]
    v_mfma_f32_16x16x32_bf16 a[156:159], a[188:191], a[76:79], a[156:159]
    s_waitcnt lgkmcnt(1)
    s_waitcnt vmcnt(12)
    s_barrier
    ds_write_b128 v37, v[156:159] offset:0
    ds_write_b128 v37, v[160:163] offset:1024
    ds_write_b128 v37, v[164:167] offset:2048
    ds_write_b128 v37, v[168:171] offset:3072
    ds_write_b128 v37, v[172:175] offset:4096
    v_mfma_f32_16x16x32_bf16 a[80:83], a[192:195], a[0:3], a[80:83]
    v_mfma_f32_16x16x32_bf16 a[84:87], a[192:195], a[4:7], a[84:87]
    ds_read_b64_tr_b16 a[168:169], v28 offset:49152
    v_mfma_f32_16x16x32_bf16 a[88:91], a[192:195], a[8:11], a[88:91]
    ds_read_b64_tr_b16 a[170:171], v28 offset:57344
    v_mfma_f32_16x16x32_bf16 a[92:95], a[192:195], a[12:15], a[92:95]
    s_add_u32 m0, s52, 65536
    s_xor_b32 s61, s61, 16384
    buffer_load_dwordx4 v42, s[28:31], s61 offen lds
    s_add_u32 m0, s52, 66432
    v_mfma_f32_16x16x32_bf16 a[96:99], a[192:195], a[16:19], a[96:99]
    ds_read_b128 a[40:43], v35 offset:32768
    v_mfma_f32_16x16x32_bf16 a[100:103], a[196:199], a[0:3], a[100:103]
    ds_read_b64_tr_b16 a[172:173], v29 offset:49152
    v_mfma_f32_16x16x32_bf16 a[104:107], a[196:199], a[4:7], a[104:107]
    ds_read_b64_tr_b16 a[174:175], v29 offset:57344
    v_mfma_f32_16x16x32_bf16 v[216:219], v[236:239], v[136:139], v[216:219]
    v_mfma_f32_16x16x32_bf16 a[108:111], a[196:199], a[8:11], a[108:111]
    ds_read_b128 a[44:47], v35 offset:33792
    v_mfma_f32_16x16x32_bf16 a[112:115], a[196:199], a[12:15], a[112:115]
    buffer_load_dwordx4 v42, s[28:31], s61 offen offset:128 lds
    s_add_u32 m0, s52, 67328
    v_mfma_f32_16x16x32_bf16 a[116:119], a[196:199], a[16:19], a[116:119]
    ds_read_b64_tr_b16 a[176:177], v30 offset:49152
    s_waitcnt lgkmcnt(12)
    v_mfma_f32_16x16x32_bf16 a[120:123], a[160:163], a[0:3], a[120:123]
    ds_read_b64_tr_b16 a[178:179], v30 offset:57344
    v_mfma_f32_16x16x32_bf16 a[124:127], a[160:163], a[4:7], a[124:127]
    ds_read_b128 a[48:51], v35 offset:34816
    v_mfma_f32_16x16x32_bf16 a[128:131], a[160:163], a[8:11], a[128:131]
    buffer_load_dwordx4 v42, s[28:31], s61 offen offset:256 lds
    s_add_u32 m0, s52, 68224
    v_mfma_f32_16x16x32_bf16 a[132:135], a[160:163], a[12:15], a[132:135]
    ds_read_b128 a[52:55], v35 offset:35840
    v_mfma_f32_16x16x32_bf16 v[220:223], v[236:239], v[140:143], v[220:223]
    v_mfma_f32_16x16x32_bf16 a[136:139], a[160:163], a[16:19], a[136:139]
    ds_read_b64_tr_b16 a[180:181], v31 offset:49152
    v_mfma_f32_16x16x32_bf16 a[140:143], a[164:167], a[0:3], a[140:143]
    ds_read_b64_tr_b16 a[182:183], v31 offset:57344
    v_mfma_f32_16x16x32_bf16 a[144:147], a[164:167], a[4:7], a[144:147]
    ds_read_b128 a[56:59], v35 offset:36864
    v_mfma_f32_16x16x32_bf16 a[148:151], a[164:167], a[8:11], a[148:151]
    buffer_load_dwordx4 v42, s[28:31], s61 offen offset:384 lds
    s_add_u32 m0, s52, 81920
    v_mfma_f32_16x16x32_bf16 a[152:155], a[164:167], a[12:15], a[152:155]
    v_xor_b32 v28, 0x10000, v28
    v_xor_b32 v29, 0x10000, v29
    v_xor_b32 v30, 0x10000, v30
    v_xor_b32 v31, 0x10000, v31
    ds_read_b64_tr_b16 a[184:185], v28 offset:0
    v_mfma_f32_16x16x32_bf16 a[156:159], a[164:167], a[16:19], a[156:159]
    ds_read_b64_tr_b16 a[186:187], v28 offset:8192
    s_waitcnt lgkmcnt(10)
    v_mfma_f32_16x16x32_bf16 a[80:83], a[168:171], a[20:23], a[80:83]
    ds_read_b128 a[60:63], v35 offset:37888
    v_mfma_f32_16x16x32_bf16 v[224:227], v[236:239], v[144:147], v[224:227]
    v_mfma_f32_16x16x32_bf16 a[84:87], a[168:171], a[24:27], a[84:87]
    s_add_u32 s57, s61, 8192
    buffer_load_dwordx4 v42, s[28:31], s57 offen lds
    s_add_u32 m0, s52, 82816
    v_mfma_f32_16x16x32_bf16 a[88:91], a[168:171], a[28:31], a[88:91]
    ds_read_b64_tr_b16 a[188:189], v29 offset:0
    v_mfma_f32_16x16x32_bf16 a[92:95], a[168:171], a[32:35], a[92:95]
    ds_read_b128 a[64:67], v35 offset:38912
    v_mfma_f32_16x16x32_bf16 a[96:99], a[168:171], a[36:39], a[96:99]
    ds_read_b64_tr_b16 a[190:191], v29 offset:8192
    v_mfma_f32_16x16x32_bf16 a[100:103], a[172:175], a[20:23], a[100:103]
    ds_read_b128 a[68:71], v35 offset:39936
    v_mfma_f32_16x16x32_bf16 a[104:107], a[172:175], a[24:27], a[104:107]
    buffer_load_dwordx4 v42, s[28:31], s57 offen offset:128 lds
    s_add_u32 m0, s52, 83712
    v_mfma_f32_16x16x32_bf16 a[108:111], a[172:175], a[28:31], a[108:111]
    ds_read_b64_tr_b16 a[192:193], v30 offset:0
    v_mfma_f32_16x16x32_bf16 a[112:115], a[172:175], a[32:35], a[112:115]
    v_mfma_f32_16x16x32_bf16 v[228:231], v[236:239], v[148:151], v[228:231]
    ds_read_b64_tr_b16 a[194:195], v30 offset:8192
    v_mfma_f32_16x16x32_bf16 a[116:119], a[172:175], a[36:39], a[116:119]
    ds_read_b128 a[72:75], v35 offset:40960
    s_waitcnt lgkmcnt(11)
    v_mfma_f32_16x16x32_bf16 a[120:123], a[176:179], a[20:23], a[120:123]
    buffer_load_dwordx4 v42, s[28:31], s57 offen offset:256 lds
    s_add_u32 m0, s52, 84608
    v_mfma_f32_16x16x32_bf16 a[124:127], a[176:179], a[24:27], a[124:127]
    ds_read_b64_tr_b16 a[196:197], v31 offset:0
    v_mfma_f32_16x16x32_bf16 a[128:131], a[176:179], a[28:31], a[128:131]
    ds_read_b128 a[76:79], v35 offset:41984
    v_mfma_f32_16x16x32_bf16 a[132:135], a[176:179], a[32:35], a[132:135]
    ds_read_b64_tr_b16 a[198:199], v31 offset:8192
    v_mfma_f32_16x16x32_bf16 a[136:139], a[176:179], a[36:39], a[136:139]
    v_mfma_f32_16x16x32_bf16 v[232:235], v[236:239], v[152:155], v[232:235]
    v_mfma_f32_16x16x32_bf16 a[140:143], a[180:183], a[20:23], a[140:143]
    buffer_load_dwordx4 v42, s[28:31], s57 offen offset:384 lds
    v_mfma_f32_16x16x32_bf16 a[144:147], a[180:183], a[24:27], a[144:147]
    v_mfma_f32_16x16x32_bf16 a[148:151], a[180:183], a[28:31], a[148:151]
    v_mfma_f32_16x16x32_bf16 a[152:155], a[180:183], a[32:35], a[152:155]
    v_mfma_f32_16x16x32_bf16 a[156:159], a[180:183], a[36:39], a[156:159]
    s_waitcnt lgkmcnt(1)
    s_waitcnt vmcnt(12)
    s_barrier
    v_mfma_f32_16x16x32_bf16 a[80:83], a[184:187], a[40:43], a[80:83]
    v_mfma_f32_16x16x32_bf16 a[84:87], a[184:187], a[44:47], a[84:87]
    ds_read_b64_tr_b16 a[160:161], v28 offset:16384
    v_mfma_f32_16x16x32_bf16 a[88:91], a[184:187], a[48:51], a[88:91]
    ds_read_b64_tr_b16 a[162:163], v28 offset:24576
    v_mfma_f32_16x16x32_bf16 a[92:95], a[184:187], a[52:55], a[92:95]
    s_add_u32 m0, s52, 98304
    s_cmp_eq_u32 s63, 0
    s_cselect_b32 s61, s76, s77
    s_add_u32 s61, s61, s50
    buffer_load_dwordx4 v42, s[28:31], s61 offen lds
    s_add_u32 m0, s52, 99200
    v_mfma_f32_16x16x32_bf16 a[96:99], a[184:187], a[56:59], a[96:99]
    ds_read_b128 a[0:3], v35 offset:43008
    v_mfma_f32_16x16x32_bf16 a[100:103], a[188:191], a[40:43], a[100:103]
    ds_read_b64_tr_b16 a[164:165], v29 offset:16384
    v_mfma_f32_16x16x32_bf16 a[104:107], a[188:191], a[44:47], a[104:107]
    ds_read_b64_tr_b16 a[166:167], v29 offset:24576
    v_mfma_f32_16x16x32_bf16 v[216:219], v[236:239], v[156:159], v[216:219]
    v_mfma_f32_16x16x32_bf16 a[108:111], a[188:191], a[48:51], a[108:111]
    ds_read_b128 a[4:7], v35 offset:44032
    v_mfma_f32_16x16x32_bf16 a[112:115], a[188:191], a[52:55], a[112:115]
    buffer_load_dwordx4 v42, s[28:31], s61 offen offset:128 lds
    s_add_u32 m0, s52, 100096
    v_mfma_f32_16x16x32_bf16 a[116:119], a[188:191], a[56:59], a[116:119]
    ds_read_b64_tr_b16 a[168:169], v30 offset:16384
    s_waitcnt lgkmcnt(7)
    v_mfma_f32_16x16x32_bf16 a[120:123], a[192:195], a[40:43], a[120:123]
    ds_read_b64_tr_b16 a[170:171], v30 offset:24576
    v_mfma_f32_16x16x32_bf16 a[124:127], a[192:195], a[44:47], a[124:127]
    ds_read_b128 a[8:11], v35 offset:45056
    v_mfma_f32_16x16x32_bf16 a[128:131], a[192:195], a[48:51], a[128:131]
    buffer_load_dwordx4 v42, s[28:31], s61 offen offset:256 lds
    s_add_u32 m0, s52, 100992
    v_mfma_f32_16x16x32_bf16 a[132:135], a[192:195], a[52:55], a[132:135]
    ds_read_b128 a[12:15], v35 offset:46080
    v_mfma_f32_16x16x32_bf16 v[220:223], v[236:239], v[160:163], v[220:223]
    v_mfma_f32_16x16x32_bf16 a[136:139], a[192:195], a[56:59], a[136:139]
    ds_read_b64_tr_b16 a[172:173], v31 offset:16384
    v_mfma_f32_16x16x32_bf16 a[140:143], a[196:199], a[40:43], a[140:143]
    ds_read_b64_tr_b16 a[174:175], v31 offset:24576
    v_mfma_f32_16x16x32_bf16 a[144:147], a[196:199], a[44:47], a[144:147]
    ds_read_b128 a[16:19], v35 offset:47104
    v_mfma_f32_16x16x32_bf16 a[148:151], a[196:199], a[48:51], a[148:151]
    buffer_load_dwordx4 v42, s[28:31], s61 offen offset:384 lds
    s_add_u32 m0, s52, 114688
    v_mfma_f32_16x16x32_bf16 a[152:155], a[196:199], a[52:55], a[152:155]
    ds_read_b64_tr_b16 a[176:177], v28 offset:32768
    v_mfma_f32_16x16x32_bf16 a[156:159], a[196:199], a[56:59], a[156:159]
    ds_read_b64_tr_b16 a[178:179], v28 offset:40960
    s_waitcnt lgkmcnt(10)
    v_mfma_f32_16x16x32_bf16 a[80:83], a[160:163], a[60:63], a[80:83]
    ds_read_b128 a[20:23], v35 offset:48128
    v_mfma_f32_16x16x32_bf16 v[224:227], v[236:239], v[164:167], v[224:227]
    v_mfma_f32_16x16x32_bf16 a[84:87], a[160:163], a[64:67], a[84:87]
    s_add_u32 s57, s61, 8192
    buffer_load_dwordx4 v42, s[28:31], s57 offen lds
    s_add_u32 m0, s52, 115584
    v_mfma_f32_16x16x32_bf16 a[88:91], a[160:163], a[68:71], a[88:91]
    ds_read_b64_tr_b16 a[180:181], v29 offset:32768
    v_mfma_f32_16x16x32_bf16 a[92:95], a[160:163], a[72:75], a[92:95]
    ds_read_b128 a[24:27], v35 offset:49152
    v_mfma_f32_16x16x32_bf16 a[96:99], a[160:163], a[76:79], a[96:99]
    ds_read_b64_tr_b16 a[182:183], v29 offset:40960
    v_mfma_f32_16x16x32_bf16 a[100:103], a[164:167], a[60:63], a[100:103]
    ds_read_b128 a[28:31], v35 offset:50176
    v_mfma_f32_16x16x32_bf16 a[104:107], a[164:167], a[64:67], a[104:107]
    buffer_load_dwordx4 v42, s[28:31], s57 offen offset:128 lds
    s_add_u32 m0, s52, 116480
    v_mfma_f32_16x16x32_bf16 a[108:111], a[164:167], a[68:71], a[108:111]
    ds_read_b64_tr_b16 a[184:185], v30 offset:32768
    v_mfma_f32_16x16x32_bf16 a[112:115], a[164:167], a[72:75], a[112:115]
    v_mfma_f32_16x16x32_bf16 v[228:231], v[236:239], v[168:171], v[228:231]
    ds_read_b64_tr_b16 a[186:187], v30 offset:40960
    v_mfma_f32_16x16x32_bf16 a[116:119], a[164:167], a[76:79], a[116:119]
    ds_read_b128 a[32:35], v35 offset:51200
    s_waitcnt lgkmcnt(11)
    v_mfma_f32_16x16x32_bf16 a[120:123], a[168:171], a[60:63], a[120:123]
    buffer_load_dwordx4 v42, s[28:31], s57 offen offset:256 lds
    s_add_u32 m0, s52, 117376
    v_mfma_f32_16x16x32_bf16 a[124:127], a[168:171], a[64:67], a[124:127]
    ds_read_b64_tr_b16 a[188:189], v31 offset:32768
    v_mfma_f32_16x16x32_bf16 a[128:131], a[168:171], a[68:71], a[128:131]
    ds_read_b128 a[36:39], v35 offset:52224
    v_mfma_f32_16x16x32_bf16 a[132:135], a[168:171], a[72:75], a[132:135]
    ds_read_b64_tr_b16 a[190:191], v31 offset:40960
    v_mfma_f32_16x16x32_bf16 a[136:139], a[168:171], a[76:79], a[136:139]
    v_mfma_f32_16x16x32_bf16 v[232:235], v[236:239], v[172:175], v[232:235]
    v_mfma_f32_16x16x32_bf16 a[140:143], a[172:175], a[60:63], a[140:143]
    buffer_load_dwordx4 v42, s[28:31], s57 offen offset:384 lds
    v_mfma_f32_16x16x32_bf16 a[144:147], a[172:175], a[64:67], a[144:147]
    v_mfma_f32_16x16x32_bf16 a[148:151], a[172:175], a[68:71], a[148:151]
    v_mfma_f32_16x16x32_bf16 a[152:155], a[172:175], a[72:75], a[152:155]
    v_mfma_f32_16x16x32_bf16 a[156:159], a[172:175], a[76:79], a[156:159]
    s_waitcnt lgkmcnt(1)
    s_waitcnt vmcnt(12)
    s_barrier
    ds_write_b128 v36, v[176:179] offset:0
    ds_write_b128 v36, v[180:183] offset:1024
    ds_write_b128 v36, v[184:187] offset:2048
    ds_write_b128 v36, v[188:191] offset:3072
    ds_write_b128 v36, v[192:195] offset:4096
    v_mfma_f32_16x16x32_bf16 a[80:83], a[176:179], a[0:3], a[80:83]
    v_mfma_f32_16x16x32_bf16 a[84:87], a[176:179], a[4:7], a[84:87]
    ds_read_b64_tr_b16 a[192:193], v28 offset:49152
    v_mfma_f32_16x16x32_bf16 a[88:91], a[176:179], a[8:11], a[88:91]
    ds_read_b64_tr_b16 a[194:195], v28 offset:57344
    v_mfma_f32_16x16x32_bf16 a[92:95], a[176:179], a[12:15], a[92:95]
    s_add_u32 m0, s52, 0
    s_xor_b32 s61, s61, 16384
    buffer_load_dwordx4 v42, s[28:31], s61 offen lds
    s_add_u32 m0, s52, 896
    v_mfma_f32_16x16x32_bf16 a[96:99], a[176:179], a[16:19], a[96:99]
    ds_read_b128 a[40:43], v35 offset:53248
    v_mfma_f32_16x16x32_bf16 a[100:103], a[180:183], a[0:3], a[100:103]
    ds_read_b64_tr_b16 a[196:197], v29 offset:49152
    v_mfma_f32_16x16x32_bf16 a[104:107], a[180:183], a[4:7], a[104:107]
    ds_read_b64_tr_b16 a[198:199], v29 offset:57344
    v_mfma_f32_16x16x32_bf16 v[216:219], v[236:239], v[176:179], v[216:219]
    v_mfma_f32_16x16x32_bf16 a[108:111], a[180:183], a[8:11], a[108:111]
    ds_read_b128 a[44:47], v35 offset:54272
    v_mfma_f32_16x16x32_bf16 a[112:115], a[180:183], a[12:15], a[112:115]
    buffer_load_dwordx4 v42, s[28:31], s61 offen offset:128 lds
    s_add_u32 m0, s52, 1792
    v_mfma_f32_16x16x32_bf16 a[116:119], a[180:183], a[16:19], a[116:119]
    ds_read_b64_tr_b16 a[160:161], v30 offset:49152
    s_waitcnt lgkmcnt(12)
    v_mfma_f32_16x16x32_bf16 a[120:123], a[184:187], a[0:3], a[120:123]
    ds_read_b64_tr_b16 a[162:163], v30 offset:57344
    v_mfma_f32_16x16x32_bf16 a[124:127], a[184:187], a[4:7], a[124:127]
    ds_read_b128 a[48:51], v35 offset:55296
    v_mfma_f32_16x16x32_bf16 a[128:131], a[184:187], a[8:11], a[128:131]
    buffer_load_dwordx4 v42, s[28:31], s61 offen offset:256 lds
    s_add_u32 m0, s52, 2688
    v_mfma_f32_16x16x32_bf16 a[132:135], a[184:187], a[12:15], a[132:135]
    ds_read_b128 a[52:55], v35 offset:56320
    v_mfma_f32_16x16x32_bf16 v[220:223], v[236:239], v[180:183], v[220:223]
    v_mfma_f32_16x16x32_bf16 a[136:139], a[184:187], a[16:19], a[136:139]
    ds_read_b64_tr_b16 a[164:165], v31 offset:49152
    v_mfma_f32_16x16x32_bf16 a[140:143], a[188:191], a[0:3], a[140:143]
    ds_read_b64_tr_b16 a[166:167], v31 offset:57344
    v_mfma_f32_16x16x32_bf16 a[144:147], a[188:191], a[4:7], a[144:147]
    ds_read_b128 a[56:59], v35 offset:57344
    v_mfma_f32_16x16x32_bf16 a[148:151], a[188:191], a[8:11], a[148:151]
    buffer_load_dwordx4 v42, s[28:31], s61 offen offset:384 lds
    s_add_u32 m0, s52, 16384
    v_mfma_f32_16x16x32_bf16 a[152:155], a[188:191], a[12:15], a[152:155]
    v_xor_b32 v28, 0x10000, v28
    v_xor_b32 v29, 0x10000, v29
    v_xor_b32 v30, 0x10000, v30
    v_xor_b32 v31, 0x10000, v31
    ds_read_b64_tr_b16 a[168:169], v28 offset:0
    v_mfma_f32_16x16x32_bf16 a[156:159], a[188:191], a[16:19], a[156:159]
    ds_read_b64_tr_b16 a[170:171], v28 offset:8192
    s_waitcnt lgkmcnt(10)
    v_mfma_f32_16x16x32_bf16 a[80:83], a[192:195], a[20:23], a[80:83]
    ds_read_b128 a[60:63], v35 offset:58368
    v_mfma_f32_16x16x32_bf16 v[224:227], v[236:239], v[184:187], v[224:227]
    v_mfma_f32_16x16x32_bf16 a[84:87], a[192:195], a[24:27], a[84:87]
    s_add_u32 s57, s61, 8192
    buffer_load_dwordx4 v42, s[28:31], s57 offen lds
    s_add_u32 m0, s52, 17280
    v_mfma_f32_16x16x32_bf16 a[88:91], a[192:195], a[28:31], a[88:91]
    ds_read_b64_tr_b16 a[172:173], v29 offset:0
    v_mfma_f32_16x16x32_bf16 a[92:95], a[192:195], a[32:35], a[92:95]
    ds_read_b128 a[64:67], v35 offset:59392
    v_mfma_f32_16x16x32_bf16 a[96:99], a[192:195], a[36:39], a[96:99]
    ds_read_b64_tr_b16 a[174:175], v29 offset:8192
    v_mfma_f32_16x16x32_bf16 a[100:103], a[196:199], a[20:23], a[100:103]
    ds_read_b128 a[68:71], v35 offset:60416
    v_mfma_f32_16x16x32_bf16 a[104:107], a[196:199], a[24:27], a[104:107]
    buffer_load_dwordx4 v42, s[28:31], s57 offen offset:128 lds
    s_add_u32 m0, s52, 18176
    v_mfma_f32_16x16x32_bf16 a[108:111], a[196:199], a[28:31], a[108:111]
    ds_read_b64_tr_b16 a[176:177], v30 offset:0
    v_mfma_f32_16x16x32_bf16 a[112:115], a[196:199], a[32:35], a[112:115]
    v_mfma_f32_16x16x32_bf16 v[228:231], v[236:239], v[188:191], v[228:231]
    ds_read_b64_tr_b16 a[178:179], v30 offset:8192
    v_mfma_f32_16x16x32_bf16 a[116:119], a[196:199], a[36:39], a[116:119]
    ds_read_b128 a[72:75], v35 offset:61440
    s_waitcnt lgkmcnt(11)
    v_mfma_f32_16x16x32_bf16 a[120:123], a[160:163], a[20:23], a[120:123]
    buffer_load_dwordx4 v42, s[28:31], s57 offen offset:256 lds
    s_add_u32 m0, s52, 19072
    v_mfma_f32_16x16x32_bf16 a[124:127], a[160:163], a[24:27], a[124:127]
    ds_read_b64_tr_b16 a[180:181], v31 offset:0
    v_mfma_f32_16x16x32_bf16 a[128:131], a[160:163], a[28:31], a[128:131]
    ds_read_b128 a[76:79], v35 offset:62464
    v_mfma_f32_16x16x32_bf16 a[132:135], a[160:163], a[32:35], a[132:135]
    ds_read_b64_tr_b16 a[182:183], v31 offset:8192
    v_mfma_f32_16x16x32_bf16 a[136:139], a[160:163], a[36:39], a[136:139]
    v_mfma_f32_16x16x32_bf16 v[232:235], v[236:239], v[192:195], v[232:235]
    v_mfma_f32_16x16x32_bf16 a[140:143], a[164:167], a[20:23], a[140:143]
    buffer_load_dwordx4 v42, s[28:31], s57 offen offset:384 lds
    v_mfma_f32_16x16x32_bf16 a[144:147], a[164:167], a[24:27], a[144:147]
    v_mfma_f32_16x16x32_bf16 a[148:151], a[164:167], a[28:31], a[148:151]
    v_mfma_f32_16x16x32_bf16 a[152:155], a[164:167], a[32:35], a[152:155]
    v_mfma_f32_16x16x32_bf16 a[156:159], a[164:167], a[36:39], a[156:159]
    s_waitcnt lgkmcnt(1)
    s_waitcnt vmcnt(12)
    s_barrier
    v_mfma_f32_16x16x32_bf16 a[80:83], a[168:171], a[40:43], a[80:83]
    v_mfma_f32_16x16x32_bf16 a[84:87], a[168:171], a[44:47], a[84:87]
    ds_read_b64_tr_b16 a[184:185], v28 offset:16384
    v_mfma_f32_16x16x32_bf16 a[88:91], a[168:171], a[48:51], a[88:91]
    ds_read_b64_tr_b16 a[186:187], v28 offset:24576
    v_mfma_f32_16x16x32_bf16 a[92:95], a[168:171], a[52:55], a[92:95]
    s_add_u32 m0, s52, 32768
    s_cmp_eq_u32 s63, 0
    s_cselect_b32 s61, s78, s79
    s_add_u32 s61, s61, s50
    buffer_load_dwordx4 v42, s[28:31], s61 offen lds
    s_add_u32 m0, s52, 33664
    v_mfma_f32_16x16x32_bf16 a[96:99], a[168:171], a[56:59], a[96:99]
    ds_read_b128 a[0:3], v35 offset:32768
    v_mfma_f32_16x16x32_bf16 a[100:103], a[172:175], a[40:43], a[100:103]
    ds_read_b64_tr_b16 a[188:189], v29 offset:16384
    v_mfma_f32_16x16x32_bf16 a[104:107], a[172:175], a[44:47], a[104:107]
    ds_read_b64_tr_b16 a[190:191], v29 offset:24576
    v_mfma_f32_16x16x32_bf16 v[216:219], v[236:239], v[196:199], v[216:219]
    v_mfma_f32_16x16x32_bf16 a[108:111], a[172:175], a[48:51], a[108:111]
    ds_read_b128 a[4:7], v35 offset:33792
    v_mfma_f32_16x16x32_bf16 a[112:115], a[172:175], a[52:55], a[112:115]
    buffer_load_dwordx4 v42, s[28:31], s61 offen offset:128 lds
    s_add_u32 m0, s52, 34560
    v_mfma_f32_16x16x32_bf16 a[116:119], a[172:175], a[56:59], a[116:119]
    ds_read_b64_tr_b16 a[192:193], v30 offset:16384
    s_waitcnt lgkmcnt(7)
    v_mfma_f32_16x16x32_bf16 a[120:123], a[176:179], a[40:43], a[120:123]
    ds_read_b64_tr_b16 a[194:195], v30 offset:24576
    v_mfma_f32_16x16x32_bf16 a[124:127], a[176:179], a[44:47], a[124:127]
    ds_read_b128 a[8:11], v35 offset:34816
    v_mfma_f32_16x16x32_bf16 a[128:131], a[176:179], a[48:51], a[128:131]
    buffer_load_dwordx4 v42, s[28:31], s61 offen offset:256 lds
    s_add_u32 m0, s52, 35456
    v_mfma_f32_16x16x32_bf16 a[132:135], a[176:179], a[52:55], a[132:135]
    ds_read_b128 a[12:15], v35 offset:35840
    v_mfma_f32_16x16x32_bf16 v[220:223], v[236:239], v[200:203], v[220:223]
    v_mfma_f32_16x16x32_bf16 a[136:139], a[176:179], a[56:59], a[136:139]
    ds_read_b64_tr_b16 a[196:197], v31 offset:16384
    v_mfma_f32_16x16x32_bf16 a[140:143], a[180:183], a[40:43], a[140:143]
    ds_read_b64_tr_b16 a[198:199], v31 offset:24576
    v_mfma_f32_16x16x32_bf16 a[144:147], a[180:183], a[44:47], a[144:147]
    ds_read_b128 a[16:19], v35 offset:36864
    v_mfma_f32_16x16x32_bf16 a[148:151], a[180:183], a[48:51], a[148:151]
    buffer_load_dwordx4 v42, s[28:31], s61 offen offset:384 lds
    s_add_u32 m0, s52, 49152
    v_mfma_f32_16x16x32_bf16 a[152:155], a[180:183], a[52:55], a[152:155]
    ds_read_b64_tr_b16 a[160:161], v28 offset:32768
    v_mfma_f32_16x16x32_bf16 a[156:159], a[180:183], a[56:59], a[156:159]
    ds_read_b64_tr_b16 a[162:163], v28 offset:40960
    s_waitcnt lgkmcnt(10)
    v_mfma_f32_16x16x32_bf16 a[80:83], a[184:187], a[60:63], a[80:83]
    ds_read_b128 a[20:23], v35 offset:37888
    v_mfma_f32_16x16x32_bf16 v[224:227], v[236:239], v[204:207], v[224:227]
    v_mfma_f32_16x16x32_bf16 a[84:87], a[184:187], a[64:67], a[84:87]
    s_add_u32 s57, s61, 8192
    buffer_load_dwordx4 v42, s[28:31], s57 offen lds
    s_add_u32 m0, s52, 50048
    v_mfma_f32_16x16x32_bf16 a[88:91], a[184:187], a[68:71], a[88:91]
    ds_read_b64_tr_b16 a[164:165], v29 offset:32768
    v_mfma_f32_16x16x32_bf16 a[92:95], a[184:187], a[72:75], a[92:95]
    ds_read_b128 a[24:27], v35 offset:38912
    v_mfma_f32_16x16x32_bf16 a[96:99], a[184:187], a[76:79], a[96:99]
    ds_read_b64_tr_b16 a[166:167], v29 offset:40960
    v_mfma_f32_16x16x32_bf16 a[100:103], a[188:191], a[60:63], a[100:103]
    ds_read_b128 a[28:31], v35 offset:39936
    v_mfma_f32_16x16x32_bf16 a[104:107], a[188:191], a[64:67], a[104:107]
    buffer_load_dwordx4 v42, s[28:31], s57 offen offset:128 lds
    s_add_u32 m0, s52, 50944
    v_mfma_f32_16x16x32_bf16 a[108:111], a[188:191], a[68:71], a[108:111]
    ds_read_b64_tr_b16 a[168:169], v30 offset:32768
    v_mfma_f32_16x16x32_bf16 a[112:115], a[188:191], a[72:75], a[112:115]
    v_mfma_f32_16x16x32_bf16 v[228:231], v[236:239], v[208:211], v[228:231]
    ds_read_b64_tr_b16 a[170:171], v30 offset:40960
    v_mfma_f32_16x16x32_bf16 a[116:119], a[188:191], a[76:79], a[116:119]
    ds_read_b128 a[32:35], v35 offset:40960
    s_waitcnt lgkmcnt(11)
    v_mfma_f32_16x16x32_bf16 a[120:123], a[192:195], a[60:63], a[120:123]
    buffer_load_dwordx4 v42, s[28:31], s57 offen offset:256 lds
    s_add_u32 m0, s52, 51840
    v_mfma_f32_16x16x32_bf16 a[124:127], a[192:195], a[64:67], a[124:127]
    ds_read_b64_tr_b16 a[172:173], v31 offset:32768
    v_mfma_f32_16x16x32_bf16 a[128:131], a[192:195], a[68:71], a[128:131]
    ds_read_b128 a[36:39], v35 offset:41984
    v_mfma_f32_16x16x32_bf16 a[132:135], a[192:195], a[72:75], a[132:135]
    ds_read_b64_tr_b16 a[174:175], v31 offset:40960
    v_mfma_f32_16x16x32_bf16 a[136:139], a[192:195], a[76:79], a[136:139]
    v_mfma_f32_16x16x32_bf16 v[232:235], v[236:239], v[212:215], v[232:235]
    v_mfma_f32_16x16x32_bf16 a[140:143], a[196:199], a[60:63], a[140:143]
    buffer_load_dwordx4 v42, s[28:31], s57 offen offset:384 lds
    v_mfma_f32_16x16x32_bf16 a[144:147], a[196:199], a[64:67], a[144:147]
    v_mfma_f32_16x16x32_bf16 a[148:151], a[196:199], a[68:71], a[148:151]
    v_mfma_f32_16x16x32_bf16 a[152:155], a[196:199], a[72:75], a[152:155]
    v_mfma_f32_16x16x32_bf16 a[156:159], a[196:199], a[76:79], a[156:159]
    s_waitcnt lgkmcnt(1)
    s_waitcnt vmcnt(12)
    s_barrier
    ds_write_b128 v38, v[196:199] offset:0
    ds_write_b128 v38, v[200:203] offset:1024
    ds_write_b128 v38, v[204:207] offset:2048
    ds_write_b128 v38, v[208:211] offset:3072
    ds_write_b128 v38, v[212:215] offset:4096
    v_mfma_f32_16x16x32_bf16 a[80:83], a[160:163], a[0:3], a[80:83]
    v_mfma_f32_16x16x32_bf16 a[84:87], a[160:163], a[4:7], a[84:87]
    ds_read_b64_tr_b16 a[176:177], v28 offset:49152
    v_mfma_f32_16x16x32_bf16 a[88:91], a[160:163], a[8:11], a[88:91]
    ds_read_b64_tr_b16 a[178:179], v28 offset:57344
    v_mfma_f32_16x16x32_bf16 a[92:95], a[160:163], a[12:15], a[92:95]
    s_add_u32 m0, s52, 65536
    s_xor_b32 s61, s61, 16384
    buffer_load_dwordx4 v42, s[28:31], s61 offen lds
    s_add_u32 m0, s52, 66432
    v_mfma_f32_16x16x32_bf16 a[96:99], a[160:163], a[16:19], a[96:99]
    ds_read_b128 a[40:43], v35 offset:43008
    v_mfma_f32_16x16x32_bf16 a[100:103], a[164:167], a[0:3], a[100:103]
    ds_read_b64_tr_b16 a[180:181], v29 offset:49152
    v_mfma_f32_16x16x32_bf16 a[104:107], a[164:167], a[4:7], a[104:107]
    ds_read_b64_tr_b16 a[182:183], v29 offset:57344
    v_mfma_f32_16x16x32_bf16 a[108:111], a[164:167], a[8:11], a[108:111]
    ds_read_b128 a[44:47], v35 offset:44032
    v_mfma_f32_16x16x32_bf16 a[112:115], a[164:167], a[12:15], a[112:115]
    buffer_load_dwordx4 v42, s[28:31], s61 offen offset:128 lds
    s_add_u32 m0, s52, 67328
    v_mfma_f32_16x16x32_bf16 a[116:119], a[164:167], a[16:19], a[116:119]
    ds_read_b64_tr_b16 a[184:185], v30 offset:49152
    s_waitcnt lgkmcnt(12)
    v_mfma_f32_16x16x32_bf16 a[120:123], a[168:171], a[0:3], a[120:123]
    ds_read_b64_tr_b16 a[186:187], v30 offset:57344
    v_mfma_f32_16x16x32_bf16 a[124:127], a[168:171], a[4:7], a[124:127]
    ds_read_b128 a[48:51], v35 offset:45056
    v_mfma_f32_16x16x32_bf16 a[128:131], a[168:171], a[8:11], a[128:131]
    buffer_load_dwordx4 v42, s[28:31], s61 offen offset:256 lds
    s_add_u32 m0, s52, 68224
    v_mfma_f32_16x16x32_bf16 a[132:135], a[168:171], a[12:15], a[132:135]
    ds_read_b128 a[52:55], v35 offset:46080
    v_mfma_f32_16x16x32_bf16 a[136:139], a[168:171], a[16:19], a[136:139]
    ds_read_b64_tr_b16 a[188:189], v31 offset:49152
    v_mfma_f32_16x16x32_bf16 a[140:143], a[172:175], a[0:3], a[140:143]
    ds_read_b64_tr_b16 a[190:191], v31 offset:57344
    v_mfma_f32_16x16x32_bf16 a[144:147], a[172:175], a[4:7], a[144:147]
    ds_read_b128 a[56:59], v35 offset:47104
    v_mfma_f32_16x16x32_bf16 a[148:151], a[172:175], a[8:11], a[148:151]
    buffer_load_dwordx4 v42, s[28:31], s61 offen offset:384 lds
    s_add_u32 m0, s52, 81920
    v_mfma_f32_16x16x32_bf16 a[152:155], a[172:175], a[12:15], a[152:155]
    v_xor_b32 v28, 0x10000, v28
    v_xor_b32 v29, 0x10000, v29
    v_xor_b32 v30, 0x10000, v30
    v_xor_b32 v31, 0x10000, v31
    ds_read_b64_tr_b16 a[192:193], v28 offset:0
    v_mfma_f32_16x16x32_bf16 a[156:159], a[172:175], a[16:19], a[156:159]
    ds_read_b64_tr_b16 a[194:195], v28 offset:8192
    s_waitcnt lgkmcnt(10)
    v_mfma_f32_16x16x32_bf16 a[80:83], a[176:179], a[20:23], a[80:83]
    ds_read_b128 a[60:63], v35 offset:48128
    v_mfma_f32_16x16x32_bf16 a[84:87], a[176:179], a[24:27], a[84:87]
    s_add_u32 s57, s61, 8192
    buffer_load_dwordx4 v42, s[28:31], s57 offen lds
    s_add_u32 m0, s52, 82816
    v_mfma_f32_16x16x32_bf16 a[88:91], a[176:179], a[28:31], a[88:91]
    ds_read_b64_tr_b16 a[196:197], v29 offset:0
    v_mfma_f32_16x16x32_bf16 a[92:95], a[176:179], a[32:35], a[92:95]
    ds_read_b128 a[64:67], v35 offset:49152
    v_mfma_f32_16x16x32_bf16 a[96:99], a[176:179], a[36:39], a[96:99]
    ds_read_b64_tr_b16 a[198:199], v29 offset:8192
    v_mfma_f32_16x16x32_bf16 a[100:103], a[180:183], a[20:23], a[100:103]
    ds_read_b128 a[68:71], v35 offset:50176
    v_mfma_f32_16x16x32_bf16 a[104:107], a[180:183], a[24:27], a[104:107]
    buffer_load_dwordx4 v42, s[28:31], s57 offen offset:128 lds
    s_add_u32 m0, s52, 83712
    v_mfma_f32_16x16x32_bf16 a[108:111], a[180:183], a[28:31], a[108:111]
    ds_read_b64_tr_b16 a[160:161], v30 offset:0
    v_mfma_f32_16x16x32_bf16 a[112:115], a[180:183], a[32:35], a[112:115]
    ds_read_b64_tr_b16 a[162:163], v30 offset:8192
    v_mfma_f32_16x16x32_bf16 a[116:119], a[180:183], a[36:39], a[116:119]
    ds_read_b128 a[72:75], v35 offset:51200
    s_waitcnt lgkmcnt(11)
    v_mfma_f32_16x16x32_bf16 a[120:123], a[184:187], a[20:23], a[120:123]
    buffer_load_dwordx4 v42, s[28:31], s57 offen offset:256 lds
    s_add_u32 m0, s52, 84608
    v_mfma_f32_16x16x32_bf16 a[124:127], a[184:187], a[24:27], a[124:127]
    ds_read_b64_tr_b16 a[164:165], v31 offset:0
    v_mfma_f32_16x16x32_bf16 a[128:131], a[184:187], a[28:31], a[128:131]
    ds_read_b128 a[76:79], v35 offset:52224
    v_mfma_f32_16x16x32_bf16 a[132:135], a[184:187], a[32:35], a[132:135]
    ds_read_b64_tr_b16 a[166:167], v31 offset:8192
    v_mfma_f32_16x16x32_bf16 a[136:139], a[184:187], a[36:39], a[136:139]
    v_mfma_f32_16x16x32_bf16 a[140:143], a[188:191], a[20:23], a[140:143]
    buffer_load_dwordx4 v42, s[28:31], s57 offen offset:384 lds
    v_mfma_f32_16x16x32_bf16 a[144:147], a[188:191], a[24:27], a[144:147]
    v_mfma_f32_16x16x32_bf16 a[148:151], a[188:191], a[28:31], a[148:151]
    v_mfma_f32_16x16x32_bf16 a[152:155], a[188:191], a[32:35], a[152:155]
    v_mfma_f32_16x16x32_bf16 a[156:159], a[188:191], a[36:39], a[156:159]
    s_waitcnt lgkmcnt(1)
    s_waitcnt vmcnt(12)
    s_barrier
    v_mfma_f32_16x16x32_bf16 a[80:83], a[192:195], a[40:43], a[80:83]
    v_mfma_f32_16x16x32_bf16 a[84:87], a[192:195], a[44:47], a[84:87]
    ds_read_b64_tr_b16 a[168:169], v28 offset:16384
    v_mfma_f32_16x16x32_bf16 a[88:91], a[192:195], a[48:51], a[88:91]
    ds_read_b64_tr_b16 a[170:171], v28 offset:24576
    v_mfma_f32_16x16x32_bf16 a[92:95], a[192:195], a[52:55], a[92:95]
    s_mov_b32 s60, s55
    v_mfma_f32_16x16x32_bf16 a[96:99], a[192:195], a[56:59], a[96:99]
    ds_read_b128 a[0:3], v35 offset:53248
    v_mfma_f32_16x16x32_bf16 a[100:103], a[196:199], a[40:43], a[100:103]
    v_and_b32 v7, 15, v0
    v_lshlrev_b32 v7, 4, v7
    s_lshl_b32 s59, s45, 2
    s_add_u32 s59, s59, 161792
    v_add_u32 v7, s59, v7
    ds_write_b32 v7, v216 offset:0
    ds_write_b32 v7, v220 offset:256
    ds_write_b32 v7, v224 offset:512
    ds_write_b32 v7, v228 offset:768
    ds_write_b32 v7, v232 offset:1024
    v_mfma_f32_16x16x32_bf16 a[104:107], a[196:199], a[44:47], a[104:107]
    ds_read_b64_tr_b16 a[172:173], v29 offset:16384
    v_mfma_f32_16x16x32_bf16 a[108:111], a[196:199], a[48:51], a[108:111]
    ds_read_b64_tr_b16 a[174:175], v29 offset:24576
    v_mfma_f32_16x16x32_bf16 a[112:115], a[196:199], a[52:55], a[112:115]
    s_add_u32 m0, s53, 98304
    s_lshl_b32 s61, s60, 7
    s_add_u32 s60, s60, 1
    s_cmp_eq_u32 s60, 7
    s_cselect_b32 s60, 0, s60
    buffer_load_dwordx4 v43, s[36:39], s61 offen lds
    s_add_u32 m0, s53, 102400
    v_mfma_f32_16x16x32_bf16 a[116:119], a[196:199], a[56:59], a[116:119]
    ds_read_b128 a[4:7], v35 offset:54272
    s_waitcnt lgkmcnt(11)
    v_mfma_f32_16x16x32_bf16 a[120:123], a[160:163], a[40:43], a[120:123]
    ds_read_b64_tr_b16 a[176:177], v30 offset:16384
    v_mfma_f32_16x16x32_bf16 a[124:127], a[160:163], a[44:47], a[124:127]
    ds_read_b64_tr_b16 a[178:179], v30 offset:24576
    v_mfma_f32_16x16x32_bf16 a[128:131], a[160:163], a[48:51], a[128:131]
    ds_read_b128 a[8:11], v35 offset:55296
    v_mfma_f32_16x16x32_bf16 a[132:135], a[160:163], a[52:55], a[132:135]
    s_add_u32 s57, s61, 28672
    buffer_load_dwordx4 v43, s[36:39], s57 offen lds
    s_add_u32 m0, s53, 106496
    v_mfma_f32_16x16x32_bf16 a[136:139], a[160:163], a[56:59], a[136:139]
    ds_read_b128 a[12:15], v35 offset:56320
    v_mfma_f32_16x16x32_bf16 a[140:143], a[164:167], a[40:43], a[140:143]
    ds_read_b64_tr_b16 a[180:181], v31 offset:16384
    v_mfma_f32_16x16x32_bf16 a[144:147], a[164:167], a[44:47], a[144:147]
    ds_read_b64_tr_b16 a[182:183], v31 offset:24576
    v_mfma_f32_16x16x32_bf16 a[148:151], a[164:167], a[48:51], a[148:151]
    s_add_u32 s56, s61, 57344
    buffer_load_dwordx4 v43, s[36:39], s56 offen lds
    s_add_u32 m0, s53, 110592
    v_mfma_f32_16x16x32_bf16 a[152:155], a[164:167], a[52:55], a[152:155]
    ds_read_b128 a[16:19], v35 offset:57344
    v_mfma_f32_16x16x32_bf16 a[156:159], a[164:167], a[56:59], a[156:159]
    ds_read_b64_tr_b16 a[184:185], v28 offset:32768
    s_waitcnt lgkmcnt(9)
    v_mfma_f32_16x16x32_bf16 a[80:83], a[168:171], a[60:63], a[80:83]
    ds_read_b64_tr_b16 a[186:187], v28 offset:40960
    v_mfma_f32_16x16x32_bf16 a[84:87], a[168:171], a[64:67], a[84:87]
    s_add_u32 s57, s61, 86016
    buffer_load_dwordx4 v43, s[36:39], s57 offen lds
    s_add_u32 m0, s53, 114688
    v_mfma_f32_16x16x32_bf16 a[88:91], a[168:171], a[68:71], a[88:91]
    ds_read_b128 a[20:23], v35 offset:58368
    v_mfma_f32_16x16x32_bf16 a[92:95], a[168:171], a[72:75], a[92:95]
    ds_read_b64_tr_b16 a[188:189], v29 offset:32768
    v_mfma_f32_16x16x32_bf16 a[96:99], a[168:171], a[76:79], a[96:99]
    ds_read_b128 a[24:27], v35 offset:59392
    v_mfma_f32_16x16x32_bf16 a[100:103], a[172:175], a[60:63], a[100:103]
    ds_read_b64_tr_b16 a[190:191], v29 offset:40960
    v_mfma_f32_16x16x32_bf16 a[104:107], a[172:175], a[64:67], a[104:107]
    s_add_u32 s56, s61, 114688
    buffer_load_dwordx4 v43, s[36:39], s56 offen lds
    s_add_u32 m0, s53, 118784
    v_mfma_f32_16x16x32_bf16 a[108:111], a[172:175], a[68:71], a[108:111]
    ds_read_b128 a[28:31], v35 offset:60416
    v_mfma_f32_16x16x32_bf16 a[112:115], a[172:175], a[72:75], a[112:115]
    ds_read_b64_tr_b16 a[192:193], v30 offset:32768
    v_mfma_f32_16x16x32_bf16 a[116:119], a[172:175], a[76:79], a[116:119]
    s_add_u32 s57, s61, 143360
    buffer_load_dwordx4 v43, s[36:39], s57 offen lds
    s_add_u32 m0, s53, 122880
    s_waitcnt lgkmcnt(9)
    v_mfma_f32_16x16x32_bf16 a[120:123], a[176:179], a[60:63], a[120:123]
    ds_read_b64_tr_b16 a[194:195], v30 offset:40960
    v_mfma_f32_16x16x32_bf16 a[124:127], a[176:179], a[64:67], a[124:127]
    ds_read_b128 a[32:35], v35 offset:61440
    v_mfma_f32_16x16x32_bf16 a[128:131], a[176:179], a[68:71], a[128:131]
    ds_read_b64_tr_b16 a[196:197], v31 offset:32768
    v_mfma_f32_16x16x32_bf16 a[132:135], a[176:179], a[72:75], a[132:135]
    s_add_u32 s56, s61, 172032
    buffer_load_dwordx4 v43, s[36:39], s56 offen lds
    s_add_u32 m0, s53, 126976
    v_mfma_f32_16x16x32_bf16 a[136:139], a[176:179], a[76:79], a[136:139]
    ds_read_b128 a[36:39], v35 offset:62464
    v_mfma_f32_16x16x32_bf16 a[140:143], a[180:183], a[60:63], a[140:143]
    ds_read_b64_tr_b16 a[198:199], v31 offset:40960
    v_mfma_f32_16x16x32_bf16 a[144:147], a[180:183], a[64:67], a[144:147]
    s_add_u32 s57, s61, 200704
    buffer_load_dwordx4 v43, s[36:39], s57 offen lds
    v_mfma_f32_16x16x32_bf16 a[148:151], a[180:183], a[68:71], a[148:151]
    v_mfma_f32_16x16x32_bf16 a[152:155], a[180:183], a[72:75], a[152:155]
    v_mfma_f32_16x16x32_bf16 a[156:159], a[180:183], a[76:79], a[156:159]
    s_waitcnt lgkmcnt(1)
    s_waitcnt vmcnt(8)
    s_barrier
    v_mfma_f32_16x16x32_bf16 a[80:83], a[184:187], a[0:3], a[80:83]
    v_mfma_f32_16x16x32_bf16 a[84:87], a[184:187], a[4:7], a[84:87]
    ds_read_b64_tr_b16 a[160:161], v28 offset:49152
    ds_read_b64_tr_b16 a[162:163], v28 offset:57344
    v_mfma_f32_16x16x32_bf16 a[88:91], a[184:187], a[8:11], a[88:91]
    v_and_b32 v7, 15, v0
    v_lshlrev_b32 v7, 4, v7
    v_add_u32 v7, 161792, v7
    ds_read_b128 v[216:219], v7 offset:0
    ds_read_b128 v[220:223], v7 offset:256
    ds_read_b128 v[224:227], v7 offset:512
    ds_read_b128 v[228:231], v7 offset:768
    ds_read_b128 v[232:235], v7 offset:1024
    v_mfma_f32_16x16x32_bf16 a[92:95], a[184:187], a[12:15], a[92:95]
    s_add_u32 m0, s53, 0
    s_lshl_b32 s61, s60, 7
    s_add_u32 s60, s60, 1
    s_cmp_eq_u32 s60, 7
    s_cselect_b32 s60, 0, s60
    buffer_load_dwordx4 v43, s[36:39], s61 offen lds
    s_add_u32 m0, s53, 4096
    v_mfma_f32_16x16x32_bf16 a[96:99], a[184:187], a[16:19], a[96:99]
    ds_read_b128 a[40:43], v35 offset:32768
    ds_read_b64_tr_b16 a[164:165], v29 offset:49152
    v_mfma_f32_16x16x32_bf16 a[100:103], a[188:191], a[0:3], a[100:103]
    ds_read_b64_tr_b16 a[166:167], v29 offset:57344
    v_mfma_f32_16x16x32_bf16 a[104:107], a[188:191], a[4:7], a[104:107]
    v_bfe_u32 v6, v0, 2, 3
    v_bfe_u32 v46, v0, 1, 1
    s_lshl_b32 s59, s45, 1
    v_or_b32 v46, s59, v46
    v_xor_b32 v46, v46, v6
    v_lshlrev_b32 v46, 4, v46
    v_lshl_add_u32 v46, v6, 7, v46
    v_and_b32 v6, 1, v0
    v_lshl_add_u32 v46, v6, 3, v46
    v_lshrrev_b32 v6, 5, v0
    v_lshl_add_u32 v32, v6, 10, v46
    v_mfma_f32_16x16x32_bf16 a[108:111], a[188:191], a[8:11], a[108:111]
    ds_read_b128 a[44:47], v35 offset:33792
    v_mfma_f32_16x16x32_bf16 a[112:115], a[188:191], a[12:15], a[112:115]
    s_add_u32 s57, s61, 28672
    buffer_load_dwordx4 v43, s[36:39], s57 offen lds
    s_add_u32 m0, s53, 8192
    v_mfma_f32_16x16x32_bf16 a[116:119], a[188:191], a[16:19], a[116:119]
    ds_read_b64_tr_b16 a[168:169], v30 offset:49152
    ds_read_b64_tr_b16 a[170:171], v30 offset:57344
    s_waitcnt lgkmcnt(13)
    v_mfma_f32_16x16x32_bf16 a[120:123], a[192:195], a[0:3], a[120:123]
    ds_read_b128 a[48:51], v35 offset:34816
    v_mfma_f32_16x16x32_bf16 a[124:127], a[192:195], a[4:7], a[124:127]
    s_add_u32 s56, s61, 57344
    buffer_load_dwordx4 v43, s[36:39], s56 offen lds
    s_add_u32 m0, s53, 12288
    v_mfma_f32_16x16x32_bf16 a[128:131], a[192:195], a[8:11], a[128:131]
    ds_read_b128 a[52:55], v35 offset:35840
    ds_read_b64_tr_b16 a[172:173], v31 offset:49152
    v_mfma_f32_16x16x32_bf16 a[132:135], a[192:195], a[12:15], a[132:135]
    ds_read_b64_tr_b16 a[174:175], v31 offset:57344
    ds_read_b128 a[56:59], v35 offset:36864
    v_mfma_f32_16x16x32_bf16 a[136:139], a[192:195], a[16:19], a[136:139]
    s_add_u32 s57, s61, 86016
    buffer_load_dwordx4 v43, s[36:39], s57 offen lds
    s_add_u32 m0, s53, 16384
    v_mfma_f32_16x16x32_bf16 a[140:143], a[196:199], a[0:3], a[140:143]
    v_xor_b32 v28, 0x10000, v28
    v_xor_b32 v29, 0x10000, v29
    v_xor_b32 v30, 0x10000, v30
    v_xor_b32 v31, 0x10000, v31
    ds_read_b64_tr_b16 a[176:177], v28 offset:0
    v_mfma_f32_16x16x32_bf16 a[144:147], a[196:199], a[4:7], a[144:147]
    ds_read_b64_tr_b16 a[178:179], v28 offset:8192
    ds_read_b128 a[60:63], v35 offset:37888
    v_mfma_f32_16x16x32_bf16 a[148:151], a[196:199], a[8:11], a[148:151]
    s_waitcnt lgkmcnt(15)
    v_add_f32 v216, v216, v217
    v_add_f32 v218, v218, v219
    v_add_f32 v48, v216, v218
    v_rcp_f32 v48, v48
    v_mfma_f32_16x16x32_bf16 a[152:155], a[196:199], a[12:15], a[152:155]
    s_add_u32 s56, s61, 114688
    buffer_load_dwordx4 v43, s[36:39], s56 offen lds
    s_add_u32 m0, s53, 20480
    v_mfma_f32_16x16x32_bf16 a[156:159], a[196:199], a[16:19], a[156:159]
    ds_read_b64_tr_b16 a[180:181], v28 offset:16384
    s_waitcnt lgkmcnt(12)
    v_mfma_f32_16x16x32_bf16 a[80:83], a[160:163], a[20:23], a[80:83]
    ds_read_b128 a[64:67], v35 offset:38912
    v_mfma_f32_16x16x32_bf16 a[84:87], a[160:163], a[24:27], a[84:87]
    v_add_f32 v220, v220, v221
    v_add_f32 v222, v222, v223
    v_add_f32 v49, v220, v222
    v_rcp_f32 v49, v49
    v_mfma_f32_16x16x32_bf16 a[88:91], a[160:163], a[28:31], a[88:91]
    ds_read_b64_tr_b16 a[182:183], v28 offset:24576
    v_mfma_f32_16x16x32_bf16 a[92:95], a[160:163], a[32:35], a[92:95]
    v_add_f32 v224, v224, v225
    v_add_f32 v226, v226, v227
    v_add_f32 v50, v224, v226
    v_rcp_f32 v50, v50
    v_mfma_f32_16x16x32_bf16 a[96:99], a[160:163], a[36:39], a[96:99]
    ds_read_b128 a[68:71], v35 offset:39936
    v_mfma_f32_16x16x32_bf16 a[100:103], a[164:167], a[20:23], a[100:103]
    s_add_u32 s57, s61, 143360
    buffer_load_dwordx4 v43, s[36:39], s57 offen lds
    s_add_u32 m0, s53, 24576
    v_mfma_f32_16x16x32_bf16 a[104:107], a[164:167], a[24:27], a[104:107]
    ds_read_b64_tr_b16 a[184:185], v29 offset:0
    v_mfma_f32_16x16x32_bf16 a[108:111], a[164:167], a[28:31], a[108:111]
    v_add_f32 v228, v228, v229
    v_add_f32 v230, v230, v231
    v_add_f32 v51, v228, v230
    v_rcp_f32 v51, v51
    v_mfma_f32_16x16x32_bf16 a[112:115], a[164:167], a[32:35], a[112:115]
    ds_read_b64_tr_b16 a[186:187], v29 offset:8192
    v_mfma_f32_16x16x32_bf16 a[116:119], a[164:167], a[36:39], a[116:119]
    ds_read_b128 a[72:75], v35 offset:40960
    s_waitcnt lgkmcnt(11)
    v_mfma_f32_16x16x32_bf16 a[120:123], a[168:171], a[20:23], a[120:123]
    v_add_f32 v232, v232, v233
    v_add_f32 v234, v234, v235
    v_add_f32 v52, v232, v234
    v_rcp_f32 v52, v52
    v_mfma_f32_16x16x32_bf16 a[124:127], a[168:171], a[24:27], a[124:127]
    s_add_u32 s56, s61, 172032
    buffer_load_dwordx4 v43, s[36:39], s56 offen lds
    s_add_u32 m0, s53, 28672
    v_mfma_f32_16x16x32_bf16 a[128:131], a[168:171], a[28:31], a[128:131]
    ds_read_b64_tr_b16 a[188:189], v29 offset:16384
    v_mfma_f32_16x16x32_bf16 a[132:135], a[168:171], a[32:35], a[132:135]
    ds_read_b128 a[76:79], v35 offset:41984
    v_mfma_f32_16x16x32_bf16 a[136:139], a[168:171], a[36:39], a[136:139]
    ds_read_b64_tr_b16 a[190:191], v29 offset:24576
    v_mfma_f32_16x16x32_bf16 a[140:143], a[172:175], a[20:23], a[140:143]
    s_add_u32 s57, s61, 200704
    buffer_load_dwordx4 v43, s[36:39], s57 offen lds
    v_mfma_f32_16x16x32_bf16 a[144:147], a[172:175], a[24:27], a[144:147]
    v_mfma_f32_16x16x32_bf16 a[148:151], a[172:175], a[28:31], a[148:151]
    v_mfma_f32_16x16x32_bf16 a[152:155], a[172:175], a[32:35], a[152:155]
    v_mfma_f32_16x16x32_bf16 a[156:159], a[172:175], a[36:39], a[156:159]
    s_waitcnt lgkmcnt(1)
    s_waitcnt vmcnt(12)
    s_barrier
    v_mfma_f32_16x16x32_bf16 a[80:83], a[176:179], a[40:43], a[80:83]
    ds_read_b64_tr_b16 a[192:193], v30 offset:0
    s_add_u32 s59, s53, 131072
    v_add_u32 v6, s59, v34
    v_subrev_u32 v7, 49152, v6
    v_mfma_f32_16x16x32_bf16 a[84:87], a[176:179], a[44:47], a[84:87]
    ds_read_b64_tr_b16 a[194:195], v30 offset:8192
    v_mfma_f32_16x16x32_bf16 a[88:91], a[176:179], a[48:51], a[88:91]
    v_mfma_f32_16x16x32_bf16 a[92:95], a[176:179], a[52:55], a[92:95]
    v_mfma_f32_16x16x32_bf16 a[96:99], a[176:179], a[56:59], a[96:99]
    ds_read_b64_tr_b16 a[196:197], v30 offset:16384
    v_mfma_f32_16x16x32_bf16 a[80:83], a[180:183], a[60:63], a[80:83]
    ds_read_b64_tr_b16 a[198:199], v30 offset:24576
    v_mfma_f32_16x16x32_bf16 a[84:87], a[180:183], a[64:67], a[84:87]
    v_mfma_f32_16x16x32_bf16 a[88:91], a[180:183], a[68:71], a[88:91]
    v_mfma_f32_16x16x32_bf16 a[92:95], a[180:183], a[72:75], a[92:95]
    ds_read_b64_tr_b16 a[160:161], v31 offset:0
    v_mfma_f32_16x16x32_bf16 a[96:99], a[180:183], a[76:79], a[96:99]
    ds_read_b64_tr_b16 a[162:163], v31 offset:8192
    s_waitcnt lgkmcnt(6)
    v_mfma_f32_16x16x32_bf16 a[100:103], a[184:187], a[40:43], a[100:103]
    v_mfma_f32_16x16x32_bf16 a[104:107], a[184:187], a[44:47], a[104:107]
    v_mfma_f32_16x16x32_bf16 a[108:111], a[184:187], a[48:51], a[108:111]
    v_accvgpr_read_b32 v56, a80
    v_accvgpr_read_b32 v57, a81
    v_accvgpr_read_b32 v58, a82
    v_accvgpr_read_b32 v59, a83
    v_mul_f32 v56, v56, v48
    v_mul_f32 v57, v57, v48
    v_mul_f32 v58, v58, v48
    v_mul_f32 v59, v59, v48
    v_cvt_pk_bf16_f32 v56, v56, v57
    v_cvt_pk_bf16_f32 v57, v58, v59
    ds_read_b64_tr_b16 a[164:165], v31 offset:16384
    v_mfma_f32_16x16x32_bf16 a[112:115], a[184:187], a[52:55], a[112:115]
    v_accvgpr_read_b32 v60, a84
    v_accvgpr_read_b32 v61, a85
    v_accvgpr_read_b32 v62, a86
    v_accvgpr_read_b32 v63, a87
    v_mul_f32 v60, v60, v49
    v_mul_f32 v61, v61, v49
    v_mul_f32 v62, v62, v49
    v_mul_f32 v63, v63, v49
    v_cvt_pk_bf16_f32 v60, v60, v61
    v_cvt_pk_bf16_f32 v61, v62, v63
    ds_read_b64_tr_b16 a[166:167], v31 offset:24576
    v_mfma_f32_16x16x32_bf16 a[116:119], a[184:187], a[56:59], a[116:119]
    v_accvgpr_read_b32 v64, a88
    v_accvgpr_read_b32 v65, a89
    v_accvgpr_read_b32 v66, a90
    v_accvgpr_read_b32 v67, a91
    v_mul_f32 v64, v64, v50
    v_mul_f32 v65, v65, v50
    v_mul_f32 v66, v66, v50
    v_mul_f32 v67, v67, v50
    v_cvt_pk_bf16_f32 v64, v64, v65
    v_cvt_pk_bf16_f32 v65, v66, v67
    v_mfma_f32_16x16x32_bf16 a[100:103], a[188:191], a[60:63], a[100:103]
    v_accvgpr_read_b32 v68, a92
    v_accvgpr_read_b32 v69, a93
    v_accvgpr_read_b32 v70, a94
    v_accvgpr_read_b32 v71, a95
    v_mul_f32 v68, v68, v51
    v_mul_f32 v69, v69, v51
    v_mul_f32 v70, v70, v51
    v_mul_f32 v71, v71, v51
    v_cvt_pk_bf16_f32 v68, v68, v69
    v_cvt_pk_bf16_f32 v69, v70, v71
    v_mfma_f32_16x16x32_bf16 a[104:107], a[188:191], a[64:67], a[104:107]
    v_accvgpr_read_b32 v72, a96
    v_accvgpr_read_b32 v73, a97
    v_accvgpr_read_b32 v74, a98
    v_accvgpr_read_b32 v75, a99
    v_mul_f32 v72, v72, v52
    v_mul_f32 v73, v73, v52
    v_mul_f32 v74, v74, v52
    v_mul_f32 v75, v75, v52
    v_cvt_pk_bf16_f32 v72, v72, v73
    v_cvt_pk_bf16_f32 v73, v74, v75
    v_mfma_f32_16x16x32_bf16 a[108:111], a[188:191], a[68:71], a[108:111]
    v_xor_b32 v32, 0x10000, v32
    ds_read_b64_tr_b16 a[168:169], v32 offset:32768
    v_mfma_f32_16x16x32_bf16 a[112:115], a[188:191], a[72:75], a[112:115]
    ds_read_b64_tr_b16 a[170:171], v32 offset:34816
    v_mfma_f32_16x16x32_bf16 a[116:119], a[188:191], a[76:79], a[116:119]
    s_waitcnt lgkmcnt(6)
    v_mfma_f32_16x16x32_bf16 a[120:123], a[192:195], a[40:43], a[120:123]
    v_mfma_f32_16x16x32_bf16 a[124:127], a[192:195], a[44:47], a[124:127]
    ds_read_b64_tr_b16 a[172:173], v32 offset:40960
    v_mfma_f32_16x16x32_bf16 a[128:131], a[192:195], a[48:51], a[128:131]
    v_accvgpr_read_b32 v76, a100
    v_accvgpr_read_b32 v77, a101
    v_accvgpr_read_b32 v78, a102
    v_accvgpr_read_b32 v79, a103
    v_mul_f32 v76, v76, v48
    v_mul_f32 v77, v77, v48
    v_mul_f32 v78, v78, v48
    v_mul_f32 v79, v79, v48
    v_cvt_pk_bf16_f32 v58, v76, v77
    v_cvt_pk_bf16_f32 v59, v78, v79
    ds_write_b128 v6, v[56:59] offset:0
    ds_read_b64_tr_b16 a[174:175], v32 offset:43008
    v_mfma_f32_16x16x32_bf16 a[132:135], a[192:195], a[52:55], a[132:135]
    v_accvgpr_read_b32 v80, a104
    v_accvgpr_read_b32 v81, a105
    v_accvgpr_read_b32 v82, a106
    v_accvgpr_read_b32 v83, a107
    v_mul_f32 v80, v80, v49
    v_mul_f32 v81, v81, v49
    v_mul_f32 v82, v82, v49
    v_mul_f32 v83, v83, v49
    v_cvt_pk_bf16_f32 v62, v80, v81
    v_cvt_pk_bf16_f32 v63, v82, v83
    ds_write_b128 v6, v[60:63] offset:4096
    v_mfma_f32_16x16x32_bf16 a[136:139], a[192:195], a[56:59], a[136:139]
    v_accvgpr_read_b32 v84, a108
    v_accvgpr_read_b32 v85, a109
    v_accvgpr_read_b32 v86, a110
    v_accvgpr_read_b32 v87, a111
    v_mul_f32 v84, v84, v50
    v_mul_f32 v85, v85, v50
    v_mul_f32 v86, v86, v50
    v_mul_f32 v87, v87, v50
    v_cvt_pk_bf16_f32 v66, v84, v85
    v_cvt_pk_bf16_f32 v67, v86, v87
    ds_write_b128 v6, v[64:67] offset:8192
    v_mfma_f32_16x16x32_bf16 a[120:123], a[196:199], a[60:63], a[120:123]
    v_accvgpr_read_b32 v88, a112
    v_accvgpr_read_b32 v89, a113
    v_accvgpr_read_b32 v90, a114
    v_accvgpr_read_b32 v91, a115
    v_mul_f32 v88, v88, v51
    v_mul_f32 v89, v89, v51
    v_mul_f32 v90, v90, v51
    v_mul_f32 v91, v91, v51
    v_cvt_pk_bf16_f32 v70, v88, v89
    v_cvt_pk_bf16_f32 v71, v90, v91
    ds_write_b128 v6, v[68:71] offset:12288
    ds_read_b64_tr_b16 a[176:177], v32 offset:36864
    v_mfma_f32_16x16x32_bf16 a[124:127], a[196:199], a[64:67], a[124:127]
    v_accvgpr_read_b32 v92, a116
    v_accvgpr_read_b32 v93, a117
    v_accvgpr_read_b32 v94, a118
    v_accvgpr_read_b32 v95, a119
    v_mul_f32 v92, v92, v52
    v_mul_f32 v93, v93, v52
    v_mul_f32 v94, v94, v52
    v_mul_f32 v95, v95, v52
    v_cvt_pk_bf16_f32 v74, v92, v93
    v_cvt_pk_bf16_f32 v75, v94, v95
    ds_write_b128 v6, v[72:75] offset:16384
    ds_read_b64_tr_b16 a[178:179], v32 offset:38912
    v_mfma_f32_16x16x32_bf16 a[128:131], a[196:199], a[68:71], a[128:131]
    v_mfma_f32_16x16x32_bf16 a[132:135], a[196:199], a[72:75], a[132:135]
    s_waitcnt lgkmcnt(0)
    s_barrier
    ds_read_b128 v[136:139], v35 offset:32768
    v_mfma_f32_16x16x32_bf16 a[136:139], a[196:199], a[76:79], a[136:139]
    ds_read_b128 v[140:143], v35 offset:36864
    ds_read_b64_tr_b16 a[180:181], v32 offset:45056
    v_mfma_f32_16x16x32_bf16 a[140:143], a[160:163], a[40:43], a[140:143]
    ds_read_b128 v[144:147], v35 offset:40960
    ds_read_b64_tr_b16 a[182:183], v32 offset:47104
    ds_read_b128 v[148:151], v35 offset:45056
    v_mfma_f32_16x16x32_bf16 a[144:147], a[160:163], a[44:47], a[144:147]
    ds_read_b128 v[152:155], v35 offset:49152
    v_mfma_f32_16x16x32_bf16 a[148:151], a[160:163], a[48:51], a[148:151]
    v_accvgpr_read_b32 v96, a120
    v_accvgpr_read_b32 v97, a121
    v_accvgpr_read_b32 v98, a122
    v_accvgpr_read_b32 v99, a123
    v_mul_f32 v96, v96, v48
    v_mul_f32 v97, v97, v48
    v_mul_f32 v98, v98, v48
    v_mul_f32 v99, v99, v48
    v_cvt_pk_bf16_f32 v96, v96, v97
    v_cvt_pk_bf16_f32 v97, v98, v99
    ds_read_b128 v[156:159], v35 offset:33792
    ds_read_b128 v[160:163], v35 offset:37888
    v_mfma_f32_16x16x32_bf16 a[152:155], a[160:163], a[52:55], a[152:155]
    v_accvgpr_read_b32 v100, a124
    v_accvgpr_read_b32 v101, a125
    v_accvgpr_read_b32 v102, a126
    v_accvgpr_read_b32 v103, a127
    v_mul_f32 v100, v100, v49
    v_mul_f32 v101, v101, v49
    v_mul_f32 v102, v102, v49
    v_mul_f32 v103, v103, v49
    v_cvt_pk_bf16_f32 v100, v100, v101
    v_cvt_pk_bf16_f32 v101, v102, v103
    ds_read_b128 v[164:167], v35 offset:41984
    ds_read_b128 v[168:171], v35 offset:46080
    v_mfma_f32_16x16x32_bf16 a[156:159], a[160:163], a[56:59], a[156:159]
    v_accvgpr_read_b32 v104, a128
    v_accvgpr_read_b32 v105, a129
    v_accvgpr_read_b32 v106, a130
    v_accvgpr_read_b32 v107, a131
    v_mul_f32 v104, v104, v50
    v_mul_f32 v105, v105, v50
    v_mul_f32 v106, v106, v50
    v_mul_f32 v107, v107, v50
    v_cvt_pk_bf16_f32 v104, v104, v105
    v_cvt_pk_bf16_f32 v105, v106, v107
    ds_read_b128 v[172:175], v35 offset:50176
    v_mfma_f32_16x16x32_bf16 a[140:143], a[164:167], a[60:63], a[140:143]
    v_accvgpr_read_b32 v108, a132
    v_accvgpr_read_b32 v109, a133
    v_accvgpr_read_b32 v110, a134
    v_accvgpr_read_b32 v111, a135
    v_mul_f32 v108, v108, v51
    v_mul_f32 v109, v109, v51
    v_mul_f32 v110, v110, v51
    v_mul_f32 v111, v111, v51
    v_cvt_pk_bf16_f32 v108, v108, v109
    v_cvt_pk_bf16_f32 v109, v110, v111
    ds_read_b128 v[176:179], v35 offset:34816
    ds_read_b128 v[180:183], v35 offset:38912
    v_mfma_f32_16x16x32_bf16 a[144:147], a[164:167], a[64:67], a[144:147]
    v_accvgpr_read_b32 v112, a136
    v_accvgpr_read_b32 v113, a137
    v_accvgpr_read_b32 v114, a138
    v_accvgpr_read_b32 v115, a139
    v_mul_f32 v112, v112, v52
    v_mul_f32 v113, v113, v52
    v_mul_f32 v114, v114, v52
    v_mul_f32 v115, v115, v52
    v_cvt_pk_bf16_f32 v112, v112, v113
    v_cvt_pk_bf16_f32 v113, v114, v115
    ds_read_b128 v[184:187], v35 offset:43008
    ds_read_b128 v[188:191], v35 offset:47104
    v_mfma_f32_16x16x32_bf16 a[148:151], a[164:167], a[68:71], a[148:151]
    ds_read_b128 v[192:195], v35 offset:51200
    v_mfma_f32_16x16x32_bf16 a[152:155], a[164:167], a[72:75], a[152:155]
    ds_read_b128 v[196:199], v35 offset:35840
    ds_read_b128 v[200:203], v35 offset:39936
    v_mfma_f32_16x16x32_bf16 a[156:159], a[164:167], a[76:79], a[156:159]
    ds_read_b128 v[204:207], v35 offset:44032
    ds_read_b128 v[208:211], v35 offset:48128
    ds_read_b128 v[212:215], v35 offset:52224
    v_accvgpr_read_b32 v116, a140
    v_accvgpr_read_b32 v117, a141
    v_accvgpr_read_b32 v118, a142
    v_accvgpr_read_b32 v119, a143
    v_mul_f32 v116, v116, v48
    v_mul_f32 v117, v117, v48
    v_mul_f32 v118, v118, v48
    v_mul_f32 v119, v119, v48
    v_cvt_pk_bf16_f32 v98, v116, v117
    v_cvt_pk_bf16_f32 v99, v118, v119
    ds_write_b128 v7, v[96:99] offset:0
    v_accvgpr_read_b32 v120, a144
    v_accvgpr_read_b32 v121, a145
    v_accvgpr_read_b32 v122, a146
    v_accvgpr_read_b32 v123, a147
    v_mul_f32 v120, v120, v49
    v_mul_f32 v121, v121, v49
    v_mul_f32 v122, v122, v49
    v_mul_f32 v123, v123, v49
    v_cvt_pk_bf16_f32 v102, v120, v121
    v_cvt_pk_bf16_f32 v103, v122, v123
    ds_write_b128 v7, v[100:103] offset:4096
    v_accvgpr_read_b32 v124, a148
    v_accvgpr_read_b32 v125, a149
    v_accvgpr_read_b32 v126, a150
    v_accvgpr_read_b32 v127, a151
    v_mul_f32 v124, v124, v50
    v_mul_f32 v125, v125, v50
    v_mul_f32 v126, v126, v50
    v_mul_f32 v127, v127, v50
    v_cvt_pk_bf16_f32 v106, v124, v125
    v_cvt_pk_bf16_f32 v107, v126, v127
    ds_write_b128 v7, v[104:107] offset:8192
    v_accvgpr_read_b32 v128, a152
    v_accvgpr_read_b32 v129, a153
    v_accvgpr_read_b32 v130, a154
    v_accvgpr_read_b32 v131, a155
    v_mul_f32 v128, v128, v51
    v_mul_f32 v129, v129, v51
    v_mul_f32 v130, v130, v51
    v_mul_f32 v131, v131, v51
    v_cvt_pk_bf16_f32 v110, v128, v129
    v_cvt_pk_bf16_f32 v111, v130, v131
    ds_write_b128 v6, v[108:111] offset:20480
    v_accvgpr_read_b32 v132, a156
    v_accvgpr_read_b32 v133, a157
    v_accvgpr_read_b32 v134, a158
    v_accvgpr_read_b32 v135, a159
    v_mul_f32 v132, v132, v52
    v_mul_f32 v133, v133, v52
    v_mul_f32 v134, v134, v52
    v_mul_f32 v135, v135, v52
    v_cvt_pk_bf16_f32 v114, v132, v133
    v_cvt_pk_bf16_f32 v115, v134, v135
    ds_write_b128 v6, v[112:115] offset:24576
    s_add_u32 m0, s53, 32768
    s_lshl_b32 s61, s60, 7
    s_add_u32 s60, s60, 1
    s_cmp_eq_u32 s60, 7
    s_cselect_b32 s60, 0, s60
    buffer_load_dwordx4 v43, s[36:39], s61 offen lds
    s_add_u32 m0, s53, 36864
    s_add_u32 s57, s61, 28672
    buffer_load_dwordx4 v43, s[36:39], s57 offen lds
    s_add_u32 m0, s53, 40960
    s_add_u32 s56, s61, 57344
    buffer_load_dwordx4 v43, s[36:39], s56 offen lds
    s_add_u32 m0, s53, 45056
    s_add_u32 s57, s61, 86016
    buffer_load_dwordx4 v43, s[36:39], s57 offen lds
    s_add_u32 m0, s53, 49152
    s_add_u32 s56, s61, 114688
    buffer_load_dwordx4 v43, s[36:39], s56 offen lds
    s_add_u32 m0, s53, 53248
    s_add_u32 s57, s61, 143360
    buffer_load_dwordx4 v43, s[36:39], s57 offen lds
    s_add_u32 m0, s53, 57344
    s_add_u32 s56, s61, 172032
    buffer_load_dwordx4 v43, s[36:39], s56 offen lds
    s_add_u32 m0, s53, 61440
    s_add_u32 s57, s61, 200704
    buffer_load_dwordx4 v43, s[36:39], s57 offen lds
    s_waitcnt lgkmcnt(0)
    s_waitcnt vmcnt(12)
    s_barrier
    v_add_u32 v6, 81920, v34
    ds_read_b128 a[0:3], v6 offset:0
    v_mfma_f32_16x16x32_bf16 v[56:59], a[168:171], v[136:139], 0
    ds_read_b128 a[4:7], v6 offset:4096
    ds_read_b64_tr_b16 a[184:185], v32 offset:49152
    v_mfma_f32_16x16x32_bf16 v[60:63], a[168:171], v[140:143], 0
    ds_read_b128 a[8:11], v6 offset:8192
    ds_read_b64_tr_b16 a[186:187], v32 offset:51200
    ds_read_b128 a[12:15], v35 offset:53248
    v_mfma_f32_16x16x32_bf16 v[64:67], a[168:171], v[144:147], 0
    ds_read_b128 a[16:19], v35 offset:57344
    v_mfma_f32_16x16x32_bf16 v[68:71], a[168:171], v[148:151], 0
    ds_read_b128 a[20:23], v6 offset:1024
    v_mfma_f32_16x16x32_bf16 v[72:75], a[168:171], v[152:155], 0
    ds_read_b128 a[24:27], v6 offset:5120
    ds_read_b64_tr_b16 a[188:189], v32 offset:57344
    v_mfma_f32_16x16x32_bf16 v[56:59], a[172:175], v[156:159], v[56:59]
    ds_read_b128 a[28:31], v6 offset:9216
    s_add_u32 m0, s53, 65536
    s_lshl_b32 s61, s60, 7
    s_add_u32 s60, s60, 1
    s_cmp_eq_u32 s60, 7
    s_cselect_b32 s60, 0, s60
    buffer_load_dwordx4 v43, s[36:39], s61 offen lds
    s_add_u32 m0, s53, 69632
    s_mul_i32 s64, s45, 18432
    s_add_u32 s65, s64, 4096
    s_add_u32 s66, s64, 8192
    s_add_u32 s67, s64, 12288
    s_add_u32 s68, s64, 16384
    ds_read_b64_tr_b16 a[190:191], v32 offset:59392
    ds_read_b128 a[32:35], v35 offset:54272
    v_mfma_f32_16x16x32_bf16 v[60:63], a[172:175], v[160:163], v[60:63]
    ds_read_b128 a[36:39], v35 offset:58368
    v_mfma_f32_16x16x32_bf16 v[64:67], a[172:175], v[164:167], v[64:67]
    ds_read_b128 a[40:43], v6 offset:2048
    v_mfma_f32_16x16x32_bf16 v[68:71], a[172:175], v[168:171], v[68:71]
    ds_read_b128 a[44:47], v6 offset:6144
    ds_read_b64_tr_b16 a[192:193], v32 offset:53248
    v_mfma_f32_16x16x32_bf16 v[72:75], a[172:175], v[172:175], v[72:75]
    ds_read_b128 a[48:51], v6 offset:10240
    ds_read_b64_tr_b16 a[194:195], v32 offset:55296
    ds_read_b128 a[52:55], v35 offset:55296
    s_waitcnt lgkmcnt(15)
    v_mfma_f32_16x16x32_bf16 v[56:59], a[176:179], a[0:3], v[56:59]
    ds_read_b128 a[56:59], v35 offset:59392
    v_mfma_f32_16x16x32_bf16 v[60:63], a[176:179], a[4:7], v[60:63]
    ds_read_b128 a[60:63], v6 offset:3072
    v_mfma_f32_16x16x32_bf16 v[64:67], a[176:179], a[8:11], v[64:67]
    ds_read_b128 a[64:67], v6 offset:7168
    ds_read_b64_tr_b16 a[196:197], v32 offset:61440
    s_waitcnt lgkmcnt(15)
    v_mfma_f32_16x16x32_bf16 v[68:71], a[176:179], a[12:15], v[68:71]
    ds_read_b128 a[68:71], v6 offset:11264
    ds_read_b128 a[72:75], v35 offset:56320
    ds_read_b64_tr_b16 a[198:199], v32 offset:63488
    v_mfma_f32_16x16x32_bf16 v[72:75], a[176:179], a[16:19], v[72:75]
    s_add_u32 s57, s61, 28672
    buffer_load_dwordx4 v43, s[36:39], s57 offen lds
    s_add_u32 m0, s53, 73728
    ds_read_b128 a[76:79], v35 offset:60416
    v_mfma_f32_16x16x32_bf16 v[56:59], a[180:183], a[20:23], v[56:59]
    v_mfma_f32_16x16x32_bf16 v[60:63], a[180:183], a[24:27], v[60:63]
    s_waitcnt lgkmcnt(15)
    v_mfma_f32_16x16x32_bf16 v[64:67], a[180:183], a[28:31], v[64:67]
    v_xor_b32 v32, 0x10000, v32
    ds_read_b64_tr_b16 a[160:161], v32 offset:4096
    v_mfma_f32_16x16x32_bf16 v[68:71], a[180:183], a[32:35], v[68:71]
    ds_read_b64_tr_b16 a[162:163], v32 offset:6144
    s_waitcnt lgkmcnt(15)
    v_mfma_f32_16x16x32_bf16 v[72:75], a[180:183], a[36:39], v[72:75]
    v_mfma_f32_16x16x32_bf16 v[56:59], a[184:187], v[176:179], v[56:59]
    v_mfma_f32_16x16x32_bf16 v[60:63], a[184:187], v[180:183], v[60:63]
    ds_read_b64_tr_b16 a[164:165], v32 offset:12288
    v_mfma_f32_16x16x32_bf16 v[64:67], a[184:187], v[184:187], v[64:67]
    ds_read_b64_tr_b16 a[166:167], v32 offset:14336
    s_add_u32 s56, s61, 57344
    buffer_load_dwordx4 v43, s[36:39], s56 offen lds
    s_add_u32 m0, s53, 77824
    v_mfma_f32_16x16x32_bf16 v[68:71], a[184:187], v[188:191], v[68:71]
    v_mfma_f32_16x16x32_bf16 v[72:75], a[184:187], v[192:195], v[72:75]
    v_mfma_f32_16x16x32_bf16 v[56:59], a[188:191], v[196:199], v[56:59]
    ds_read_b64_tr_b16 a[168:169], v32 offset:0
    v_mfma_f32_16x16x32_bf16 v[60:63], a[188:191], v[200:203], v[60:63]
    ds_read_b64_tr_b16 a[170:171], v32 offset:2048
    v_mfma_f32_16x16x32_bf16 v[64:67], a[188:191], v[204:207], v[64:67]
    v_mfma_f32_16x16x32_bf16 v[68:71], a[188:191], v[208:211], v[68:71]
    v_mfma_f32_16x16x32_bf16 v[72:75], a[188:191], v[212:215], v[72:75]
    ds_read_b64_tr_b16 a[172:173], v32 offset:8192
    s_waitcnt lgkmcnt(8)
    v_mfma_f32_16x16x32_bf16 v[56:59], a[192:195], a[40:43], v[56:59]
    ds_read_b64_tr_b16 a[174:175], v32 offset:10240
    v_mfma_f32_16x16x32_bf16 v[60:63], a[192:195], a[44:47], v[60:63]
    s_add_u32 s57, s61, 86016
    buffer_load_dwordx4 v43, s[36:39], s57 offen lds
    v_mfma_f32_16x16x32_bf16 v[64:67], a[192:195], a[48:51], v[64:67]
    v_mfma_f32_16x16x32_bf16 v[68:71], a[192:195], a[52:55], v[68:71]
    v_mfma_f32_16x16x32_bf16 v[72:75], a[192:195], a[56:59], v[72:75]
    v_mfma_f32_16x16x32_bf16 v[56:59], a[196:199], a[60:63], v[56:59]
    v_mfma_f32_16x16x32_bf16 v[60:63], a[196:199], a[64:67], v[60:63]
    v_mfma_f32_16x16x32_bf16 v[64:67], a[196:199], a[68:71], v[64:67]
    v_mfma_f32_16x16x32_bf16 v[68:71], a[196:199], a[72:75], v[68:71]
    s_waitcnt lgkmcnt(8)
    v_mfma_f32_16x16x32_bf16 v[72:75], a[196:199], a[76:79], v[72:75]
    s_waitcnt vmcnt(8)
    s_barrier
    s_waitcnt lgkmcnt(4)
    v_mfma_f32_16x16x32_bf16 v[76:79], a[160:163], a[0:3], 0
    v_mfma_f32_16x16x32_bf16 v[80:83], a[160:163], a[4:7], 0
    ds_read_b64_tr_b16 a[176:177], v32 offset:20480
    v_mfma_f32_16x16x32_bf16 v[84:87], a[160:163], a[8:11], 0
    ds_read_b64_tr_b16 a[178:179], v32 offset:22528
    v_mfma_f32_16x16x32_bf16 v[88:91], a[160:163], a[12:15], 0
    s_add_u32 m0, s53, 81920
    s_add_u32 s56, s61, 114688
    buffer_load_dwordx4 v43, s[36:39], s56 offen lds
    s_add_u32 m0, s53, 86016
    v_mfma_f32_16x16x32_bf16 v[92:95], a[160:163], a[16:19], 0
    v_cvt_pk_bf16_f32 v56, v56, v57
    ds_read_b64_tr_b16 a[180:181], v32 offset:28672
    v_mfma_f32_16x16x32_bf16 v[76:79], a[164:167], a[20:23], v[76:79]
    s_add_u32 s57, s61, 143360
    buffer_load_dwordx4 v43, s[36:39], s57 offen lds
    s_add_u32 m0, s53, 90112
    v_mfma_f32_16x16x32_bf16 v[80:83], a[164:167], a[24:27], v[80:83]
    ds_read_b64_tr_b16 a[182:183], v32 offset:30720
    v_cvt_pk_bf16_f32 v57, v58, v59
    v_mfma_f32_16x16x32_bf16 v[84:87], a[164:167], a[28:31], v[84:87]
    s_add_u32 s56, s61, 172032
    buffer_load_dwordx4 v43, s[36:39], s56 offen lds
    s_add_u32 m0, s53, 94208
    v_mfma_f32_16x16x32_bf16 v[88:91], a[164:167], a[32:35], v[88:91]
    ds_read_b64_tr_b16 a[184:185], v32 offset:16384
    v_mfma_f32_16x16x32_bf16 v[92:95], a[164:167], a[36:39], v[92:95]
    ds_read_b64_tr_b16 a[186:187], v32 offset:18432
    v_cvt_pk_bf16_f32 v58, v60, v61
    s_waitcnt lgkmcnt(6)
    v_mfma_f32_16x16x32_bf16 v[76:79], a[168:171], v[136:139], v[76:79]
    s_add_u32 s57, s61, 200704
    buffer_load_dwordx4 v43, s[36:39], s57 offen lds
    v_mfma_f32_16x16x32_bf16 v[80:83], a[168:171], v[140:143], v[80:83]
    ds_read_b64_tr_b16 a[188:189], v32 offset:24576
    v_mfma_f32_16x16x32_bf16 v[84:87], a[168:171], v[144:147], v[84:87]
    v_cvt_pk_bf16_f32 v59, v62, v63
    ds_read_b64_tr_b16 a[190:191], v32 offset:26624
    v_mfma_f32_16x16x32_bf16 v[88:91], a[168:171], v[148:151], v[88:91]
    s_add_u32 m0, s53, 98304
    s_lshl_b32 s61, s60, 7
    s_add_u32 s60, s60, 1
    s_cmp_eq_u32 s60, 7
    s_cselect_b32 s60, 0, s60
    buffer_load_dwordx4 v43, s[36:39], s61 offen lds
    s_add_u32 m0, s53, 102400
    v_mfma_f32_16x16x32_bf16 v[92:95], a[168:171], v[152:155], v[92:95]
    buffer_store_dwordx4 v[56:59], v34, s[40:43], s64 offen offset:0 nt
    v_mfma_f32_16x16x32_bf16 v[76:79], a[172:175], v[156:159], v[76:79]
    s_add_u32 s57, s61, 28672
    buffer_load_dwordx4 v43, s[36:39], s57 offen lds
    s_add_u32 m0, s53, 106496
    v_mfma_f32_16x16x32_bf16 v[80:83], a[172:175], v[160:163], v[80:83]
    ds_read_b64_tr_b16 a[192:193], v32 offset:36864
    v_mfma_f32_16x16x32_bf16 v[84:87], a[172:175], v[164:167], v[84:87]
    ds_read_b64_tr_b16 a[194:195], v32 offset:38912
    v_mfma_f32_16x16x32_bf16 v[88:91], a[172:175], v[168:171], v[88:91]
    v_cvt_pk_bf16_f32 v64, v64, v65
    v_mfma_f32_16x16x32_bf16 v[92:95], a[172:175], v[172:175], v[92:95]
    s_add_u32 s56, s61, 57344
    buffer_load_dwordx4 v43, s[36:39], s56 offen lds
    s_add_u32 m0, s53, 110592
    s_waitcnt lgkmcnt(6)
    v_mfma_f32_16x16x32_bf16 v[76:79], a[176:179], a[40:43], v[76:79]
    ds_read_b64_tr_b16 a[196:197], v32 offset:45056
    v_mfma_f32_16x16x32_bf16 v[80:83], a[176:179], a[44:47], v[80:83]
    v_cvt_pk_bf16_f32 v65, v66, v67
    ds_read_b64_tr_b16 a[198:199], v32 offset:47104
    v_mfma_f32_16x16x32_bf16 v[84:87], a[176:179], a[48:51], v[84:87]
    s_add_u32 s57, s61, 86016
    buffer_load_dwordx4 v43, s[36:39], s57 offen lds
    s_add_u32 m0, s53, 114688
    v_mfma_f32_16x16x32_bf16 v[88:91], a[176:179], a[52:55], v[88:91]
    v_cvt_pk_bf16_f32 v68, v68, v69
    v_mfma_f32_16x16x32_bf16 v[92:95], a[176:179], a[56:59], v[92:95]
    ds_read_b64_tr_b16 a[160:161], v32 offset:32768
    v_mfma_f32_16x16x32_bf16 v[76:79], a[180:183], a[60:63], v[76:79]
    s_add_u32 s56, s61, 114688
    buffer_load_dwordx4 v43, s[36:39], s56 offen lds
    s_add_u32 m0, s53, 118784
    v_mfma_f32_16x16x32_bf16 v[80:83], a[180:183], a[64:67], v[80:83]
    ds_read_b64_tr_b16 a[162:163], v32 offset:34816
    v_mfma_f32_16x16x32_bf16 v[84:87], a[180:183], a[68:71], v[84:87]
    v_cvt_pk_bf16_f32 v69, v70, v71
    v_mfma_f32_16x16x32_bf16 v[88:91], a[180:183], a[72:75], v[88:91]
    s_add_u32 s57, s61, 143360
    buffer_load_dwordx4 v43, s[36:39], s57 offen lds
    s_add_u32 m0, s53, 122880
    v_mfma_f32_16x16x32_bf16 v[92:95], a[180:183], a[76:79], v[92:95]
    ds_read_b64_tr_b16 a[164:165], v32 offset:40960
    s_waitcnt lgkmcnt(7)
    v_mfma_f32_16x16x32_bf16 v[76:79], a[184:187], v[176:179], v[76:79]
    v_cvt_pk_bf16_f32 v70, v72, v73
    v_mfma_f32_16x16x32_bf16 v[80:83], a[184:187], v[180:183], v[80:83]
    ds_read_b64_tr_b16 a[166:167], v32 offset:43008
    v_mfma_f32_16x16x32_bf16 v[84:87], a[184:187], v[184:187], v[84:87]
    s_add_u32 s56, s61, 172032
    buffer_load_dwordx4 v43, s[36:39], s56 offen lds
    s_add_u32 m0, s53, 126976
    v_mfma_f32_16x16x32_bf16 v[88:91], a[184:187], v[188:191], v[88:91]
    v_cvt_pk_bf16_f32 v71, v74, v75
    v_mfma_f32_16x16x32_bf16 v[92:95], a[184:187], v[192:195], v[92:95]
    s_add_u32 s57, s61, 200704
    buffer_load_dwordx4 v43, s[36:39], s57 offen lds
    v_mfma_f32_16x16x32_bf16 v[76:79], a[188:191], v[196:199], v[76:79]
    v_mfma_f32_16x16x32_bf16 v[80:83], a[188:191], v[200:203], v[80:83]
    v_mfma_f32_16x16x32_bf16 v[84:87], a[188:191], v[204:207], v[84:87]
    v_mfma_f32_16x16x32_bf16 v[88:91], a[188:191], v[208:211], v[88:91]
    buffer_store_dwordx4 v[68:71], v34, s[40:43], s66 offen offset:3072 nt
    v_mfma_f32_16x16x32_bf16 v[92:95], a[188:191], v[212:215], v[92:95]
    s_waitcnt vmcnt(14)
    s_barrier
    s_waitcnt lgkmcnt(4)
    v_mfma_f32_16x16x32_bf16 v[96:99], a[192:195], a[0:3], 0
    v_mfma_f32_16x16x32_bf16 v[100:103], a[192:195], a[4:7], 0
    ds_read_b64_tr_b16 a[168:169], v32 offset:53248
    v_mfma_f32_16x16x32_bf16 v[104:107], a[192:195], a[8:11], 0
    ds_read_b64_tr_b16 a[170:171], v32 offset:55296
    v_mfma_f32_16x16x32_bf16 v[108:111], a[192:195], a[12:15], 0
    s_add_u32 m0, s53, 0
    s_lshl_b32 s61, s60, 7
    s_add_u32 s60, s60, 1
    s_cmp_eq_u32 s60, 7
    s_cselect_b32 s60, 0, s60
    buffer_load_dwordx4 v43, s[36:39], s61 offen lds
    s_add_u32 m0, s53, 4096
    v_mfma_f32_16x16x32_bf16 v[112:115], a[192:195], a[16:19], 0
    v_cvt_pk_bf16_f32 v76, v76, v77
    v_mfma_f32_16x16x32_bf16 v[96:99], a[196:199], a[20:23], v[96:99]
    ds_read_b64_tr_b16 a[172:173], v32 offset:61440
    v_mfma_f32_16x16x32_bf16 v[100:103], a[196:199], a[24:27], v[100:103]
    ds_read_b64_tr_b16 a[174:175], v32 offset:63488
    v_mfma_f32_16x16x32_bf16 v[104:107], a[196:199], a[28:31], v[104:107]
    v_cvt_pk_bf16_f32 v77, v78, v79
    v_mfma_f32_16x16x32_bf16 v[108:111], a[196:199], a[32:35], v[108:111]
    s_add_u32 s57, s61, 28672
    buffer_load_dwordx4 v43, s[36:39], s57 offen lds
    s_add_u32 m0, s53, 8192
    v_mfma_f32_16x16x32_bf16 v[112:115], a[196:199], a[36:39], v[112:115]
    ds_read_b64_tr_b16 a[176:177], v32 offset:49152
    s_waitcnt lgkmcnt(5)
    v_mfma_f32_16x16x32_bf16 v[96:99], a[160:163], v[136:139], v[96:99]
    v_cvt_pk_bf16_f32 v78, v80, v81
    v_mfma_f32_16x16x32_bf16 v[100:103], a[160:163], v[140:143], v[100:103]
    ds_read_b64_tr_b16 a[178:179], v32 offset:51200
    v_mfma_f32_16x16x32_bf16 v[104:107], a[160:163], v[144:147], v[104:107]
    s_add_u32 s56, s61, 57344
    buffer_load_dwordx4 v43, s[36:39], s56 offen lds
    s_add_u32 m0, s53, 12288
    v_mfma_f32_16x16x32_bf16 v[108:111], a[160:163], v[148:151], v[108:111]
    v_cvt_pk_bf16_f32 v79, v82, v83
    v_mfma_f32_16x16x32_bf16 v[112:115], a[160:163], v[152:155], v[112:115]
    ds_read_b64_tr_b16 a[180:181], v32 offset:57344
    v_mfma_f32_16x16x32_bf16 v[96:99], a[164:167], v[156:159], v[96:99]
    ds_read_b64_tr_b16 a[182:183], v32 offset:59392
    v_mfma_f32_16x16x32_bf16 v[100:103], a[164:167], v[160:163], v[100:103]
    buffer_store_dwordx4 v[76:79], v34, s[40:43], s64 offen offset:1024 nt
    v_mfma_f32_16x16x32_bf16 v[104:107], a[164:167], v[164:167], v[104:107]
    s_add_u32 s57, s61, 86016
    buffer_load_dwordx4 v43, s[36:39], s57 offen lds
    s_add_u32 m0, s53, 16384
    v_mfma_f32_16x16x32_bf16 v[108:111], a[164:167], v[168:171], v[108:111]
    v_xor_b32 v32, 0x10000, v32
    ds_read_b64_tr_b16 a[184:185], v32 offset:4096
    v_mfma_f32_16x16x32_bf16 v[112:115], a[164:167], v[172:175], v[112:115]
    v_cvt_pk_bf16_f32 v66, v84, v85
    s_waitcnt lgkmcnt(5)
    v_mfma_f32_16x16x32_bf16 v[96:99], a[168:171], a[40:43], v[96:99]
    ds_read_b64_tr_b16 a[186:187], v32 offset:6144
    v_mfma_f32_16x16x32_bf16 v[100:103], a[168:171], a[44:47], v[100:103]
    v_cvt_pk_bf16_f32 v67, v86, v87
    v_mfma_f32_16x16x32_bf16 v[104:107], a[168:171], a[48:51], v[104:107]
    s_add_u32 s56, s61, 114688
    buffer_load_dwordx4 v43, s[36:39], s56 offen lds
    s_add_u32 m0, s53, 20480
    v_mfma_f32_16x16x32_bf16 v[108:111], a[168:171], a[52:55], v[108:111]
    ds_read_b64_tr_b16 a[188:189], v32 offset:12288
    v_mfma_f32_16x16x32_bf16 v[112:115], a[168:171], a[56:59], v[112:115]
    ds_read_b64_tr_b16 a[190:191], v32 offset:14336
    v_mfma_f32_16x16x32_bf16 v[96:99], a[172:175], a[60:63], v[96:99]
    buffer_store_dwordx4 v[64:67], v34, s[40:43], s65 offen offset:3072 nt
    v_mfma_f32_16x16x32_bf16 v[100:103], a[172:175], a[64:67], v[100:103]
    s_add_u32 s57, s61, 143360
    buffer_load_dwordx4 v43, s[36:39], s57 offen lds
    s_add_u32 m0, s53, 24576
    v_mfma_f32_16x16x32_bf16 v[104:107], a[172:175], a[68:71], v[104:107]
    ds_read_b64_tr_b16 a[192:193], v32 offset:0
    v_mfma_f32_16x16x32_bf16 v[108:111], a[172:175], a[72:75], v[108:111]
    v_cvt_pk_bf16_f32 v88, v88, v89
    v_mfma_f32_16x16x32_bf16 v[112:115], a[172:175], a[76:79], v[112:115]
    ds_read_b64_tr_b16 a[194:195], v32 offset:2048
    s_waitcnt lgkmcnt(6)
    v_mfma_f32_16x16x32_bf16 v[96:99], a[176:179], v[176:179], v[96:99]
    v_cvt_pk_bf16_f32 v89, v90, v91
    v_mfma_f32_16x16x32_bf16 v[100:103], a[176:179], v[180:183], v[100:103]
    s_add_u32 s56, s61, 172032
    buffer_load_dwordx4 v43, s[36:39], s56 offen lds
    s_add_u32 m0, s53, 28672
    v_mfma_f32_16x16x32_bf16 v[104:107], a[176:179], v[184:187], v[104:107]
    ds_read_b64_tr_b16 a[196:197], v32 offset:8192
    v_mfma_f32_16x16x32_bf16 v[108:111], a[176:179], v[188:191], v[108:111]
    ds_read_b64_tr_b16 a[198:199], v32 offset:10240
    v_mfma_f32_16x16x32_bf16 v[112:115], a[176:179], v[192:195], v[112:115]
    v_cvt_pk_bf16_f32 v90, v92, v93
    v_mfma_f32_16x16x32_bf16 v[96:99], a[180:183], v[196:199], v[96:99]
    s_add_u32 s57, s61, 200704
    buffer_load_dwordx4 v43, s[36:39], s57 offen lds
    v_mfma_f32_16x16x32_bf16 v[100:103], a[180:183], v[200:203], v[100:103]
    v_cvt_pk_bf16_f32 v91, v94, v95
    v_mfma_f32_16x16x32_bf16 v[104:107], a[180:183], v[204:207], v[104:107]
    v_mfma_f32_16x16x32_bf16 v[108:111], a[180:183], v[208:211], v[108:111]
    buffer_store_dwordx4 v[88:91], v34, s[40:43], s67 offen offset:0 nt
    v_mfma_f32_16x16x32_bf16 v[112:115], a[180:183], v[212:215], v[112:115]
    s_waitcnt vmcnt(16)
    s_barrier
    s_waitcnt lgkmcnt(4)
    v_mfma_f32_16x16x32_bf16 v[116:119], a[184:187], a[0:3], 0
    v_mfma_f32_16x16x32_bf16 v[120:123], a[184:187], a[4:7], 0
    ds_read_b64_tr_b16 a[160:161], v32 offset:20480
    v_mfma_f32_16x16x32_bf16 v[124:127], a[184:187], a[8:11], 0
    ds_read_b64_tr_b16 a[162:163], v32 offset:22528
    v_mfma_f32_16x16x32_bf16 v[128:131], a[184:187], a[12:15], 0
    s_add_u32 m0, s53, 32768
    s_lshl_b32 s61, s60, 7
    s_add_u32 s60, s60, 1
    s_cmp_eq_u32 s60, 7
    s_cselect_b32 s60, 0, s60
    buffer_load_dwordx4 v43, s[36:39], s61 offen lds
    s_add_u32 m0, s53, 36864
    v_mfma_f32_16x16x32_bf16 v[132:135], a[184:187], a[16:19], 0
    v_cvt_pk_bf16_f32 v96, v96, v97
    v_mfma_f32_16x16x32_bf16 v[116:119], a[188:191], a[20:23], v[116:119]
    ds_read_b64_tr_b16 a[164:165], v32 offset:28672
    v_mfma_f32_16x16x32_bf16 v[120:123], a[188:191], a[24:27], v[120:123]
    ds_read_b64_tr_b16 a[166:167], v32 offset:30720
    v_mfma_f32_16x16x32_bf16 v[124:127], a[188:191], a[28:31], v[124:127]
    v_cvt_pk_bf16_f32 v97, v98, v99
    v_mfma_f32_16x16x32_bf16 v[128:131], a[188:191], a[32:35], v[128:131]
    s_add_u32 s57, s61, 28672
    buffer_load_dwordx4 v43, s[36:39], s57 offen lds
    s_add_u32 m0, s53, 40960
    v_mfma_f32_16x16x32_bf16 v[132:135], a[188:191], a[36:39], v[132:135]
    ds_read_b64_tr_b16 a[168:169], v32 offset:16384
    s_waitcnt lgkmcnt(5)
    v_mfma_f32_16x16x32_bf16 v[116:119], a[192:195], v[136:139], v[116:119]
    ds_read_b64_tr_b16 a[170:171], v32 offset:18432
    v_mfma_f32_16x16x32_bf16 v[120:123], a[192:195], v[140:143], v[120:123]
    v_cvt_pk_bf16_f32 v98, v100, v101
    v_mfma_f32_16x16x32_bf16 v[124:127], a[192:195], v[144:147], v[124:127]
    s_add_u32 s56, s61, 57344
    buffer_load_dwordx4 v43, s[36:39], s56 offen lds
    s_add_u32 m0, s53, 45056
    v_mfma_f32_16x16x32_bf16 v[128:131], a[192:195], v[148:151], v[128:131]
    ds_read_b64_tr_b16 a[172:173], v32 offset:24576
    v_mfma_f32_16x16x32_bf16 v[132:135], a[192:195], v[152:155], v[132:135]
    v_cvt_pk_bf16_f32 v99, v102, v103
    v_mfma_f32_16x16x32_bf16 v[116:119], a[196:199], v[156:159], v[116:119]
    ds_read_b64_tr_b16 a[174:175], v32 offset:26624
    v_mfma_f32_16x16x32_bf16 v[120:123], a[196:199], v[160:163], v[120:123]
    buffer_store_dwordx4 v[96:99], v34, s[40:43], s64 offen offset:2048 nt
    v_mfma_f32_16x16x32_bf16 v[124:127], a[196:199], v[164:167], v[124:127]
    s_add_u32 s57, s61, 86016
    buffer_load_dwordx4 v43, s[36:39], s57 offen lds
    s_add_u32 m0, s53, 49152
    v_mfma_f32_16x16x32_bf16 v[128:131], a[196:199], v[168:171], v[128:131]
    ds_read_b64_tr_b16 a[176:177], v32 offset:36864
    v_mfma_f32_16x16x32_bf16 v[132:135], a[196:199], v[172:175], v[132:135]
    ds_read_b64_tr_b16 a[178:179], v32 offset:38912
    s_waitcnt lgkmcnt(6)
    v_mfma_f32_16x16x32_bf16 v[116:119], a[160:163], a[40:43], v[116:119]
    v_cvt_pk_bf16_f32 v104, v104, v105
    v_mfma_f32_16x16x32_bf16 v[120:123], a[160:163], a[44:47], v[120:123]
    s_add_u32 s56, s61, 114688
    buffer_load_dwordx4 v43, s[36:39], s56 offen lds
    s_add_u32 m0, s53, 53248
    v_mfma_f32_16x16x32_bf16 v[124:127], a[160:163], a[48:51], v[124:127]
    ds_read_b64_tr_b16 a[180:181], v32 offset:45056
    v_mfma_f32_16x16x32_bf16 v[128:131], a[160:163], a[52:55], v[128:131]
    v_cvt_pk_bf16_f32 v105, v106, v107
    v_mfma_f32_16x16x32_bf16 v[132:135], a[160:163], a[56:59], v[132:135]
    ds_read_b64_tr_b16 a[182:183], v32 offset:47104
    v_mfma_f32_16x16x32_bf16 v[116:119], a[164:167], a[60:63], v[116:119]
    v_cvt_pk_bf16_f32 v108, v108, v109
    v_mfma_f32_16x16x32_bf16 v[120:123], a[164:167], a[64:67], v[120:123]
    s_add_u32 s57, s61, 143360
    buffer_load_dwordx4 v43, s[36:39], s57 offen lds
    s_add_u32 m0, s53, 57344
    v_mfma_f32_16x16x32_bf16 v[124:127], a[164:167], a[68:71], v[124:127]
    ds_read_b64_tr_b16 a[184:185], v32 offset:32768
    v_mfma_f32_16x16x32_bf16 v[128:131], a[164:167], a[72:75], v[128:131]
    ds_read_b64_tr_b16 a[186:187], v32 offset:34816
    v_mfma_f32_16x16x32_bf16 v[132:135], a[164:167], a[76:79], v[132:135]
    v_cvt_pk_bf16_f32 v109, v110, v111
    s_waitcnt lgkmcnt(6)
    v_mfma_f32_16x16x32_bf16 v[116:119], a[168:171], v[176:179], v[116:119]
    s_add_u32 s56, s61, 172032
    buffer_load_dwordx4 v43, s[36:39], s56 offen lds
    s_add_u32 m0, s53, 61440
    v_mfma_f32_16x16x32_bf16 v[120:123], a[168:171], v[180:183], v[120:123]
    ds_read_b64_tr_b16 a[188:189], v32 offset:40960
    v_mfma_f32_16x16x32_bf16 v[124:127], a[168:171], v[184:187], v[124:127]
    v_cvt_pk_bf16_f32 v110, v112, v113
    v_mfma_f32_16x16x32_bf16 v[128:131], a[168:171], v[188:191], v[128:131]
    ds_read_b64_tr_b16 a[190:191], v32 offset:43008
    v_mfma_f32_16x16x32_bf16 v[132:135], a[168:171], v[192:195], v[132:135]
    v_cvt_pk_bf16_f32 v111, v114, v115
    v_mfma_f32_16x16x32_bf16 v[116:119], a[172:175], v[196:199], v[116:119]
    s_add_u32 s57, s61, 200704
    buffer_load_dwordx4 v43, s[36:39], s57 offen lds
    v_mfma_f32_16x16x32_bf16 v[120:123], a[172:175], v[200:203], v[120:123]
    v_mfma_f32_16x16x32_bf16 v[124:127], a[172:175], v[204:207], v[124:127]
    v_mfma_f32_16x16x32_bf16 v[128:131], a[172:175], v[208:211], v[128:131]
    buffer_store_dwordx4 v[108:111], v34, s[40:43], s67 offen offset:1024 nt
    v_mfma_f32_16x16x32_bf16 v[132:135], a[172:175], v[212:215], v[132:135]
    s_waitcnt vmcnt(16)
    s_barrier
    s_waitcnt lgkmcnt(4)
    v_mfma_f32_16x16x32_bf16 v[56:59], a[176:179], a[0:3], 0
    v_mfma_f32_16x16x32_bf16 v[60:63], a[176:179], a[4:7], 0
    ds_read_b64_tr_b16 a[192:193], v32 offset:53248
    v_mfma_f32_16x16x32_bf16 v[64:67], a[176:179], a[8:11], 0
    ds_read_b64_tr_b16 a[194:195], v32 offset:55296
    v_mfma_f32_16x16x32_bf16 v[68:71], a[176:179], a[12:15], 0
    v_cvt_pk_bf16_f32 v116, v116, v117
    v_mfma_f32_16x16x32_bf16 v[72:75], a[176:179], a[16:19], 0
    ds_read_b64_tr_b16 a[196:197], v32 offset:61440
    v_mfma_f32_16x16x32_bf16 v[56:59], a[180:183], a[20:23], v[56:59]
    ds_read_b64_tr_b16 a[198:199], v32 offset:63488
    v_mfma_f32_16x16x32_bf16 v[60:63], a[180:183], a[24:27], v[60:63]
    v_cvt_pk_bf16_f32 v117, v118, v119
    v_mfma_f32_16x16x32_bf16 v[64:67], a[180:183], a[28:31], v[64:67]
    ds_read_b64_tr_b16 a[160:161], v32 offset:49152
    v_mfma_f32_16x16x32_bf16 v[68:71], a[180:183], a[32:35], v[68:71]
    v_cvt_pk_bf16_f32 v118, v120, v121
    v_mfma_f32_16x16x32_bf16 v[72:75], a[180:183], a[36:39], v[72:75]
    ds_read_b64_tr_b16 a[162:163], v32 offset:51200
    s_waitcnt lgkmcnt(6)
    v_mfma_f32_16x16x32_bf16 v[56:59], a[184:187], v[136:139], v[56:59]
    v_cvt_pk_bf16_f32 v119, v122, v123
    v_mfma_f32_16x16x32_bf16 v[60:63], a[184:187], v[140:143], v[60:63]
    ds_read_b64_tr_b16 a[164:165], v32 offset:57344
    v_mfma_f32_16x16x32_bf16 v[64:67], a[184:187], v[144:147], v[64:67]
    ds_read_b64_tr_b16 a[166:167], v32 offset:59392
    v_mfma_f32_16x16x32_bf16 v[68:71], a[184:187], v[148:151], v[68:71]
    buffer_store_dwordx4 v[116:119], v34, s[40:43], s64 offen offset:3072 nt
    v_mfma_f32_16x16x32_bf16 v[72:75], a[184:187], v[152:155], v[72:75]
    v_xor_b32 v32, 0x10000, v32
    ds_read_b64_tr_b16 a[168:169], v32 offset:4096
    v_mfma_f32_16x16x32_bf16 v[56:59], a[188:191], v[156:159], v[56:59]
    v_cvt_pk_bf16_f32 v106, v124, v125
    v_mfma_f32_16x16x32_bf16 v[60:63], a[188:191], v[160:163], v[60:63]
    v_mfma_f32_16x16x32_bf16 v[64:67], a[188:191], v[164:167], v[64:67]
    ds_read_b64_tr_b16 a[170:171], v32 offset:6144
    v_mfma_f32_16x16x32_bf16 v[68:71], a[188:191], v[168:171], v[68:71]
    v_cvt_pk_bf16_f32 v107, v126, v127
    v_mfma_f32_16x16x32_bf16 v[72:75], a[188:191], v[172:175], v[72:75]
    s_waitcnt lgkmcnt(6)
    v_mfma_f32_16x16x32_bf16 v[56:59], a[192:195], a[40:43], v[56:59]
    ds_read_b64_tr_b16 a[172:173], v32 offset:12288
    v_mfma_f32_16x16x32_bf16 v[60:63], a[192:195], a[44:47], v[60:63]
    v_mfma_f32_16x16x32_bf16 v[64:67], a[192:195], a[48:51], v[64:67]
    ds_read_b64_tr_b16 a[174:175], v32 offset:14336
    v_mfma_f32_16x16x32_bf16 v[68:71], a[192:195], a[52:55], v[68:71]
    buffer_store_dwordx4 v[104:107], v34, s[40:43], s66 offen offset:0 nt
    v_mfma_f32_16x16x32_bf16 v[72:75], a[192:195], a[56:59], v[72:75]
    v_mfma_f32_16x16x32_bf16 v[56:59], a[196:199], a[60:63], v[56:59]
    v_mfma_f32_16x16x32_bf16 v[60:63], a[196:199], a[64:67], v[60:63]
    ds_read_b64_tr_b16 a[176:177], v32 offset:0
    v_mfma_f32_16x16x32_bf16 v[64:67], a[196:199], a[68:71], v[64:67]
    v_cvt_pk_bf16_f32 v128, v128, v129
    v_mfma_f32_16x16x32_bf16 v[68:71], a[196:199], a[72:75], v[68:71]
    v_mfma_f32_16x16x32_bf16 v[72:75], a[196:199], a[76:79], v[72:75]
    ds_read_b64_tr_b16 a[178:179], v32 offset:2048
    s_waitcnt lgkmcnt(6)
    v_mfma_f32_16x16x32_bf16 v[56:59], a[160:163], v[176:179], v[56:59]
    v_cvt_pk_bf16_f32 v129, v130, v131
    v_mfma_f32_16x16x32_bf16 v[60:63], a[160:163], v[180:183], v[60:63]
    v_mfma_f32_16x16x32_bf16 v[64:67], a[160:163], v[184:187], v[64:67]
    ds_read_b64_tr_b16 a[180:181], v32 offset:8192
    v_mfma_f32_16x16x32_bf16 v[68:71], a[160:163], v[188:191], v[68:71]
    v_mfma_f32_16x16x32_bf16 v[72:75], a[160:163], v[192:195], v[72:75]
    ds_read_b64_tr_b16 a[182:183], v32 offset:10240
    v_mfma_f32_16x16x32_bf16 v[56:59], a[164:167], v[196:199], v[56:59]
    v_cvt_pk_bf16_f32 v130, v132, v133
    v_mfma_f32_16x16x32_bf16 v[60:63], a[164:167], v[200:203], v[60:63]
    v_cvt_pk_bf16_f32 v131, v134, v135
    v_mfma_f32_16x16x32_bf16 v[64:67], a[164:167], v[204:207], v[64:67]
    v_mfma_f32_16x16x32_bf16 v[68:71], a[164:167], v[208:211], v[68:71]
    buffer_store_dwordx4 v[128:131], v34, s[40:43], s67 offen offset:2048 nt
    v_mfma_f32_16x16x32_bf16 v[72:75], a[164:167], v[212:215], v[72:75]
    s_waitcnt vmcnt(8)
    s_barrier
    s_waitcnt lgkmcnt(4)
    v_mfma_f32_16x16x32_bf16 v[76:79], a[168:171], a[0:3], 0
    v_mfma_f32_16x16x32_bf16 v[80:83], a[168:171], a[4:7], 0
    ds_read_b64_tr_b16 a[184:185], v32 offset:20480
    v_mfma_f32_16x16x32_bf16 v[84:87], a[168:171], a[8:11], 0
    ds_read_b64_tr_b16 a[186:187], v32 offset:22528
    v_mfma_f32_16x16x32_bf16 v[88:91], a[168:171], a[12:15], 0
    v_cvt_pk_bf16_f32 v56, v56, v57
    v_mfma_f32_16x16x32_bf16 v[92:95], a[168:171], a[16:19], 0
    ds_read_b64_tr_b16 a[188:189], v32 offset:28672
    v_mfma_f32_16x16x32_bf16 v[76:79], a[172:175], a[20:23], v[76:79]
    ds_read_b64_tr_b16 a[190:191], v32 offset:30720
    v_mfma_f32_16x16x32_bf16 v[80:83], a[172:175], a[24:27], v[80:83]
    v_cvt_pk_bf16_f32 v57, v58, v59
    v_mfma_f32_16x16x32_bf16 v[84:87], a[172:175], a[28:31], v[84:87]
    ds_read_b64_tr_b16 a[192:193], v32 offset:16384
    v_mfma_f32_16x16x32_bf16 v[88:91], a[172:175], a[32:35], v[88:91]
    ds_read_b64_tr_b16 a[194:195], v32 offset:18432
    v_mfma_f32_16x16x32_bf16 v[92:95], a[172:175], a[36:39], v[92:95]
    v_cvt_pk_bf16_f32 v58, v60, v61
    s_waitcnt lgkmcnt(6)
    v_mfma_f32_16x16x32_bf16 v[76:79], a[176:179], v[136:139], v[76:79]
    ds_read_b64_tr_b16 a[196:197], v32 offset:24576
    v_mfma_f32_16x16x32_bf16 v[80:83], a[176:179], v[140:143], v[80:83]
    v_cvt_pk_bf16_f32 v59, v62, v63
    v_mfma_f32_16x16x32_bf16 v[84:87], a[176:179], v[144:147], v[84:87]
    ds_read_b64_tr_b16 a[198:199], v32 offset:26624
    v_mfma_f32_16x16x32_bf16 v[88:91], a[176:179], v[148:151], v[88:91]
    buffer_store_dwordx4 v[56:59], v34, s[40:43], s65 offen offset:0 nt
    v_mfma_f32_16x16x32_bf16 v[92:95], a[176:179], v[152:155], v[92:95]
    v_mfma_f32_16x16x32_bf16 v[76:79], a[180:183], v[156:159], v[76:79]
    ds_read_b64_tr_b16 a[160:161], v32 offset:36864
    v_mfma_f32_16x16x32_bf16 v[80:83], a[180:183], v[160:163], v[80:83]
    v_mfma_f32_16x16x32_bf16 v[84:87], a[180:183], v[164:167], v[84:87]
    ds_read_b64_tr_b16 a[162:163], v32 offset:38912
    v_mfma_f32_16x16x32_bf16 v[88:91], a[180:183], v[168:171], v[88:91]
    v_cvt_pk_bf16_f32 v64, v64, v65
    v_mfma_f32_16x16x32_bf16 v[92:95], a[180:183], v[172:175], v[92:95]
    s_waitcnt lgkmcnt(6)
    v_mfma_f32_16x16x32_bf16 v[76:79], a[184:187], a[40:43], v[76:79]
    ds_read_b64_tr_b16 a[164:165], v32 offset:45056
    v_mfma_f32_16x16x32_bf16 v[80:83], a[184:187], a[44:47], v[80:83]
    v_cvt_pk_bf16_f32 v65, v66, v67
    v_mfma_f32_16x16x32_bf16 v[84:87], a[184:187], a[48:51], v[84:87]
    v_mfma_f32_16x16x32_bf16 v[88:91], a[184:187], a[52:55], v[88:91]
    v_mfma_f32_16x16x32_bf16 v[92:95], a[184:187], a[56:59], v[92:95]
    ds_read_b64_tr_b16 a[166:167], v32 offset:47104
    v_mfma_f32_16x16x32_bf16 v[76:79], a[188:191], a[60:63], v[76:79]
    v_cvt_pk_bf16_f32 v68, v68, v69
    v_mfma_f32_16x16x32_bf16 v[80:83], a[188:191], a[64:67], v[80:83]
    v_mfma_f32_16x16x32_bf16 v[84:87], a[188:191], a[68:71], v[84:87]
    ds_read_b64_tr_b16 a[168:169], v32 offset:32768
    v_mfma_f32_16x16x32_bf16 v[88:91], a[188:191], a[72:75], v[88:91]
    v_mfma_f32_16x16x32_bf16 v[92:95], a[188:191], a[76:79], v[92:95]
    ds_read_b64_tr_b16 a[170:171], v32 offset:34816
    s_waitcnt lgkmcnt(6)
    v_mfma_f32_16x16x32_bf16 v[76:79], a[192:195], v[176:179], v[76:79]
    v_cvt_pk_bf16_f32 v69, v70, v71
    v_mfma_f32_16x16x32_bf16 v[80:83], a[192:195], v[180:183], v[80:83]
    v_mfma_f32_16x16x32_bf16 v[84:87], a[192:195], v[184:187], v[84:87]
    ds_read_b64_tr_b16 a[172:173], v32 offset:40960
    v_mfma_f32_16x16x32_bf16 v[88:91], a[192:195], v[188:191], v[88:91]
    v_cvt_pk_bf16_f32 v70, v72, v73
    v_mfma_f32_16x16x32_bf16 v[92:95], a[192:195], v[192:195], v[92:95]
    v_mfma_f32_16x16x32_bf16 v[76:79], a[196:199], v[196:199], v[76:79]
    v_mfma_f32_16x16x32_bf16 v[80:83], a[196:199], v[200:203], v[80:83]
    ds_read_b64_tr_b16 a[174:175], v32 offset:43008
    v_mfma_f32_16x16x32_bf16 v[84:87], a[196:199], v[204:207], v[84:87]
    v_cvt_pk_bf16_f32 v71, v74, v75
    v_mfma_f32_16x16x32_bf16 v[88:91], a[196:199], v[208:211], v[88:91]
    buffer_store_dwordx4 v[68:71], v34, s[40:43], s67 offen offset:3072 nt
    v_mfma_f32_16x16x32_bf16 v[92:95], a[196:199], v[212:215], v[92:95]
    s_waitcnt vmcnt(6)
    s_barrier
    s_waitcnt lgkmcnt(4)
    v_mfma_f32_16x16x32_bf16 v[96:99], a[160:163], a[0:3], 0
    v_mfma_f32_16x16x32_bf16 v[100:103], a[160:163], a[4:7], 0
    v_mfma_f32_16x16x32_bf16 v[104:107], a[160:163], a[8:11], 0
    v_mfma_f32_16x16x32_bf16 v[108:111], a[160:163], a[12:15], 0
    v_mfma_f32_16x16x32_bf16 v[112:115], a[160:163], a[16:19], 0
    v_mfma_f32_16x16x32_bf16 v[96:99], a[164:167], a[20:23], v[96:99]
    v_mfma_f32_16x16x32_bf16 v[100:103], a[164:167], a[24:27], v[100:103]
    v_mfma_f32_16x16x32_bf16 v[104:107], a[164:167], a[28:31], v[104:107]
    ds_read_b64_tr_b16 a[176:177], v32 offset:53248
    v_mfma_f32_16x16x32_bf16 v[108:111], a[164:167], a[32:35], v[108:111]
    v_mfma_f32_16x16x32_bf16 v[112:115], a[164:167], a[36:39], v[112:115]
    ds_read_b64_tr_b16 a[178:179], v32 offset:55296
    s_waitcnt lgkmcnt(2)
    v_mfma_f32_16x16x32_bf16 v[96:99], a[168:171], v[136:139], v[96:99]
    v_cvt_pk_bf16_f32 v76, v76, v77
    v_mfma_f32_16x16x32_bf16 v[100:103], a[168:171], v[140:143], v[100:103]
    v_mfma_f32_16x16x32_bf16 v[104:107], a[168:171], v[144:147], v[104:107]
    ds_read_b64_tr_b16 a[180:181], v32 offset:61440
    v_mfma_f32_16x16x32_bf16 v[108:111], a[168:171], v[148:151], v[108:111]
    v_mfma_f32_16x16x32_bf16 v[112:115], a[168:171], v[152:155], v[112:115]
    ds_read_b64_tr_b16 a[182:183], v32 offset:63488
    v_mfma_f32_16x16x32_bf16 v[96:99], a[172:175], v[156:159], v[96:99]
    v_cvt_pk_bf16_f32 v77, v78, v79
    v_mfma_f32_16x16x32_bf16 v[100:103], a[172:175], v[160:163], v[100:103]
    v_mfma_f32_16x16x32_bf16 v[104:107], a[172:175], v[164:167], v[104:107]
    v_mfma_f32_16x16x32_bf16 v[108:111], a[172:175], v[168:171], v[108:111]
    ds_read_b64_tr_b16 a[184:185], v32 offset:49152
    v_mfma_f32_16x16x32_bf16 v[112:115], a[172:175], v[172:175], v[112:115]
    v_cvt_pk_bf16_f32 v78, v80, v81
    s_waitcnt lgkmcnt(1)
    v_mfma_f32_16x16x32_bf16 v[96:99], a[176:179], a[40:43], v[96:99]
    v_mfma_f32_16x16x32_bf16 v[100:103], a[176:179], a[44:47], v[100:103]
    ds_read_b64_tr_b16 a[186:187], v32 offset:51200
    v_mfma_f32_16x16x32_bf16 v[104:107], a[176:179], a[48:51], v[104:107]
    v_cvt_pk_bf16_f32 v79, v82, v83
    v_mfma_f32_16x16x32_bf16 v[108:111], a[176:179], a[52:55], v[108:111]
    v_mfma_f32_16x16x32_bf16 v[112:115], a[176:179], a[56:59], v[112:115]
    ds_read_b64_tr_b16 a[188:189], v32 offset:57344
    v_mfma_f32_16x16x32_bf16 v[96:99], a[180:183], a[60:63], v[96:99]
    v_mfma_f32_16x16x32_bf16 v[100:103], a[180:183], a[64:67], v[100:103]
    ds_read_b64_tr_b16 a[190:191], v32 offset:59392
    v_mfma_f32_16x16x32_bf16 v[104:107], a[180:183], a[68:71], v[104:107]
    buffer_store_dwordx4 v[76:79], v34, s[40:43], s65 offen offset:1024 nt
    v_mfma_f32_16x16x32_bf16 v[108:111], a[180:183], a[72:75], v[108:111]
    v_cvt_pk_bf16_f32 v66, v84, v85
    v_mfma_f32_16x16x32_bf16 v[112:115], a[180:183], a[76:79], v[112:115]
    v_cvt_pk_bf16_f32 v67, v86, v87
    s_waitcnt lgkmcnt(0)
    v_mfma_f32_16x16x32_bf16 v[96:99], a[184:187], v[176:179], v[96:99]
    buffer_store_dwordx4 v[64:67], v34, s[40:43], s66 offen offset:1024 nt
    v_mfma_f32_16x16x32_bf16 v[100:103], a[184:187], v[180:183], v[100:103]
    v_cvt_pk_bf16_f32 v88, v88, v89
    v_mfma_f32_16x16x32_bf16 v[104:107], a[184:187], v[184:187], v[104:107]
    v_cvt_pk_bf16_f32 v89, v90, v91
    v_mfma_f32_16x16x32_bf16 v[108:111], a[184:187], v[188:191], v[108:111]
    v_mfma_f32_16x16x32_bf16 v[112:115], a[184:187], v[192:195], v[112:115]
    v_cvt_pk_bf16_f32 v90, v92, v93
    v_mfma_f32_16x16x32_bf16 v[96:99], a[188:191], v[196:199], v[96:99]
    v_mfma_f32_16x16x32_bf16 v[100:103], a[188:191], v[200:203], v[100:103]
    v_cvt_pk_bf16_f32 v91, v94, v95
    v_mfma_f32_16x16x32_bf16 v[104:107], a[188:191], v[204:207], v[104:107]
    v_mfma_f32_16x16x32_bf16 v[108:111], a[188:191], v[208:211], v[108:111]
    buffer_store_dwordx4 v[88:91], v34, s[40:43], s68 offen offset:0 nt
    v_mfma_f32_16x16x32_bf16 v[112:115], a[188:191], v[212:215], v[112:115]
    s_nop 1
    v_cvt_pk_bf16_f32 v96, v96, v97
    v_cvt_pk_bf16_f32 v97, v98, v99
    v_cvt_pk_bf16_f32 v98, v100, v101
    v_cvt_pk_bf16_f32 v99, v102, v103
    buffer_store_dwordx4 v[96:99], v34, s[40:43], s65 offen offset:2048 nt
    v_cvt_pk_bf16_f32 v104, v104, v105
    v_cvt_pk_bf16_f32 v105, v106, v107
    buffer_store_dwordx4 v[104:107], v34, s[40:43], s66 offen offset:2048 nt
    v_cvt_pk_bf16_f32 v108, v108, v109
    v_cvt_pk_bf16_f32 v109, v110, v111
    v_cvt_pk_bf16_f32 v110, v112, v113
    v_cvt_pk_bf16_f32 v111, v114, v115
    buffer_store_dwordx4 v[108:111], v34, s[40:43], s68 offen offset:1024 nt
    s_endpgm
L_redo:
    s_nop 9
    s_waitcnt vmcnt(0) lgkmcnt(0)
    s_barrier
    v_and_b32 v7, 15, v0
    v_lshlrev_b32 v7, 4, v7
    s_lshl_b32 s59, s45, 2
    s_add_u32 s59, s59, 161792
    v_add_u32 v7, s59, v7
    v_sub_f32 v1, v1, v8
    v_mov_b32 v6, v1
    s_nop 1
    v_permlane32_swap_b32 v1, v6
    v_max_f32 v1, v1, v6
    v_mov_b32 v6, v1
    s_nop 1
    v_permlane16_swap_b32 v1, v6
    v_max_f32 v1, v1, v6
    ds_write_b32 v7, v1 offset:0
    v_sub_f32 v2, v2, v12
    v_mov_b32 v6, v2
    s_nop 1
    v_permlane32_swap_b32 v2, v6
    v_max_f32 v2, v2, v6
    v_mov_b32 v6, v2
    s_nop 1
    v_permlane16_swap_b32 v2, v6
    v_max_f32 v2, v2, v6
    ds_write_b32 v7, v2 offset:256
    v_sub_f32 v3, v3, v16
    v_mov_b32 v6, v3
    s_nop 1
    v_permlane32_swap_b32 v3, v6
    v_max_f32 v3, v3, v6
    v_mov_b32 v6, v3
    s_nop 1
    v_permlane16_swap_b32 v3, v6
    v_max_f32 v3, v3, v6
    ds_write_b32 v7, v3 offset:512
    v_sub_f32 v4, v4, v20
    v_mov_b32 v6, v4
    s_nop 1
    v_permlane32_swap_b32 v4, v6
    v_max_f32 v4, v4, v6
    v_mov_b32 v6, v4
    s_nop 1
    v_permlane16_swap_b32 v4, v6
    v_max_f32 v4, v4, v6
    ds_write_b32 v7, v4 offset:768
    v_sub_f32 v5, v5, v24
    v_mov_b32 v6, v5
    s_nop 1
    v_permlane32_swap_b32 v5, v6
    v_max_f32 v5, v5, v6
    v_mov_b32 v6, v5
    s_nop 1
    v_permlane16_swap_b32 v5, v6
    v_max_f32 v5, v5, v6
    ds_write_b32 v7, v5 offset:1024
    s_waitcnt lgkmcnt(0)
    s_barrier
    v_and_b32 v7, 15, v0
    v_lshlrev_b32 v7, 4, v7
    v_add_u32 v7, 161792, v7
    ds_read_b128 v[56:59], v7 offset:0
    s_waitcnt lgkmcnt(0)
    v_max3_f32 v8, v56, v57, v58
    v_max_f32 v8, v8, v59
    v_sub_f32 v8, 0, v8
    ds_read_b128 v[60:63], v7 offset:256
    s_waitcnt lgkmcnt(0)
    v_max3_f32 v12, v60, v61, v62
    v_max_f32 v12, v12, v63
    v_sub_f32 v12, 0, v12
    ds_read_b128 v[64:67], v7 offset:512
    s_waitcnt lgkmcnt(0)
    v_max3_f32 v16, v64, v65, v66
    v_max_f32 v16, v16, v67
    v_sub_f32 v16, 0, v16
    ds_read_b128 v[68:71], v7 offset:768
    s_waitcnt lgkmcnt(0)
    v_max3_f32 v20, v68, v69, v70
    v_max_f32 v20, v20, v71
    v_sub_f32 v20, 0, v20
    ds_read_b128 v[72:75], v7 offset:1024
    s_waitcnt lgkmcnt(0)
    v_max3_f32 v24, v72, v73, v74
    v_max_f32 v24, v24, v75
    v_sub_f32 v24, 0, v24
    s_mov_b32 s54, 1
    s_barrier
    s_nop 9
    s_branch L_restart
L_attn_kernel_done:
    s_endpgm
.section .rodata,"a"
.p2align 6
.amdhsa_kernel attn_kernel
  .amdhsa_next_free_vgpr 512
  .amdhsa_next_free_sgpr 102
  .amdhsa_accum_offset 256
  .amdhsa_group_segment_fixed_size 0
  .amdhsa_kernarg_size 64
  .amdhsa_user_sgpr_count 2
  .amdhsa_user_sgpr_kernarg_segment_ptr 1
  .amdhsa_system_sgpr_workgroup_id_x 1
.end_amdhsa_kernel
.text
.text
.globl red_kernel
.p2align 8
.type red_kernel,@function
red_kernel:
    s_cmp_ge_u32 s2, 2304
    s_cbranch_scc1 L_red_kernel_done
    s_load_dwordx2 s[4:5], s[0:1], 40
    s_load_dwordx2 s[6:7], s[0:1], 56
    s_and_b32 s8, s2, 15
    s_lshr_b32 s9, s2, 5
    s_bfe_u32 s33, s2, 0x10004
    v_and_b32 v6, 31, v0
    s_lshl_b32 s34, s33, 5
    v_add_u32 v6, s34, v6
    v_lshrrev_b32 v7, 5, v0
    s_mov_b32 s35, 9437184
    v_mul_lo_u32 v7, v7, s35
    v_lshl_add_u32 v1, v6, 4, v7
    s_mul_i32 s12, s8, 73728
    s_lshl_b32 s13, s9, 10
    s_add_u32 s12, s12, s13
    s_waitcnt lgkmcnt(0)
    s_mov_b32 s16, s6
    s_and_b32 s17, s7, 0xffff
    s_mov_b32 s18, 18874368
    s_mov_b32 s19, 0x00020000
    buffer_load_dwordx4 v[8:11], v1, s[16:19], s12 offen nt
    s_add_u32 s12, s12, 1179648
    buffer_load_dwordx4 v[12:15], v1, s[16:19], s12 offen nt
    s_add_u32 s12, s12, 1179648
    buffer_load_dwordx4 v[16:19], v1, s[16:19], s12 offen nt
    s_add_u32 s12, s12, 1179648
    buffer_load_dwordx4 v[20:23], v1, s[16:19], s12 offen nt
    s_add_u32 s12, s12, 1179648
    buffer_load_dwordx4 v[24:27], v1, s[16:19], s12 offen nt
    s_add_u32 s12, s12, 1179648
    buffer_load_dwordx4 v[28:31], v1, s[16:19], s12 offen nt
    s_add_u32 s12, s12, 1179648
    buffer_load_dwordx4 v[32:35], v1, s[16:19], s12 offen nt
    s_add_u32 s12, s12, 1179648
    buffer_load_dwordx4 v[36:39], v1, s[16:19], s12 offen nt
    s_mov_b32 s20, s4
    s_and_b32 s21, s5, 0xffff
    s_mov_b32 s22, 1146880
    s_mov_b32 s23, 0x00020000
    s_mul_i32 s10, s9, 57
    s_lshr_b32 s10, s10, 10
    s_mul_i32 s11, s10, 18
    s_sub_u32 s11, s9, s11
    v_and_b32 v2, 15, v6
    v_mul_u32_u24 v2, 896, v2
    v_lshrrev_b32 v3, 4, v6
    v_lshl_add_u32 v2, v3, 3, v2
    s_mul_i32 s32, s8, 37
    s_lshr_b32 s32, s32, 8
    s_mul_i32 s32, s32, 7
    s_sub_u32 s32, s8, s32
    s_mov_b32 s25, s11
    s_mov_b32 s26, 0
    s_lshl_b32 s24, s11, 1
    s_sub_u32 s24, s24, 14
    s_cmp_ge_u32 s11, 7
    s_cselect_b32 s25, s24, s25
    s_cselect_b32 s26, 2, s26
    s_sub_u32 s24, s11, 11
    s_cmp_ge_u32 s11, 11
    s_cselect_b32 s25, s24, s25
    s_cselect_b32 s26, 3, s26
    s_add_u32 s25, s25, s32
    s_sub_u32 s24, s25, 7
    s_cmp_ge_u32 s25, 7
    s_cselect_b32 s25, s24, s25
    s_lshl_b32 s27, s26, 4
    s_mul_i32 s29, s8, 80
    s_add_u32 s27, s27, s29
    s_mul_i32 s27, s27, 896
    s_lshl_b32 s28, s25, 7
    s_add_u32 s27, s27, s28
    s_lshl_b32 s28, s10, 5
    s_add_u32 s30, s27, s28
    s_mov_b32 s25, s11
    s_mov_b32 s26, 1
    s_lshl_b32 s24, s11, 1
    s_sub_u32 s24, s24, 13
    s_cmp_ge_u32 s11, 7
    s_cselect_b32 s25, s24, s25
    s_cselect_b32 s26, 2, s26
    s_sub_u32 s24, s11, 11
    s_cmp_ge_u32 s11, 11
    s_cselect_b32 s25, s24, s25
    s_cselect_b32 s26, 4, s26
    s_add_u32 s25, s25, s32
    s_sub_u32 s24, s25, 7
    s_cmp_ge_u32 s25, 7
    s_cselect_b32 s25, s24, s25
    s_lshl_b32 s27, s26, 4
    s_mul_i32 s29, s8, 80
    s_add_u32 s27, s27, s29
    s_mul_i32 s27, s27, 896
    s_lshl_b32 s28, s25, 7
    s_add_u32 s27, s27, s28
    s_lshl_b32 s28, s10, 5
    s_add_u32 s31, s27, s28
    s_cmp_eq_u32 s11, 10
    s_cselect_b32 s31, 0x70000000, s31
    v_mov_b32 v3, s30
    v_mov_b32 v4, s31
    v_cmp_gt_u32 vcc, 32, v0
    s_nop 1
    v_cndmask_b32 v3, v4, v3, vcc
    v_add_u32 v2, v2, v3
    s_waitcnt vmcnt(7)
    v_lshlrev_b32 v40, 16, v8
    v_and_b32 v41, 0xffff0000, v8
    v_lshlrev_b32 v42, 16, v9
    v_and_b32 v43, 0xffff0000, v9
    v_lshlrev_b32 v44, 16, v10
    v_and_b32 v45, 0xffff0000, v10
    v_lshlrev_b32 v46, 16, v11
    v_and_b32 v47, 0xffff0000, v11
    s_waitcnt vmcnt(6)
    v_lshlrev_b32 v4, 16, v12
    v_and_b32 v5, 0xffff0000, v12
    v_pk_add_f32 v[40:41], v[40:41], v[4:5]
    v_lshlrev_b32 v6, 16, v13
    v_and_b32 v7, 0xffff0000, v13
    v_pk_add_f32 v[42:43], v[42:43], v[6:7]
    v_lshlrev_b32 v4, 16, v14
    v_and_b32 v5, 0xffff0000, v14
    v_pk_add_f32 v[44:45], v[44:45], v[4:5]
    v_lshlrev_b32 v6, 16, v15
    v_and_b32 v7, 0xffff0000, v15
    v_pk_add_f32 v[46:47], v[46:47], v[6:7]
    s_waitcnt vmcnt(5)
    v_lshlrev_b32 v4, 16, v16
    v_and_b32 v5, 0xffff0000, v16
    v_pk_add_f32 v[40:41], v[40:41], v[4:5]
    v_lshlrev_b32 v6, 16, v17
    v_and_b32 v7, 0xffff0000, v17
    v_pk_add_f32 v[42:43], v[42:43], v[6:7]
    v_lshlrev_b32 v4, 16, v18
    v_and_b32 v5, 0xffff0000, v18
    v_pk_add_f32 v[44:45], v[44:45], v[4:5]
    v_lshlrev_b32 v6, 16, v19
    v_and_b32 v7, 0xffff0000, v19
    v_pk_add_f32 v[46:47], v[46:47], v[6:7]
    s_waitcnt vmcnt(4)
    v_lshlrev_b32 v4, 16, v20
    v_and_b32 v5, 0xffff0000, v20
    v_pk_add_f32 v[40:41], v[40:41], v[4:5]
    v_lshlrev_b32 v6, 16, v21
    v_and_b32 v7, 0xffff0000, v21
    v_pk_add_f32 v[42:43], v[42:43], v[6:7]
    v_lshlrev_b32 v4, 16, v22
    v_and_b32 v5, 0xffff0000, v22
    v_pk_add_f32 v[44:45], v[44:45], v[4:5]
    v_lshlrev_b32 v6, 16, v23
    v_and_b32 v7, 0xffff0000, v23
    v_pk_add_f32 v[46:47], v[46:47], v[6:7]
    s_waitcnt vmcnt(3)
    v_lshlrev_b32 v4, 16, v24
    v_and_b32 v5, 0xffff0000, v24
    v_pk_add_f32 v[40:41], v[40:41], v[4:5]
    v_lshlrev_b32 v6, 16, v25
    v_and_b32 v7, 0xffff0000, v25
    v_pk_add_f32 v[42:43], v[42:43], v[6:7]
    v_lshlrev_b32 v4, 16, v26
    v_and_b32 v5, 0xffff0000, v26
    v_pk_add_f32 v[44:45], v[44:45], v[4:5]
    v_lshlrev_b32 v6, 16, v27
    v_and_b32 v7, 0xffff0000, v27
    v_pk_add_f32 v[46:47], v[46:47], v[6:7]
    s_waitcnt vmcnt(2)
    v_lshlrev_b32 v4, 16, v28
    v_and_b32 v5, 0xffff0000, v28
    v_pk_add_f32 v[40:41], v[40:41], v[4:5]
    v_lshlrev_b32 v6, 16, v29
    v_and_b32 v7, 0xffff0000, v29
    v_pk_add_f32 v[42:43], v[42:43], v[6:7]
    v_lshlrev_b32 v4, 16, v30
    v_and_b32 v5, 0xffff0000, v30
    v_pk_add_f32 v[44:45], v[44:45], v[4:5]
    v_lshlrev_b32 v6, 16, v31
    v_and_b32 v7, 0xffff0000, v31
    v_pk_add_f32 v[46:47], v[46:47], v[6:7]
    s_waitcnt vmcnt(1)
    v_lshlrev_b32 v4, 16, v32
    v_and_b32 v5, 0xffff0000, v32
    v_pk_add_f32 v[40:41], v[40:41], v[4:5]
    v_lshlrev_b32 v6, 16, v33
    v_and_b32 v7, 0xffff0000, v33
    v_pk_add_f32 v[42:43], v[42:43], v[6:7]
    v_lshlrev_b32 v4, 16, v34
    v_and_b32 v5, 0xffff0000, v34
    v_pk_add_f32 v[44:45], v[44:45], v[4:5]
    v_lshlrev_b32 v6, 16, v35
    v_and_b32 v7, 0xffff0000, v35
    v_pk_add_f32 v[46:47], v[46:47], v[6:7]
    s_waitcnt vmcnt(0)
    v_lshlrev_b32 v4, 16, v36
    v_and_b32 v5, 0xffff0000, v36
    v_pk_add_f32 v[40:41], v[40:41], v[4:5]
    v_lshlrev_b32 v6, 16, v37
    v_and_b32 v7, 0xffff0000, v37
    v_pk_add_f32 v[42:43], v[42:43], v[6:7]
    v_lshlrev_b32 v4, 16, v38
    v_and_b32 v5, 0xffff0000, v38
    v_pk_add_f32 v[44:45], v[44:45], v[4:5]
    v_lshlrev_b32 v6, 16, v39
    v_and_b32 v7, 0xffff0000, v39
    v_pk_add_f32 v[46:47], v[46:47], v[6:7]
    v_permlane32_swap_b32 v40, v44
    v_permlane32_swap_b32 v41, v45
    v_permlane32_swap_b32 v42, v46
    v_permlane32_swap_b32 v43, v47
    v_add_f32 v40, v40, v44
    v_add_f32 v41, v41, v45
    v_add_f32 v42, v42, v46
    v_add_f32 v43, v43, v47
    v_cvt_pk_bf16_f32 v8, v40, v41
    v_cvt_pk_bf16_f32 v9, v42, v43
    buffer_store_dwordx2 v[8:9], v2, s[20:23], 0 offen
L_red_kernel_done:
    s_endpgm
.section .rodata,"a"
.p2align 6
.amdhsa_kernel red_kernel
  .amdhsa_next_free_vgpr 48
  .amdhsa_next_free_sgpr 40
  .amdhsa_accum_offset 48
  .amdhsa_group_segment_fixed_size 0
  .amdhsa_kernarg_size 64
  .amdhsa_user_sgpr_count 2
  .amdhsa_user_sgpr_kernarg_segment_ptr 1
  .amdhsa_system_sgpr_workgroup_id_x 1
.end_amdhsa_kernel
.text
L_text_end:
```
